```python
import torch

def _softmax(x, axis=-1):
    return torch.softmax(x, dim=axis)
def _gelu(x):
    return torch.nn.functional.gelu(x, approximate="tanh")
def _silu(x):
    return torch.nn.functional.silu(x)
def _sigmoid(x):
    return torch.sigmoid(x)
def _layernorm(x, axis=-1, eps=1e-5):
    m = x.mean(dim=axis, keepdim=True)
    v = x.var(dim=axis, keepdim=True, unbiased=False)
    return (x - m) / torch.sqrt(v + eps)
def _scatter_add(tgt, idx, src, axis=0):
    return tgt.clone().index_add_(axis, idx, src)
def _segment_sum(src, seg, n):
    out = torch.zeros((n,) + src.shape[1:], dtype=src.dtype)
    return out.index_add_(0, seg, src)
def _pad(x, pw):
    flat = tuple(v for pair in reversed(pw) for v in pair)
    return torch.nn.functional.pad(x, flat)

kernel_name = 'gated_mix__softmax_full_mha__mixer_s_mlp__prompt'

def setup_inputs():

    _w = (lambda a: (lambda t: t.to(torch.bfloat16) if t.is_floating_point() else t)(torch.as_tensor(a)))
    def _A_setup():
        B, S, D = 1, 2048, 576
        return {
            "x": _w((lambda *s: torch.randn(*s, dtype=torch.bfloat16) * 0.05)(B, S, D)),
            "wqkv": _w((lambda *s: torch.randn(*s, dtype=torch.bfloat16) * 1.6)(D, 3 * D)),
            "wo": _w((lambda *s: torch.randn(*s, dtype=torch.bfloat16) * 0.1)(D, D)),
        }
    _A_in = _A_setup()

    def _B_setup():
        B, S, D, F = 1, 2048, 576, 4608
        return {
            "x":  _w((lambda *s: torch.randn(*s, dtype=torch.bfloat16) * 0.05)(B, S, D)),
            "w1": _w((lambda *s: torch.randn(*s, dtype=torch.bfloat16) * 3.2)(D, D) * (D ** -0.5)),
            "w2": _w((lambda *s: torch.randn(*s, dtype=torch.bfloat16) * 3.2)(D, D) * (D ** -0.5)),
            "w3": _w((lambda *s: torch.randn(*s, dtype=torch.bfloat16) * 3.2)(D, F) * (D ** -0.5)),
            "w4": _w((lambda *s: torch.randn(*s, dtype=torch.bfloat16) * 3.2)(F, D) * (F ** -0.5)),
        }
    _B_in = _B_setup()

    return {
        "A_x": _A_in["x"],
        "A_wqkv": _A_in["wqkv"],
        "A_wo": _A_in["wo"],
        "B_x": _B_in["x"],
        "B_w1": _B_in["w1"],
        "B_w2": _B_in["w2"],
        "B_w3": _B_in["w3"],
        "B_w4": _B_in["w4"],
        "gate_w": _w((lambda *s: torch.randn(*s, dtype=torch.bfloat16) * 0.05)(576) * 16.0),
    }

def reference(A_x, A_wqkv, A_wo, B_x, B_w1, B_w2, B_w3, B_w4, gate_w):
    def _A_ref(x, wqkv, wo):
        B, S, D = x.shape
        H = 32; Dh = D // H
        qkv = (lambda x, *d: x.permute(*d))((x @ wqkv).reshape(B, S, 3, H, Dh), 2, 0, 3, 1, 4)
        q, k, v = qkv[0], qkv[1], qkv[2]
        scale = Dh ** -0.5
        scores = torch.einsum("bhqd,bhkd->bhqk", q, k) * scale
        p = _softmax(scores, axis=-1)
        o = torch.einsum("bhqk,bhkd->bhqd", p, v)
        return (lambda x, *d: x.permute(*d))(o, 0, 2, 1, 3).reshape(B, S, D) @ wo

    def _B_ref(x, w1, w2, w3, w4):
        B, S, D = x.shape
        h = _gelu(_layernorm(x, axis=-1) @ w1)
        c = D // 4
        g0 = _pad(h[:, :, 0*c:1*c], ((0, 0), (1, 0), (0, 0)))[:, :S, :]
        g1 = _pad(h[:, :, 1*c:2*c], ((0, 0), (0, 1), (0, 0)))[:, 1:, :]
        g2 = _pad(h[:, :, 2*c:3*c], ((0, 0), (2, 0), (0, 0)))[:, :S, :]
        g3 = _pad(h[:, :, 3*c:   ], ((0, 0), (0, 2), (0, 0)))[:, 2:, :]
        hs = torch.concatenate([g0, g1, g2, g3], axis=-1) @ w2
        x1 = x + hs
        h2 = _gelu(_layernorm(x1, axis=-1) @ w3) @ w4
        return x1 + h2

    x = A_x
    g = _sigmoid((x * gate_w).sum(-1, keepdims=True))
    a = _A_ref(x, A_wqkv, A_wo)
    b = _B_ref(x, B_w1, B_w2, B_w3, B_w4)
    return g * a + (1 - g) * b
```

```asm
; @launch kernel=k1_kernel grid=(256,1,1) block=(256,1,1) lds=163840
; @launch kernel=k234_kernel grid=(256,1,1) block=(256,1,1) lds=163840
.amdgcn_target "amdgcn-amd-amdhsa--gfx950"
.text
.globl k1_kernel
.p2align 8
.type k1_kernel,@function
k1_kernel:
  s_cmp_ge_u32 s2, 256
  s_cbranch_scc1 L_k1_end
  s_load_dwordx16 s[80:95], s[0:1], 0
  s_load_dwordx4 s[96:99], s[0:1], 64
  s_load_dwordx2 s[100:101], s[0:1], 88
  v_lshrrev_b32 v2, 6, v0
  v_and_b32 v1, 63, v0
  v_readfirstlane_b32 s3, v2
  s_getpc_b64 s[64:65]
L_pc_k1_kernel_1:
  s_sub_u32 s64, s64, L_pc_k1_kernel_1-k1_kernel
  s_subb_u32 s65, s65, 0
  s_mov_b32 s66, L_k1_end-k1_kernel
  s_mov_b32 s67, 0x20000
  s_lshr_b32 s68, s2, 3
  s_lshl_b32 s68, s68, 2
  s_add_u32 s68, s68, s3
  s_lshl_b32 s68, s68, 10
  v_lshlrev_b32 v2, 4, v1
  buffer_load_dwordx4 v[240:243], v2, s[64:67], s68 offen
  s_lshr_b32 s39, s2, 3
  s_and_b32 s38, s2, 6
  s_lshl_b32 s38, s38, 1
  s_and_b32 s27, s39, 3
  s_add_u32 s16, s38, s27
  s_lshl_b32 s18, s16, 2
  s_add_u32 s18, s18, s3
  s_lshr_b32 s39, s39, 2
  s_bitcmp1_b32 s2, 0
  s_waitcnt lgkmcnt(0)
  s_cbranch_scc1 L_k1_y1
  s_cmp_lt_u32 s39, 5
  s_cbranch_scc0 L_k1_y0b
  s_mov_b32 s17, s39
  s_branch L_k1_qkv
L_k1_y0b:
  s_cmp_eq_u32 s39, 7
  s_cbranch_scc1 L_k1_gate
  s_sub_u32 s17, s39, 5
  s_branch L_k1_b1
L_k1_y1:
  s_cmp_lt_u32 s39, 4
  s_cbranch_scc0 L_k1_y1b
  s_add_u32 s17, s39, 5
  s_branch L_k1_qkv
L_k1_y1b:
  s_sub_u32 s17, s39, 2
  s_branch L_k1_b1
L_k1_qkv:
  s_mov_b64 s[70:71], s[80:81]
  s_mov_b64 s[72:73], s[82:83]
  s_lshr_b32 s74, s2, 3
  s_lshl_b32 s74, s74, 2
  s_add_u32 s74, s74, s3
  v_lshlrev_b32 v3, 4, v1
  s_mov_b32 m0, 155648
  s_bfe_u32 s75, s2, 0x20001
  s_mul_i32 s75, s75, 589824
  s_lshl_b32 s76, s74, 10
  s_add_u32 s75, s75, s76
  s_lshr_b32 s76, s74, 1
  s_mul_i32 s76, s76, 3456
  s_and_b32 s77, s74, 1
  s_bitcmp1_b32 s2, 0
  s_movk_i32 s68, 896
  s_cselect_b32 s68, 512, s68
  s_cselect_b32 s69, 1920, 0
  s_mul_i32 s77, s77, s68
  s_add_u32 s76, s76, s77
  s_add_u32 s76, s76, s69
  s_waitcnt lgkmcnt(0)
  s_mov_b32 s64, s70
  s_mov_b32 s65, s71
  s_mov_b32 s66, 2359296
  s_mov_b32 s67, 0x20000
  buffer_load_dwordx4 v3, s[64:67], s75 offen lds
  s_add_u32 s75, s75, 131072
  buffer_load_dwordx4 v3, s[64:67], s75 offen lds
  s_add_u32 s75, s75, 131072
  buffer_load_dwordx4 v3, s[64:67], s75 offen lds
  s_add_u32 s75, s75, 131072
  buffer_load_dwordx4 v3, s[64:67], s75 offen lds
  s_add_u32 s75, s75, 131072
  buffer_load_dwordx4 v3, s[64:67], s75 offen lds
  s_add_u32 s75, s75, 131072
  s_mov_b32 s64, s72
  s_mov_b32 s65, s73
  s_mov_b32 s66, 1990656
  s_mov_b32 s67, 0x20000
  buffer_load_dwordx4 v3, s[64:67], s76 offen lds
  s_add_u32 s76, s76, 221184
  buffer_load_dwordx4 v3, s[64:67], s76 offen lds
  s_add_u32 s76, s76, 221184
  buffer_load_dwordx4 v3, s[64:67], s76 offen lds
  s_add_u32 s76, s76, 221184
  buffer_load_dwordx4 v3, s[64:67], s76 offen lds
  s_add_u32 s76, s76, 221184
  buffer_load_dwordx4 v3, s[64:67], s76 offen lds
  s_add_u32 s76, s76, 221184
  buffer_load_dwordx4 v3, s[64:67], s76 offen lds
  s_add_u32 s76, s76, 221184
  buffer_load_dwordx4 v3, s[64:67], s76 offen lds
  s_add_u32 s76, s76, 221184
  buffer_load_dwordx4 v3, s[64:67], s76 offen lds
  s_add_u32 s76, s76, 221184
  buffer_load_dwordx4 v3, s[64:67], s76 offen lds
  s_add_u32 s76, s76, 221184
  s_mul_i32 s23, s17, 384
  s_mov_b64 s[40:41], s[80:81]
  s_mov_b64 s[42:43], s[82:83]
  s_mov_b64 s[44:45], s[100:101]
  v_lshrrev_b32 v2, 2, v1
  s_mov_b32 s27, 3456
  v_mul_lo_u32 v11, v2, s27
  v_and_b32 v2, 3, v1
  v_lshlrev_b32 v2, 4, v2
  v_add_u32 v11, v11, v2
  v_add_u32 v11, s23, v11
  s_lshr_b32 s27, s3, 1
  s_mul_i32 s36, s27, 55296
  s_and_b32 s27, s3, 1
  s_mul_i32 s27, s27, 192
  s_add_u32 s36, s36, s27
  v_lshrrev_b32 v2, 2, v1
  v_mul_u32_u24 v12, 1152, v2
  v_bfe_u32 v2, v1, 4, 2
  v_and_b32 v3, 3, v1
  v_xor_b32 v2, v2, v3
  v_lshlrev_b32 v2, 4, v2
  v_add_u32 v12, v12, v2
  v_add_u32 v230, 18432, v12
  s_and_b32 s35, s2, 7
  s_lshl_b32 s35, s35, 1
  s_mul_i32 s28, s35, 110592
  s_add_u32 s28, s28, s36
  s_mul_i32 s29, s18, 36864
  s_mul_i32 s27, s35, 64
  s_add_u32 s29, s29, s27
  s_mov_b32 s48, 110592
  s_mov_b32 s49, 4293087232
  s_mov_b32 s50, 64
  s_mov_b32 s51, 4294966208
  s_mul_i32 s46, s3, 2048
  s_mul_i32 s47, s3, 3072
  s_add_u32 s47, s47, 8192
  s_waitcnt lgkmcnt(0)
  s_mov_b32 s4, s40
  s_mov_b32 s5, s41
  s_mov_b32 s6, 2359296
  s_mov_b32 s7, 0x20000
  s_mov_b32 s8, s42
  s_mov_b32 s9, s43
  s_mov_b32 s10, 1990656
  s_mov_b32 s11, 0x20000
  s_mov_b32 s33, 1990656
  s_mov_b32 s34, 2359296
  s_add_u32 s32, s46, 0
  s_add_u32 s31, s47, 0
  s_add_u32 m0, s32, 0
  s_nop 0
  buffer_load_dwordx4 v12, s[4:7], s29 offen offset:0 lds
  s_add_u32 m0, s32, 1024
  s_nop 0
  buffer_load_dwordx4 v230, s[4:7], s29 offen offset:0 lds
  s_add_u32 m0, s31, 0
  s_nop 0
  buffer_load_dwordx4 v11, s[8:11], s28 offen offset:0 lds
  s_add_u32 m0, s31, 960
  s_nop 0
  buffer_load_dwordx4 v11, s[8:11], s28 offen offset:64 lds
  s_add_u32 m0, s31, 1920
  s_nop 0
  buffer_load_dwordx4 v11, s[8:11], s28 offen offset:128 lds
  s_add_u32 s35, s35, 1
  s_cmp_eq_u32 s35, 18
  s_cselect_b32 s35, 0, s35
  s_cselect_b32 s27, s49, s48
  s_cselect_b32 s22, s51, s50
  s_add_u32 s28, s28, s27
  s_add_u32 s29, s29, s22
  s_add_u32 s32, s46, 20480
  s_add_u32 s31, s47, 20480
  s_add_u32 m0, s32, 0
  s_nop 0
  buffer_load_dwordx4 v12, s[4:7], s29 offen offset:0 lds
  s_add_u32 m0, s32, 1024
  s_nop 0
  buffer_load_dwordx4 v230, s[4:7], s29 offen offset:0 lds
  s_add_u32 m0, s31, 0
  s_nop 0
  buffer_load_dwordx4 v11, s[8:11], s28 offen offset:0 lds
  s_add_u32 m0, s31, 960
  s_nop 0
  buffer_load_dwordx4 v11, s[8:11], s28 offen offset:64 lds
  s_add_u32 m0, s31, 1920
  s_nop 0
  buffer_load_dwordx4 v11, s[8:11], s28 offen offset:128 lds
  s_add_u32 s35, s35, 1
  s_cmp_eq_u32 s35, 18
  s_cselect_b32 s35, 0, s35
  s_cselect_b32 s27, s49, s48
  s_cselect_b32 s22, s51, s50
  s_add_u32 s28, s28, s27
  s_add_u32 s29, s29, s22
  s_add_u32 s32, s46, 40960
  s_add_u32 s31, s47, 40960
  s_add_u32 m0, s32, 0
  s_nop 0
  buffer_load_dwordx4 v12, s[4:7], s29 offen offset:0 lds
  s_add_u32 m0, s32, 1024
  s_nop 0
  buffer_load_dwordx4 v230, s[4:7], s29 offen offset:0 lds
  s_add_u32 m0, s31, 0
  s_nop 0
  buffer_load_dwordx4 v11, s[8:11], s28 offen offset:0 lds
  s_add_u32 m0, s31, 960
  s_nop 0
  buffer_load_dwordx4 v11, s[8:11], s28 offen offset:64 lds
  s_add_u32 m0, s31, 1920
  s_nop 0
  buffer_load_dwordx4 v11, s[8:11], s28 offen offset:128 lds
  v_bfe_u32 v2, v1, 2, 2
  v_lshrrev_b32 v3, 5, v1
  v_lshlrev_b32 v3, 3, v3
  v_add_u32 v2, v2, v3
  v_lshlrev_b32 v7, 6, v2
  v_bfe_u32 v2, v1, 4, 1
  v_lshlrev_b32 v2, 5, v2
  v_add_u32 v7, v7, v2
  v_and_b32 v2, 3, v1
  v_lshlrev_b32 v2, 3, v2
  v_add_u32 v7, v7, v2
  v_add_u32 v7, 8192, v7
  v_and_b32 v2, 31, v1
  v_lshlrev_b32 v10, 6, v2
  v_bfe_u32 v2, v1, 2, 2
  v_lshrrev_b32 v3, 5, v1
  v_xor_b32 v2, v2, v3
  v_lshlrev_b32 v2, 4, v2
  v_add_u32 v10, v10, v2
  s_mul_i32 s27, s3, 2048
  v_add_u32 v10, s27, v10
  v_mov_b32 v16, 0
  v_mov_b32 v17, 0
  v_mov_b32 v18, 0
  v_mov_b32 v19, 0
  v_mov_b32 v20, 0
  v_mov_b32 v21, 0
  v_mov_b32 v22, 0
  v_mov_b32 v23, 0
  v_mov_b32 v24, 0
  v_mov_b32 v25, 0
  v_mov_b32 v26, 0
  v_mov_b32 v27, 0
  v_mov_b32 v28, 0
  v_mov_b32 v29, 0
  v_mov_b32 v30, 0
  v_mov_b32 v31, 0
  v_mov_b32 v32, 0
  v_mov_b32 v33, 0
  v_mov_b32 v34, 0
  v_mov_b32 v35, 0
  v_mov_b32 v36, 0
  v_mov_b32 v37, 0
  v_mov_b32 v38, 0
  v_mov_b32 v39, 0
  v_mov_b32 v40, 0
  v_mov_b32 v41, 0
  v_mov_b32 v42, 0
  v_mov_b32 v43, 0
  v_mov_b32 v44, 0
  v_mov_b32 v45, 0
  v_mov_b32 v46, 0
  v_mov_b32 v47, 0
  v_mov_b32 v48, 0
  v_mov_b32 v49, 0
  v_mov_b32 v50, 0
  v_mov_b32 v51, 0
  v_mov_b32 v52, 0
  v_mov_b32 v53, 0
  v_mov_b32 v54, 0
  v_mov_b32 v55, 0
  v_mov_b32 v56, 0
  v_mov_b32 v57, 0
  v_mov_b32 v58, 0
  v_mov_b32 v59, 0
  v_mov_b32 v60, 0
  v_mov_b32 v61, 0
  v_mov_b32 v62, 0
  v_mov_b32 v63, 0
  v_mov_b32 v64, 0
  v_mov_b32 v65, 0
  v_mov_b32 v66, 0
  v_mov_b32 v67, 0
  v_mov_b32 v68, 0
  v_mov_b32 v69, 0
  v_mov_b32 v70, 0
  v_mov_b32 v71, 0
  v_mov_b32 v72, 0
  v_mov_b32 v73, 0
  v_mov_b32 v74, 0
  v_mov_b32 v75, 0
  v_mov_b32 v76, 0
  v_mov_b32 v77, 0
  v_mov_b32 v78, 0
  v_mov_b32 v79, 0
  v_mov_b32 v80, 0
  v_mov_b32 v81, 0
  v_mov_b32 v82, 0
  v_mov_b32 v83, 0
  v_mov_b32 v84, 0
  v_mov_b32 v85, 0
  v_mov_b32 v86, 0
  v_mov_b32 v87, 0
  v_mov_b32 v88, 0
  v_mov_b32 v89, 0
  v_mov_b32 v90, 0
  v_mov_b32 v91, 0
  v_mov_b32 v92, 0
  v_mov_b32 v93, 0
  v_mov_b32 v94, 0
  v_mov_b32 v95, 0
  v_mov_b32 v96, 0
  v_mov_b32 v97, 0
  v_mov_b32 v98, 0
  v_mov_b32 v99, 0
  v_mov_b32 v100, 0
  v_mov_b32 v101, 0
  v_mov_b32 v102, 0
  v_mov_b32 v103, 0
  v_mov_b32 v104, 0
  v_mov_b32 v105, 0
  v_mov_b32 v106, 0
  v_mov_b32 v107, 0
  v_mov_b32 v108, 0
  v_mov_b32 v109, 0
  v_mov_b32 v110, 0
  v_mov_b32 v111, 0
  s_cmp_lt_u32 s17, 6
  s_cbranch_scc0 L_k1_v
  s_mov_b32 s12, s44
  s_mov_b32 s13, s45
  s_mov_b32 s14, 4718592
  s_mov_b32 s15, 0x20000
  s_mul_i32 s23, s18, 73728
  s_mul_i32 s27, s17, 12288
  s_add_u32 s23, s23, s27
  s_cmp_lt_u32 s17, 3
  s_cselect_b32 s26, 0x3eae1a93, 1.0
  v_and_b32 v2, 31, v1
  v_lshlrev_b32 v13, 2, v2
  v_lshrrev_b32 v2, 5, v1
  v_lshlrev_b32 v2, 8, v2
  v_add_u32 v13, v13, v2
  s_waitcnt vmcnt(10)
  s_barrier
  v_mov_b32 v5, v7
  v_add_u32 v6, 20480, v7
  v_mov_b32 v8, v10
  v_xor_b32 v9, 32, v10
  ds_read_b128 v[136:139], v8 offset:0
  ds_read_b128 v[140:143], v9 offset:0
  ds_read_b64_tr_b16 v[112:113], v5 offset:0
  ds_read_b64_tr_b16 v[114:115], v5 offset:256
  ds_read_b64_tr_b16 v[116:117], v5 offset:1024
  ds_read_b64_tr_b16 v[118:119], v5 offset:1280
  ds_read_b64_tr_b16 v[120:121], v5 offset:2048
  ds_read_b64_tr_b16 v[122:123], v5 offset:2304
  ds_read_b64_tr_b16 v[124:125], v5 offset:3072
  ds_read_b64_tr_b16 v[126:127], v5 offset:3328
  ds_read_b64_tr_b16 v[128:129], v5 offset:4096
  ds_read_b64_tr_b16 v[130:131], v5 offset:4352
  ds_read_b64_tr_b16 v[132:133], v5 offset:5120
  ds_read_b64_tr_b16 v[134:135], v5 offset:5376
  v_add_u32 v8, 20480, v10
  v_xor_b32 v9, 32, v8
  s_mov_b32 s20, 20480
  s_mov_b32 s21, 61440
  s_mov_b32 s19, 0
L_qk_loop:
  s_waitcnt lgkmcnt(10)
  v_mfma_f32_32x32x16_bf16 v[16:31], v[112:115], v[136:139], v[16:31]
  ds_read_b64_tr_b16 v[112:113], v5 offset:6144
  ds_read_b64_tr_b16 v[114:115], v5 offset:6400
  s_add_u32 s35, s35, 1
  s_cmp_eq_u32 s35, 18
  s_cselect_b32 s35, 0, s35
  s_cselect_b32 s27, s49, s48
  s_cselect_b32 s22, s51, s50
  v_add_u32 v6, s20, v7
  s_waitcnt lgkmcnt(10)
  v_mfma_f32_32x32x16_bf16 v[32:47], v[116:119], v[136:139], v[32:47]
  ds_read_b64_tr_b16 v[116:117], v5 offset:7168
  ds_read_b64_tr_b16 v[118:119], v5 offset:7424
  s_add_u32 s28, s28, s27
  v_xor_b32 v9, 32, v8
  s_waitcnt lgkmcnt(10)
  v_mfma_f32_32x32x16_bf16 v[48:63], v[120:123], v[136:139], v[48:63]
  ds_read_b64_tr_b16 v[120:121], v5 offset:8192
  ds_read_b64_tr_b16 v[122:123], v5 offset:8448
  s_add_u32 s29, s29, s22
  s_add_u32 s32, s46, s21
  s_waitcnt lgkmcnt(10)
  v_mfma_f32_32x32x16_bf16 v[64:79], v[124:127], v[136:139], v[64:79]
  ds_read_b64_tr_b16 v[124:125], v5 offset:9216
  ds_read_b64_tr_b16 v[126:127], v5 offset:9472
  s_add_u32 s31, s47, s21
  s_waitcnt lgkmcnt(10)
  v_mfma_f32_32x32x16_bf16 v[80:95], v[128:131], v[136:139], v[80:95]
  ds_read_b64_tr_b16 v[128:129], v5 offset:10240
  ds_read_b64_tr_b16 v[130:131], v5 offset:10496
  s_cmp_lt_u32 s19, 15
  s_cselect_b32 s10, s33, 0
  s_cselect_b32 s6, s34, 0
  s_waitcnt vmcnt(5)
  s_barrier
  s_waitcnt lgkmcnt(10)
  v_mfma_f32_32x32x16_bf16 v[96:111], v[132:135], v[136:139], v[96:111]
  s_add_u32 m0, s32, 0
  ds_read_b64_tr_b16 v[132:133], v5 offset:11264
  buffer_load_dwordx4 v12, s[4:7], s29 offen offset:0 lds
  ds_read_b64_tr_b16 v[134:135], v5 offset:11520
  ds_read_b128 v[136:139], v8 offset:0
  s_waitcnt lgkmcnt(11)
  v_mfma_f32_32x32x16_bf16 v[16:31], v[112:115], v[140:143], v[16:31]
  s_add_u32 m0, s32, 1024
  ds_read_b64_tr_b16 v[112:113], v6 offset:0
  buffer_load_dwordx4 v230, s[4:7], s29 offen offset:0 lds
  ds_read_b64_tr_b16 v[114:115], v6 offset:256
  v_mov_b32 v5, v6
  s_add_u32 s20, s20, 20480
  s_waitcnt lgkmcnt(11)
  v_mfma_f32_32x32x16_bf16 v[32:47], v[116:119], v[140:143], v[32:47]
  s_add_u32 m0, s31, 0
  ds_read_b64_tr_b16 v[116:117], v6 offset:1024
  buffer_load_dwordx4 v11, s[8:11], s28 offen offset:0 lds
  ds_read_b64_tr_b16 v[118:119], v6 offset:1280
  s_add_u32 s21, s21, 20480
  s_cmp_eq_u32 s20, 163840
  s_cselect_b32 s20, 0, s20
  s_waitcnt lgkmcnt(11)
  v_mfma_f32_32x32x16_bf16 v[48:63], v[120:123], v[140:143], v[48:63]
  ds_read_b64_tr_b16 v[120:121], v6 offset:2048
  ds_read_b64_tr_b16 v[122:123], v6 offset:2304
  s_cmp_eq_u32 s21, 163840
  s_cselect_b32 s21, 0, s21
  s_waitcnt lgkmcnt(11)
  v_mfma_f32_32x32x16_bf16 v[64:79], v[124:127], v[140:143], v[64:79]
  s_add_u32 m0, s31, 960
  ds_read_b64_tr_b16 v[124:125], v6 offset:3072
  buffer_load_dwordx4 v11, s[8:11], s28 offen offset:64 lds
  ds_read_b64_tr_b16 v[126:127], v6 offset:3328
  v_add_u32 v8, s20, v10
  s_waitcnt lgkmcnt(11)
  v_mfma_f32_32x32x16_bf16 v[80:95], v[128:131], v[140:143], v[80:95]
  s_add_u32 m0, s31, 1920
  ds_read_b64_tr_b16 v[128:129], v6 offset:4096
  buffer_load_dwordx4 v11, s[8:11], s28 offen offset:128 lds
  ds_read_b64_tr_b16 v[130:131], v6 offset:4352
  s_add_u32 s19, s19, 1
  s_waitcnt lgkmcnt(11)
  v_mfma_f32_32x32x16_bf16 v[96:111], v[132:135], v[140:143], v[96:111]
  ds_read_b64_tr_b16 v[132:133], v6 offset:5120
  ds_read_b64_tr_b16 v[134:135], v6 offset:5376
  ds_read_b128 v[140:143], v9 offset:0
  s_cmp_lt_u32 s19, 18
  s_cbranch_scc1 L_qk_loop
  s_waitcnt vmcnt(0)
  s_barrier
  s_mul_i32 s27, s3, 12288
  v_add_u32 v13, s27, v13
  v_lshlrev_b32 v2, 4, v1
  v_add_u32 v3, s27, v2
  v_mul_f32 v16, s26, v16
  v_mul_f32 v17, s26, v17
  v_mul_f32 v18, s26, v18
  v_mul_f32 v19, s26, v19
  v_mul_f32 v20, s26, v20
  v_mul_f32 v21, s26, v21
  v_mul_f32 v22, s26, v22
  v_mul_f32 v23, s26, v23
  v_mul_f32 v24, s26, v24
  v_mul_f32 v25, s26, v25
  v_mul_f32 v26, s26, v26
  v_mul_f32 v27, s26, v27
  v_mul_f32 v28, s26, v28
  v_mul_f32 v29, s26, v29
  v_mul_f32 v30, s26, v30
  v_mul_f32 v31, s26, v31
  v_cvt_pk_bf16_f32 v16, v16, v17
  v_cvt_pk_bf16_f32 v17, v18, v19
  v_cvt_pk_bf16_f32 v18, v20, v21
  v_cvt_pk_bf16_f32 v19, v22, v23
  v_cvt_pk_bf16_f32 v20, v24, v25
  v_cvt_pk_bf16_f32 v21, v26, v27
  v_cvt_pk_bf16_f32 v22, v28, v29
  v_cvt_pk_bf16_f32 v23, v30, v31
  ds_write_b32 v13, v16 offset:0
  ds_write_b32 v13, v17 offset:128
  ds_write_b32 v13, v18 offset:512
  ds_write_b32 v13, v19 offset:640
  ds_write_b32 v13, v20 offset:1024
  ds_write_b32 v13, v21 offset:1152
  ds_write_b32 v13, v22 offset:1536
  ds_write_b32 v13, v23 offset:1664
  v_mul_f32 v32, s26, v32
  v_mul_f32 v33, s26, v33
  v_mul_f32 v34, s26, v34
  v_mul_f32 v35, s26, v35
  v_mul_f32 v36, s26, v36
  v_mul_f32 v37, s26, v37
  v_mul_f32 v38, s26, v38
  v_mul_f32 v39, s26, v39
  v_mul_f32 v40, s26, v40
  v_mul_f32 v41, s26, v41
  v_mul_f32 v42, s26, v42
  v_mul_f32 v43, s26, v43
  v_mul_f32 v44, s26, v44
  v_mul_f32 v45, s26, v45
  v_mul_f32 v46, s26, v46
  v_mul_f32 v47, s26, v47
  v_cvt_pk_bf16_f32 v32, v32, v33
  v_cvt_pk_bf16_f32 v33, v34, v35
  v_cvt_pk_bf16_f32 v34, v36, v37
  v_cvt_pk_bf16_f32 v35, v38, v39
  v_cvt_pk_bf16_f32 v36, v40, v41
  v_cvt_pk_bf16_f32 v37, v42, v43
  v_cvt_pk_bf16_f32 v38, v44, v45
  v_cvt_pk_bf16_f32 v39, v46, v47
  ds_write_b32 v13, v32 offset:2048
  ds_write_b32 v13, v33 offset:2176
  ds_write_b32 v13, v34 offset:2560
  ds_write_b32 v13, v35 offset:2688
  ds_write_b32 v13, v36 offset:3072
  ds_write_b32 v13, v37 offset:3200
  ds_write_b32 v13, v38 offset:3584
  ds_write_b32 v13, v39 offset:3712
  ds_read_b128 v[24:27], v3 offset:0
  ds_read_b128 v[28:31], v3 offset:1024
  v_mul_f32 v48, s26, v48
  v_mul_f32 v49, s26, v49
  v_mul_f32 v50, s26, v50
  v_mul_f32 v51, s26, v51
  v_mul_f32 v52, s26, v52
  v_mul_f32 v53, s26, v53
  v_mul_f32 v54, s26, v54
  v_mul_f32 v55, s26, v55
  v_mul_f32 v56, s26, v56
  v_mul_f32 v57, s26, v57
  v_mul_f32 v58, s26, v58
  v_mul_f32 v59, s26, v59
  v_mul_f32 v60, s26, v60
  v_mul_f32 v61, s26, v61
  v_mul_f32 v62, s26, v62
  v_mul_f32 v63, s26, v63
  v_cvt_pk_bf16_f32 v48, v48, v49
  v_cvt_pk_bf16_f32 v49, v50, v51
  v_cvt_pk_bf16_f32 v50, v52, v53
  v_cvt_pk_bf16_f32 v51, v54, v55
  v_cvt_pk_bf16_f32 v52, v56, v57
  v_cvt_pk_bf16_f32 v53, v58, v59
  v_cvt_pk_bf16_f32 v54, v60, v61
  v_cvt_pk_bf16_f32 v55, v62, v63
  ds_write_b32 v13, v48 offset:4096
  ds_write_b32 v13, v49 offset:4224
  ds_write_b32 v13, v50 offset:4608
  ds_write_b32 v13, v51 offset:4736
  ds_write_b32 v13, v52 offset:5120
  ds_write_b32 v13, v53 offset:5248
  ds_write_b32 v13, v54 offset:5632
  ds_write_b32 v13, v55 offset:5760
  ds_read_b128 v[40:43], v3 offset:2048
  ds_read_b128 v[44:47], v3 offset:3072
  s_waitcnt lgkmcnt(11)
  buffer_store_dwordx4 v[24:27], v2, s[12:15], s23 offen offset:0 sc1
  s_waitcnt lgkmcnt(10)
  buffer_store_dwordx4 v[28:31], v2, s[12:15], s23 offen offset:1024 sc1
  v_mul_f32 v64, s26, v64
  v_mul_f32 v65, s26, v65
  v_mul_f32 v66, s26, v66
  v_mul_f32 v67, s26, v67
  v_mul_f32 v68, s26, v68
  v_mul_f32 v69, s26, v69
  v_mul_f32 v70, s26, v70
  v_mul_f32 v71, s26, v71
  v_mul_f32 v72, s26, v72
  v_mul_f32 v73, s26, v73
  v_mul_f32 v74, s26, v74
  v_mul_f32 v75, s26, v75
  v_mul_f32 v76, s26, v76
  v_mul_f32 v77, s26, v77
  v_mul_f32 v78, s26, v78
  v_mul_f32 v79, s26, v79
  v_cvt_pk_bf16_f32 v64, v64, v65
  v_cvt_pk_bf16_f32 v65, v66, v67
  v_cvt_pk_bf16_f32 v66, v68, v69
  v_cvt_pk_bf16_f32 v67, v70, v71
  v_cvt_pk_bf16_f32 v68, v72, v73
  v_cvt_pk_bf16_f32 v69, v74, v75
  v_cvt_pk_bf16_f32 v70, v76, v77
  v_cvt_pk_bf16_f32 v71, v78, v79
  ds_write_b32 v13, v64 offset:6144
  ds_write_b32 v13, v65 offset:6272
  ds_write_b32 v13, v66 offset:6656
  ds_write_b32 v13, v67 offset:6784
  ds_write_b32 v13, v68 offset:7168
  ds_write_b32 v13, v69 offset:7296
  ds_write_b32 v13, v70 offset:7680
  ds_write_b32 v13, v71 offset:7808
  ds_read_b128 v[56:59], v3 offset:4096
  ds_read_b128 v[60:63], v3 offset:5120
  s_waitcnt lgkmcnt(11)
  buffer_store_dwordx4 v[40:43], v2, s[12:15], s23 offen offset:2048 sc1
  s_waitcnt lgkmcnt(10)
  buffer_store_dwordx4 v[44:47], v2, s[12:15], s23 offen offset:3072 sc1
  s_add_u32 s23, s23, 4096
  v_mul_f32 v80, s26, v80
  v_mul_f32 v81, s26, v81
  v_mul_f32 v82, s26, v82
  v_mul_f32 v83, s26, v83
  v_mul_f32 v84, s26, v84
  v_mul_f32 v85, s26, v85
  v_mul_f32 v86, s26, v86
  v_mul_f32 v87, s26, v87
  v_mul_f32 v88, s26, v88
  v_mul_f32 v89, s26, v89
  v_mul_f32 v90, s26, v90
  v_mul_f32 v91, s26, v91
  v_mul_f32 v92, s26, v92
  v_mul_f32 v93, s26, v93
  v_mul_f32 v94, s26, v94
  v_mul_f32 v95, s26, v95
  v_cvt_pk_bf16_f32 v80, v80, v81
  v_cvt_pk_bf16_f32 v81, v82, v83
  v_cvt_pk_bf16_f32 v82, v84, v85
  v_cvt_pk_bf16_f32 v83, v86, v87
  v_cvt_pk_bf16_f32 v84, v88, v89
  v_cvt_pk_bf16_f32 v85, v90, v91
  v_cvt_pk_bf16_f32 v86, v92, v93
  v_cvt_pk_bf16_f32 v87, v94, v95
  ds_write_b32 v13, v80 offset:8192
  ds_write_b32 v13, v81 offset:8320
  ds_write_b32 v13, v82 offset:8704
  ds_write_b32 v13, v83 offset:8832
  ds_write_b32 v13, v84 offset:9216
  ds_write_b32 v13, v85 offset:9344
  ds_write_b32 v13, v86 offset:9728
  ds_write_b32 v13, v87 offset:9856
  ds_read_b128 v[72:75], v3 offset:6144
  ds_read_b128 v[76:79], v3 offset:7168
  s_waitcnt lgkmcnt(11)
  buffer_store_dwordx4 v[56:59], v2, s[12:15], s23 offen offset:0 sc1
  s_waitcnt lgkmcnt(10)
  buffer_store_dwordx4 v[60:63], v2, s[12:15], s23 offen offset:1024 sc1
  v_mul_f32 v96, s26, v96
  v_mul_f32 v97, s26, v97
  v_mul_f32 v98, s26, v98
  v_mul_f32 v99, s26, v99
  v_mul_f32 v100, s26, v100
  v_mul_f32 v101, s26, v101
  v_mul_f32 v102, s26, v102
  v_mul_f32 v103, s26, v103
  v_mul_f32 v104, s26, v104
  v_mul_f32 v105, s26, v105
  v_mul_f32 v106, s26, v106
  v_mul_f32 v107, s26, v107
  v_mul_f32 v108, s26, v108
  v_mul_f32 v109, s26, v109
  v_mul_f32 v110, s26, v110
  v_mul_f32 v111, s26, v111
  v_cvt_pk_bf16_f32 v96, v96, v97
  v_cvt_pk_bf16_f32 v97, v98, v99
  v_cvt_pk_bf16_f32 v98, v100, v101
  v_cvt_pk_bf16_f32 v99, v102, v103
  v_cvt_pk_bf16_f32 v100, v104, v105
  v_cvt_pk_bf16_f32 v101, v106, v107
  v_cvt_pk_bf16_f32 v102, v108, v109
  v_cvt_pk_bf16_f32 v103, v110, v111
  ds_write_b32 v13, v96 offset:10240
  ds_write_b32 v13, v97 offset:10368
  ds_write_b32 v13, v98 offset:10752
  ds_write_b32 v13, v99 offset:10880
  ds_write_b32 v13, v100 offset:11264
  ds_write_b32 v13, v101 offset:11392
  ds_write_b32 v13, v102 offset:11776
  ds_write_b32 v13, v103 offset:11904
  ds_read_b128 v[88:91], v3 offset:8192
  ds_read_b128 v[92:95], v3 offset:9216
  s_waitcnt lgkmcnt(11)
  buffer_store_dwordx4 v[72:75], v2, s[12:15], s23 offen offset:2048 sc1
  s_waitcnt lgkmcnt(10)
  buffer_store_dwordx4 v[76:79], v2, s[12:15], s23 offen offset:3072 sc1
  s_add_u32 s23, s23, 4096
  ds_read_b128 v[104:107], v3 offset:10240
  ds_read_b128 v[108:111], v3 offset:11264
  s_waitcnt lgkmcnt(3)
  buffer_store_dwordx4 v[88:91], v2, s[12:15], s23 offen offset:0 sc1
  s_waitcnt lgkmcnt(2)
  buffer_store_dwordx4 v[92:95], v2, s[12:15], s23 offen offset:1024 sc1
  s_waitcnt lgkmcnt(1)
  buffer_store_dwordx4 v[104:107], v2, s[12:15], s23 offen offset:2048 sc1
  s_waitcnt lgkmcnt(0)
  buffer_store_dwordx4 v[108:111], v2, s[12:15], s23 offen offset:3072 sc1
  s_add_u32 s23, s23, 4096
  s_branch L_k1_end
L_k1_v:
  s_add_u32 s12, s44, 4718592
  s_addc_u32 s13, s45, 0
  s_mov_b32 s14, 2359296
  s_mov_b32 s15, 0x20000
  s_mul_i32 s23, s18, 36864
  s_sub_u32 s27, s17, 6
  s_mul_i32 s27, s27, 3072
  s_add_u32 s23, s23, s27
  s_add_u32 s24, s23, 18432
  v_and_b32 v2, 31, v1
  v_lshlrev_b32 v13, 4, v2
  v_lshrrev_b32 v2, 5, v1
  v_mul_u32_u24 v2, 9216, v2
  v_add_u32 v13, v13, v2
  s_waitcnt vmcnt(10)
  s_barrier
  v_mov_b32 v5, v7
  v_add_u32 v6, 20480, v7
  v_mov_b32 v8, v10
  v_xor_b32 v9, 32, v10
  ds_read_b128 v[136:139], v8 offset:0
  ds_read_b128 v[140:143], v9 offset:0
  ds_read_b64_tr_b16 v[112:113], v5 offset:0
  ds_read_b64_tr_b16 v[114:115], v5 offset:256
  ds_read_b64_tr_b16 v[116:117], v5 offset:1024
  ds_read_b64_tr_b16 v[118:119], v5 offset:1280
  ds_read_b64_tr_b16 v[120:121], v5 offset:2048
  ds_read_b64_tr_b16 v[122:123], v5 offset:2304
  ds_read_b64_tr_b16 v[124:125], v5 offset:3072
  ds_read_b64_tr_b16 v[126:127], v5 offset:3328
  ds_read_b64_tr_b16 v[128:129], v5 offset:4096
  ds_read_b64_tr_b16 v[130:131], v5 offset:4352
  ds_read_b64_tr_b16 v[132:133], v5 offset:5120
  ds_read_b64_tr_b16 v[134:135], v5 offset:5376
  v_add_u32 v8, 20480, v10
  v_xor_b32 v9, 32, v8
  s_mov_b32 s20, 20480
  s_mov_b32 s21, 61440
  s_mov_b32 s19, 0
L_v_loop:
  s_waitcnt lgkmcnt(10)
  v_mfma_f32_32x32x16_bf16 v[16:31], v[136:139], v[112:115], v[16:31]
  ds_read_b64_tr_b16 v[112:113], v5 offset:6144
  ds_read_b64_tr_b16 v[114:115], v5 offset:6400
  s_add_u32 s35, s35, 1
  s_cmp_eq_u32 s35, 18
  s_cselect_b32 s35, 0, s35
  s_cselect_b32 s27, s49, s48
  s_cselect_b32 s22, s51, s50
  v_add_u32 v6, s20, v7
  s_waitcnt lgkmcnt(10)
  v_mfma_f32_32x32x16_bf16 v[32:47], v[136:139], v[116:119], v[32:47]
  ds_read_b64_tr_b16 v[116:117], v5 offset:7168
  ds_read_b64_tr_b16 v[118:119], v5 offset:7424
  s_add_u32 s28, s28, s27
  v_xor_b32 v9, 32, v8
  s_waitcnt lgkmcnt(10)
  v_mfma_f32_32x32x16_bf16 v[48:63], v[136:139], v[120:123], v[48:63]
  ds_read_b64_tr_b16 v[120:121], v5 offset:8192
  ds_read_b64_tr_b16 v[122:123], v5 offset:8448
  s_add_u32 s29, s29, s22
  s_add_u32 s32, s46, s21
  s_waitcnt lgkmcnt(10)
  v_mfma_f32_32x32x16_bf16 v[64:79], v[136:139], v[124:127], v[64:79]
  ds_read_b64_tr_b16 v[124:125], v5 offset:9216
  ds_read_b64_tr_b16 v[126:127], v5 offset:9472
  s_add_u32 s31, s47, s21
  s_waitcnt lgkmcnt(10)
  v_mfma_f32_32x32x16_bf16 v[80:95], v[136:139], v[128:131], v[80:95]
  ds_read_b64_tr_b16 v[128:129], v5 offset:10240
  ds_read_b64_tr_b16 v[130:131], v5 offset:10496
  s_cmp_lt_u32 s19, 15
  s_cselect_b32 s10, s33, 0
  s_cselect_b32 s6, s34, 0
  s_waitcnt vmcnt(5)
  s_barrier
  s_waitcnt lgkmcnt(10)
  v_mfma_f32_32x32x16_bf16 v[96:111], v[136:139], v[132:135], v[96:111]
  s_add_u32 m0, s32, 0
  ds_read_b64_tr_b16 v[132:133], v5 offset:11264
  buffer_load_dwordx4 v12, s[4:7], s29 offen offset:0 lds
  ds_read_b64_tr_b16 v[134:135], v5 offset:11520
  ds_read_b128 v[136:139], v8 offset:0
  s_waitcnt lgkmcnt(11)
  v_mfma_f32_32x32x16_bf16 v[16:31], v[140:143], v[112:115], v[16:31]
  s_add_u32 m0, s32, 1024
  ds_read_b64_tr_b16 v[112:113], v6 offset:0
  buffer_load_dwordx4 v230, s[4:7], s29 offen offset:0 lds
  ds_read_b64_tr_b16 v[114:115], v6 offset:256
  v_mov_b32 v5, v6
  s_add_u32 s20, s20, 20480
  s_waitcnt lgkmcnt(11)
  v_mfma_f32_32x32x16_bf16 v[32:47], v[140:143], v[116:119], v[32:47]
  s_add_u32 m0, s31, 0
  ds_read_b64_tr_b16 v[116:117], v6 offset:1024
  buffer_load_dwordx4 v11, s[8:11], s28 offen offset:0 lds
  ds_read_b64_tr_b16 v[118:119], v6 offset:1280
  s_add_u32 s21, s21, 20480
  s_cmp_eq_u32 s20, 163840
  s_cselect_b32 s20, 0, s20
  s_waitcnt lgkmcnt(11)
  v_mfma_f32_32x32x16_bf16 v[48:63], v[140:143], v[120:123], v[48:63]
  ds_read_b64_tr_b16 v[120:121], v6 offset:2048
  ds_read_b64_tr_b16 v[122:123], v6 offset:2304
  s_cmp_eq_u32 s21, 163840
  s_cselect_b32 s21, 0, s21
  s_waitcnt lgkmcnt(11)
  v_mfma_f32_32x32x16_bf16 v[64:79], v[140:143], v[124:127], v[64:79]
  s_add_u32 m0, s31, 960
  ds_read_b64_tr_b16 v[124:125], v6 offset:3072
  buffer_load_dwordx4 v11, s[8:11], s28 offen offset:64 lds
  ds_read_b64_tr_b16 v[126:127], v6 offset:3328
  v_add_u32 v8, s20, v10
  s_waitcnt lgkmcnt(11)
  v_mfma_f32_32x32x16_bf16 v[80:95], v[140:143], v[128:131], v[80:95]
  s_add_u32 m0, s31, 1920
  ds_read_b64_tr_b16 v[128:129], v6 offset:4096
  buffer_load_dwordx4 v11, s[8:11], s28 offen offset:128 lds
  ds_read_b64_tr_b16 v[130:131], v6 offset:4352
  s_add_u32 s19, s19, 1
  s_waitcnt lgkmcnt(11)
  v_mfma_f32_32x32x16_bf16 v[96:111], v[140:143], v[132:135], v[96:111]
  ds_read_b64_tr_b16 v[132:133], v6 offset:5120
  ds_read_b64_tr_b16 v[134:135], v6 offset:5376
  ds_read_b128 v[140:143], v9 offset:0
  s_cmp_lt_u32 s19, 18
  s_cbranch_scc1 L_v_loop
  v_cvt_pk_bf16_f32 v16, v16, v17
  v_cvt_pk_bf16_f32 v17, v18, v19
  v_cvt_pk_bf16_f32 v18, v20, v21
  v_cvt_pk_bf16_f32 v19, v22, v23
  v_cvt_pk_bf16_f32 v20, v24, v25
  v_cvt_pk_bf16_f32 v21, v26, v27
  v_cvt_pk_bf16_f32 v22, v28, v29
  v_cvt_pk_bf16_f32 v23, v30, v31
  buffer_store_dwordx4 v[16:19], v13, s[12:15], s23 offen offset:0 sc1
  buffer_store_dwordx4 v[20:23], v13, s[12:15], s24 offen offset:0 sc1
  v_cvt_pk_bf16_f32 v32, v32, v33
  v_cvt_pk_bf16_f32 v33, v34, v35
  v_cvt_pk_bf16_f32 v34, v36, v37
  v_cvt_pk_bf16_f32 v35, v38, v39
  v_cvt_pk_bf16_f32 v36, v40, v41
  v_cvt_pk_bf16_f32 v37, v42, v43
  v_cvt_pk_bf16_f32 v38, v44, v45
  v_cvt_pk_bf16_f32 v39, v46, v47
  buffer_store_dwordx4 v[32:35], v13, s[12:15], s23 offen offset:512 sc1
  buffer_store_dwordx4 v[36:39], v13, s[12:15], s24 offen offset:512 sc1
  v_cvt_pk_bf16_f32 v48, v48, v49
  v_cvt_pk_bf16_f32 v49, v50, v51
  v_cvt_pk_bf16_f32 v50, v52, v53
  v_cvt_pk_bf16_f32 v51, v54, v55
  v_cvt_pk_bf16_f32 v52, v56, v57
  v_cvt_pk_bf16_f32 v53, v58, v59
  v_cvt_pk_bf16_f32 v54, v60, v61
  v_cvt_pk_bf16_f32 v55, v62, v63
  buffer_store_dwordx4 v[48:51], v13, s[12:15], s23 offen offset:1024 sc1
  buffer_store_dwordx4 v[52:55], v13, s[12:15], s24 offen offset:1024 sc1
  v_cvt_pk_bf16_f32 v64, v64, v65
  v_cvt_pk_bf16_f32 v65, v66, v67
  v_cvt_pk_bf16_f32 v66, v68, v69
  v_cvt_pk_bf16_f32 v67, v70, v71
  v_cvt_pk_bf16_f32 v68, v72, v73
  v_cvt_pk_bf16_f32 v69, v74, v75
  v_cvt_pk_bf16_f32 v70, v76, v77
  v_cvt_pk_bf16_f32 v71, v78, v79
  buffer_store_dwordx4 v[64:67], v13, s[12:15], s23 offen offset:1536 sc1
  buffer_store_dwordx4 v[68:71], v13, s[12:15], s24 offen offset:1536 sc1
  v_cvt_pk_bf16_f32 v80, v80, v81
  v_cvt_pk_bf16_f32 v81, v82, v83
  v_cvt_pk_bf16_f32 v82, v84, v85
  v_cvt_pk_bf16_f32 v83, v86, v87
  v_cvt_pk_bf16_f32 v84, v88, v89
  v_cvt_pk_bf16_f32 v85, v90, v91
  v_cvt_pk_bf16_f32 v86, v92, v93
  v_cvt_pk_bf16_f32 v87, v94, v95
  buffer_store_dwordx4 v[80:83], v13, s[12:15], s23 offen offset:2048 sc1
  buffer_store_dwordx4 v[84:87], v13, s[12:15], s24 offen offset:2048 sc1
  v_cvt_pk_bf16_f32 v96, v96, v97
  v_cvt_pk_bf16_f32 v97, v98, v99
  v_cvt_pk_bf16_f32 v98, v100, v101
  v_cvt_pk_bf16_f32 v99, v102, v103
  v_cvt_pk_bf16_f32 v100, v104, v105
  v_cvt_pk_bf16_f32 v101, v106, v107
  v_cvt_pk_bf16_f32 v102, v108, v109
  v_cvt_pk_bf16_f32 v103, v110, v111
  buffer_store_dwordx4 v[96:99], v13, s[12:15], s23 offen offset:2560 sc1
  buffer_store_dwordx4 v[100:103], v13, s[12:15], s24 offen offset:2560 sc1
  s_branch L_k1_end
L_k1_b1:
  s_mul_i32 s23, s17, 192
  s_mov_b64 s[40:41], s[80:81]
  s_mov_b64 s[42:43], s[88:89]
  s_mov_b64 s[44:45], s[100:101]
  v_lshrrev_b32 v2, 2, v1
  s_mov_b32 s27, 1152
  v_mul_lo_u32 v11, v2, s27
  v_and_b32 v2, 3, v1
  v_lshlrev_b32 v2, 4, v2
  v_add_u32 v11, v11, v2
  v_add_u32 v11, s23, v11
  s_mul_i32 s36, s3, 18432
  v_lshrrev_b32 v2, 2, v1
  v_mul_u32_u24 v12, 1152, v2
  v_bfe_u32 v2, v1, 4, 2
  v_and_b32 v3, 3, v1
  v_xor_b32 v2, v2, v3
  v_lshlrev_b32 v2, 4, v2
  v_add_u32 v12, v12, v2
  v_add_u32 v230, 18432, v12
  s_and_b32 s35, s2, 7
  s_mul_i32 s28, s35, 73728
  s_add_u32 s28, s28, s36
  s_mul_i32 s29, s18, 36864
  s_mul_i32 s27, s35, 128
  s_add_u32 s29, s29, s27
  s_mov_b32 s48, 73728
  s_mov_b32 s49, 4294377472
  s_mov_b32 s50, 128
  s_mov_b32 s51, 4294966272
  s_mul_i32 s46, s3, 4096
  s_mul_i32 s47, s3, 3072
  s_add_u32 s47, s47, 16384
  s_waitcnt lgkmcnt(0)
  s_mov_b32 s4, s40
  s_mov_b32 s5, s41
  s_mov_b32 s6, 2359296
  s_mov_b32 s7, 0x20000
  s_mov_b32 s8, s42
  s_mov_b32 s9, s43
  s_mov_b32 s10, 663552
  s_mov_b32 s11, 0x20000
  s_mov_b32 s33, 663552
  s_mov_b32 s34, 2359296
  s_add_u32 s32, s46, 0
  s_add_u32 s31, s47, 0
  s_add_u32 m0, s32, 0
  s_nop 0
  buffer_load_dwordx4 v12, s[4:7], s29 offen offset:0 lds
  s_add_u32 m0, s32, 1024
  s_nop 0
  buffer_load_dwordx4 v230, s[4:7], s29 offen offset:0 lds
  s_add_u32 m0, s32, 1984
  s_nop 0
  buffer_load_dwordx4 v12, s[4:7], s29 offen offset:64 lds
  s_add_u32 m0, s32, 3008
  s_nop 0
  buffer_load_dwordx4 v230, s[4:7], s29 offen offset:64 lds
  s_add_u32 m0, s31, 0
  s_nop 0
  buffer_load_dwordx4 v11, s[8:11], s28 offen offset:0 lds
  s_add_u32 m0, s31, 960
  s_nop 0
  buffer_load_dwordx4 v11, s[8:11], s28 offen offset:64 lds
  s_add_u32 m0, s31, 1920
  s_nop 0
  buffer_load_dwordx4 v11, s[8:11], s28 offen offset:128 lds
  s_add_u32 s35, s35, 1
  s_cmp_eq_u32 s35, 9
  s_cselect_b32 s35, 0, s35
  s_cselect_b32 s27, s49, s48
  s_cselect_b32 s22, s51, s50
  s_add_u32 s28, s28, s27
  s_add_u32 s29, s29, s22
  s_add_u32 s32, s46, 28672
  s_add_u32 s31, s47, 28672
  s_add_u32 m0, s32, 0
  s_nop 0
  buffer_load_dwordx4 v12, s[4:7], s29 offen offset:0 lds
  s_add_u32 m0, s32, 1024
  s_nop 0
  buffer_load_dwordx4 v230, s[4:7], s29 offen offset:0 lds
  s_add_u32 m0, s32, 1984
  s_nop 0
  buffer_load_dwordx4 v12, s[4:7], s29 offen offset:64 lds
  s_add_u32 m0, s32, 3008
  s_nop 0
  buffer_load_dwordx4 v230, s[4:7], s29 offen offset:64 lds
  s_add_u32 m0, s31, 0
  s_nop 0
  buffer_load_dwordx4 v11, s[8:11], s28 offen offset:0 lds
  s_add_u32 m0, s31, 960
  s_nop 0
  buffer_load_dwordx4 v11, s[8:11], s28 offen offset:64 lds
  s_add_u32 m0, s31, 1920
  s_nop 0
  buffer_load_dwordx4 v11, s[8:11], s28 offen offset:128 lds
  s_add_u32 s35, s35, 1
  s_cmp_eq_u32 s35, 9
  s_cselect_b32 s35, 0, s35
  s_cselect_b32 s27, s49, s48
  s_cselect_b32 s22, s51, s50
  s_add_u32 s28, s28, s27
  s_add_u32 s29, s29, s22
  s_add_u32 s32, s46, 57344
  s_add_u32 s31, s47, 57344
  s_add_u32 m0, s32, 0
  s_nop 0
  buffer_load_dwordx4 v12, s[4:7], s29 offen offset:0 lds
  s_add_u32 m0, s32, 1024
  s_nop 0
  buffer_load_dwordx4 v230, s[4:7], s29 offen offset:0 lds
  s_add_u32 m0, s32, 1984
  s_nop 0
  buffer_load_dwordx4 v12, s[4:7], s29 offen offset:64 lds
  s_add_u32 m0, s32, 3008
  s_nop 0
  buffer_load_dwordx4 v230, s[4:7], s29 offen offset:64 lds
  s_add_u32 m0, s31, 0
  s_nop 0
  buffer_load_dwordx4 v11, s[8:11], s28 offen offset:0 lds
  s_add_u32 m0, s31, 960
  s_nop 0
  buffer_load_dwordx4 v11, s[8:11], s28 offen offset:64 lds
  s_add_u32 m0, s31, 1920
  s_nop 0
  buffer_load_dwordx4 v11, s[8:11], s28 offen offset:128 lds
  v_bfe_u32 v2, v1, 2, 2
  v_lshrrev_b32 v3, 5, v1
  v_lshlrev_b32 v3, 3, v3
  v_add_u32 v2, v2, v3
  v_lshlrev_b32 v7, 6, v2
  v_bfe_u32 v2, v1, 4, 1
  v_lshlrev_b32 v2, 5, v2
  v_add_u32 v7, v7, v2
  v_and_b32 v2, 3, v1
  v_lshlrev_b32 v2, 3, v2
  v_add_u32 v7, v7, v2
  v_add_u32 v7, 16384, v7
  v_and_b32 v2, 31, v1
  v_lshlrev_b32 v10, 6, v2
  v_bfe_u32 v2, v1, 2, 2
  v_lshrrev_b32 v3, 5, v1
  v_xor_b32 v2, v2, v3
  v_lshlrev_b32 v2, 4, v2
  v_add_u32 v10, v10, v2
  s_mul_i32 s27, s3, 4096
  v_add_u32 v10, s27, v10
  v_mov_b32 v16, 0
  v_mov_b32 v17, 0
  v_mov_b32 v18, 0
  v_mov_b32 v19, 0
  v_mov_b32 v20, 0
  v_mov_b32 v21, 0
  v_mov_b32 v22, 0
  v_mov_b32 v23, 0
  v_mov_b32 v24, 0
  v_mov_b32 v25, 0
  v_mov_b32 v26, 0
  v_mov_b32 v27, 0
  v_mov_b32 v28, 0
  v_mov_b32 v29, 0
  v_mov_b32 v30, 0
  v_mov_b32 v31, 0
  v_mov_b32 v32, 0
  v_mov_b32 v33, 0
  v_mov_b32 v34, 0
  v_mov_b32 v35, 0
  v_mov_b32 v36, 0
  v_mov_b32 v37, 0
  v_mov_b32 v38, 0
  v_mov_b32 v39, 0
  v_mov_b32 v40, 0
  v_mov_b32 v41, 0
  v_mov_b32 v42, 0
  v_mov_b32 v43, 0
  v_mov_b32 v44, 0
  v_mov_b32 v45, 0
  v_mov_b32 v46, 0
  v_mov_b32 v47, 0
  v_mov_b32 v48, 0
  v_mov_b32 v49, 0
  v_mov_b32 v50, 0
  v_mov_b32 v51, 0
  v_mov_b32 v52, 0
  v_mov_b32 v53, 0
  v_mov_b32 v54, 0
  v_mov_b32 v55, 0
  v_mov_b32 v56, 0
  v_mov_b32 v57, 0
  v_mov_b32 v58, 0
  v_mov_b32 v59, 0
  v_mov_b32 v60, 0
  v_mov_b32 v61, 0
  v_mov_b32 v62, 0
  v_mov_b32 v63, 0
  s_add_u32 s12, s44, 7077888
  s_addc_u32 s13, s45, 0
  s_mov_b32 s14, 2359296
  s_mov_b32 s15, 0x20000
  s_mul_i32 s23, s18, 36864
  s_mul_i32 s27, s17, 6144
  s_add_u32 s23, s23, s27
  s_add_u32 s24, s23, 4096
  v_lshlrev_b32 v13, 4, v1
  v_mov_b32 v14, 0xc0135761
  v_mov_b32 v15, 0xbdd2d3e8
  v_mov_b32 v156, 0x3f803f80
  v_mov_b32 v157, 0x3f803f80
  v_mov_b32 v158, 0x3f803f80
  v_mov_b32 v159, 0x3f803f80
  v_mov_b32 v64, 0
  v_mov_b32 v65, 0
  v_mov_b32 v66, 0
  v_mov_b32 v67, 0
  v_mov_b32 v68, 0
  v_mov_b32 v69, 0
  v_mov_b32 v70, 0
  v_mov_b32 v71, 0
  v_mov_b32 v72, 0
  v_mov_b32 v73, 0
  v_mov_b32 v74, 0
  v_mov_b32 v75, 0
  v_mov_b32 v76, 0
  v_mov_b32 v77, 0
  v_mov_b32 v78, 0
  v_mov_b32 v79, 0
  v_mov_b32 v80, 0
  v_mov_b32 v81, 0
  v_mov_b32 v82, 0
  v_mov_b32 v83, 0
  v_mov_b32 v84, 0
  v_mov_b32 v85, 0
  v_mov_b32 v86, 0
  v_mov_b32 v87, 0
  v_mov_b32 v88, 0
  v_mov_b32 v89, 0
  v_mov_b32 v90, 0
  v_mov_b32 v91, 0
  v_mov_b32 v92, 0
  v_mov_b32 v93, 0
  v_mov_b32 v94, 0
  v_mov_b32 v95, 0
  v_mov_b32 v3, v10
  v_xor_b32 v4, 32, v10
  s_waitcnt vmcnt(14)
  s_barrier
  v_mov_b32 v5, v7
  v_add_u32 v6, 28672, v7
  v_mov_b32 v8, v10
  v_xor_b32 v9, 32, v10
  ds_read_b128 v[136:139], v8 offset:0
  ds_read_b128 v[140:143], v9 offset:0
  ds_read_b64_tr_b16 v[112:113], v5 offset:0
  ds_read_b64_tr_b16 v[114:115], v5 offset:256
  ds_read_b64_tr_b16 v[116:117], v5 offset:1024
  ds_read_b64_tr_b16 v[118:119], v5 offset:1280
  ds_read_b64_tr_b16 v[120:121], v5 offset:2048
  ds_read_b64_tr_b16 v[122:123], v5 offset:2304
  ds_read_b64_tr_b16 v[124:125], v5 offset:3072
  ds_read_b64_tr_b16 v[126:127], v5 offset:3328
  ds_read_b64_tr_b16 v[128:129], v5 offset:4096
  ds_read_b64_tr_b16 v[130:131], v5 offset:4352
  ds_read_b64_tr_b16 v[132:133], v5 offset:5120
  ds_read_b64_tr_b16 v[134:135], v5 offset:5376
  v_add_u32 v8, 28672, v10
  v_xor_b32 v9, 32, v8
  s_mov_b32 s20, 28672
  s_mov_b32 s21, 86016
  s_mov_b32 s19, 0
L_h_loop:
  s_waitcnt lgkmcnt(7)
  v_mfma_f32_32x32x16_bf16 v[16:31], v[112:115], v[136:139], v[16:31]
  v_mfma_f32_32x32x16_bf16 v[64:79], v[156:159], v[136:139], v[64:79]
  ds_read_b64_tr_b16 v[112:113], v5 offset:6144
  ds_read_b64_tr_b16 v[114:115], v5 offset:6400
  s_add_u32 s35, s35, 1
  s_cmp_eq_u32 s35, 9
  s_cselect_b32 s35, 0, s35
  s_cselect_b32 s27, s49, s48
  s_cselect_b32 s22, s51, s50
  v_add_u32 v6, s20, v7
  s_waitcnt lgkmcnt(10)
  v_mfma_f32_32x32x16_bf16 v[32:47], v[116:119], v[136:139], v[32:47]
  v_mfma_f32_32x32x16_bf16 v[80:95], v[136:139], v[136:139], v[80:95]
  ds_read_b64_tr_b16 v[116:117], v5 offset:7168
  ds_read_b64_tr_b16 v[118:119], v5 offset:7424
  s_add_u32 s28, s28, s27
  v_xor_b32 v9, 32, v8
  s_waitcnt lgkmcnt(10)
  v_mfma_f32_32x32x16_bf16 v[48:63], v[120:123], v[136:139], v[48:63]
  ds_read_b64_tr_b16 v[120:121], v5 offset:8192
  ds_read_b64_tr_b16 v[122:123], v5 offset:8448
  ds_read_b128 v[136:139], v3 offset:2048
  s_add_u32 s29, s29, s22
  s_waitcnt lgkmcnt(7)
  v_mfma_f32_32x32x16_bf16 v[16:31], v[124:127], v[140:143], v[16:31]
  v_mfma_f32_32x32x16_bf16 v[64:79], v[156:159], v[140:143], v[64:79]
  ds_read_b64_tr_b16 v[124:125], v5 offset:9216
  ds_read_b64_tr_b16 v[126:127], v5 offset:9472
  s_add_u32 s32, s46, s21
  s_waitcnt lgkmcnt(11)
  v_mfma_f32_32x32x16_bf16 v[32:47], v[128:131], v[140:143], v[32:47]
  v_mfma_f32_32x32x16_bf16 v[80:95], v[140:143], v[140:143], v[80:95]
  ds_read_b64_tr_b16 v[128:129], v5 offset:10240
  ds_read_b64_tr_b16 v[130:131], v5 offset:10496
  s_add_u32 s31, s47, s21
  s_waitcnt lgkmcnt(11)
  v_mfma_f32_32x32x16_bf16 v[48:63], v[132:135], v[140:143], v[48:63]
  ds_read_b64_tr_b16 v[132:133], v5 offset:11264
  ds_read_b64_tr_b16 v[134:135], v5 offset:11520
  ds_read_b128 v[140:143], v4 offset:2048
  s_cmp_lt_u32 s19, 6
  s_cselect_b32 s10, s33, 0
  s_cselect_b32 s6, s34, 0
  s_waitcnt vmcnt(7)
  s_barrier
  s_waitcnt lgkmcnt(7)
  v_mfma_f32_32x32x16_bf16 v[16:31], v[112:115], v[136:139], v[16:31]
  v_mfma_f32_32x32x16_bf16 v[64:79], v[156:159], v[136:139], v[64:79]
  s_add_u32 m0, s32, 0
  ds_read_b64_tr_b16 v[112:113], v6 offset:0
  buffer_load_dwordx4 v12, s[4:7], s29 offen offset:0 lds
  ds_read_b64_tr_b16 v[114:115], v6 offset:256
  s_add_u32 m0, s32, 1024
  s_nop 0
  buffer_load_dwordx4 v230, s[4:7], s29 offen offset:0 lds
  v_mov_b32 v5, v6
  v_mov_b32 v3, v8
  v_mov_b32 v4, v9
  v_mfma_f32_32x32x16_bf16 v[32:47], v[116:119], v[136:139], v[32:47]
  v_mfma_f32_32x32x16_bf16 v[80:95], v[136:139], v[136:139], v[80:95]
  s_add_u32 m0, s32, 1984
  ds_read_b64_tr_b16 v[116:117], v6 offset:1024
  buffer_load_dwordx4 v12, s[4:7], s29 offen offset:64 lds
  ds_read_b64_tr_b16 v[118:119], v6 offset:1280
  s_add_u32 s21, s21, 28672
  v_mfma_f32_32x32x16_bf16 v[48:63], v[120:123], v[136:139], v[48:63]
  s_add_u32 m0, s32, 3008
  ds_read_b64_tr_b16 v[120:121], v6 offset:2048
  buffer_load_dwordx4 v230, s[4:7], s29 offen offset:64 lds
  ds_read_b64_tr_b16 v[122:123], v6 offset:2304
  ds_read_b128 v[136:139], v8 offset:0
  s_cmp_eq_u32 s21, 143360
  s_cselect_b32 s21, 0, s21
  s_waitcnt lgkmcnt(7)
  v_mfma_f32_32x32x16_bf16 v[16:31], v[124:127], v[140:143], v[16:31]
  v_mfma_f32_32x32x16_bf16 v[64:79], v[156:159], v[140:143], v[64:79]
  s_add_u32 m0, s31, 0
  ds_read_b64_tr_b16 v[124:125], v6 offset:3072
  buffer_load_dwordx4 v11, s[8:11], s28 offen offset:0 lds
  ds_read_b64_tr_b16 v[126:127], v6 offset:3328
  s_add_u32 s20, s20, 28672
  v_mfma_f32_32x32x16_bf16 v[32:47], v[128:131], v[140:143], v[32:47]
  v_mfma_f32_32x32x16_bf16 v[80:95], v[140:143], v[140:143], v[80:95]
  s_add_u32 m0, s31, 960
  ds_read_b64_tr_b16 v[128:129], v6 offset:4096
  buffer_load_dwordx4 v11, s[8:11], s28 offen offset:64 lds
  ds_read_b64_tr_b16 v[130:131], v6 offset:4352
  s_cmp_eq_u32 s20, 143360
  s_cselect_b32 s20, 0, s20
  v_add_u32 v8, s20, v10
  s_add_u32 s19, s19, 1
  v_mfma_f32_32x32x16_bf16 v[48:63], v[132:135], v[140:143], v[48:63]
  s_add_u32 m0, s31, 1920
  ds_read_b64_tr_b16 v[132:133], v6 offset:5120
  buffer_load_dwordx4 v11, s[8:11], s28 offen offset:128 lds
  ds_read_b64_tr_b16 v[134:135], v6 offset:5376
  ds_read_b128 v[140:143], v9 offset:0
  s_cmp_lt_u32 s19, 9
  s_cbranch_scc1 L_h_loop
  s_load_dwordx2 s[52:53], s[0:1], 80
  s_waitcnt lgkmcnt(0)
  s_mov_b32 s56, s52
  s_mov_b32 s57, s53
  s_mov_b32 s58, 256
  s_mov_b32 s59, 0x20000
  v_mov_b32 v4, 0
  buffer_load_dword v208, v4, s[56:59], 0 offen sc1
  v_and_b32 v152, 3, v1
  v_bfe_u32 v153, v1, 3, 2
  v_lshl_add_u32 v152, v153, 2, v152
  v_mov_b32 v153, v80
  v_cmp_eq_u32 vcc, 1, v152
  s_nop 1
  v_cndmask_b32 v153, v153, v81, vcc
  v_cmp_eq_u32 s[62:63], 2, v152
  s_nop 1
  v_cndmask_b32 v153, v153, v82, s[62:63]
  v_cmp_eq_u32 vcc, 3, v152
  s_nop 1
  v_cndmask_b32 v153, v153, v83, vcc
  v_cmp_eq_u32 s[62:63], 4, v152
  s_nop 1
  v_cndmask_b32 v153, v153, v84, s[62:63]
  v_cmp_eq_u32 vcc, 5, v152
  s_nop 1
  v_cndmask_b32 v153, v153, v85, vcc
  v_cmp_eq_u32 s[62:63], 6, v152
  s_nop 1
  v_cndmask_b32 v153, v153, v86, s[62:63]
  v_cmp_eq_u32 vcc, 7, v152
  s_nop 1
  v_cndmask_b32 v153, v153, v87, vcc
  v_cmp_eq_u32 s[62:63], 8, v152
  s_nop 1
  v_cndmask_b32 v153, v153, v88, s[62:63]
  v_cmp_eq_u32 vcc, 9, v152
  s_nop 1
  v_cndmask_b32 v153, v153, v89, vcc
  v_cmp_eq_u32 s[62:63], 10, v152
  s_nop 1
  v_cndmask_b32 v153, v153, v90, s[62:63]
  v_cmp_eq_u32 vcc, 11, v152
  s_nop 1
  v_cndmask_b32 v153, v153, v91, vcc
  v_cmp_eq_u32 s[62:63], 12, v152
  s_nop 1
  v_cndmask_b32 v153, v153, v92, s[62:63]
  v_cmp_eq_u32 vcc, 13, v152
  s_nop 1
  v_cndmask_b32 v153, v153, v93, vcc
  v_cmp_eq_u32 s[62:63], 14, v152
  s_nop 1
  v_cndmask_b32 v153, v153, v94, s[62:63]
  v_cmp_eq_u32 vcc, 15, v152
  s_nop 1
  v_cndmask_b32 v153, v153, v95, vcc
  v_mov_b32 v154, v153
  v_mov_b32 v155, v153
  s_nop 1
  v_permlane32_swap_b32 v154, v155
  v_bfe_u32 v152, v1, 2, 1
  v_cmp_eq_u32 vcc, 1, v152
  s_nop 1
  v_cndmask_b32 v153, v154, v155, vcc
  v_mul_f32 v152, 0x3ae38e39, v64
  v_mul_f32 v153, 0x3ae38e39, v153
  v_fma_f32 v153, -v152, v152, v153
  v_max_f32 v153, 0, v153
  v_add_f32 v153, 0x3727c5ac, v153
  v_rsq_f32 v224, v153
  s_nop 0
  v_mul_f32 v226, v152, v224
  v_sub_f32 v226, 0, v226
  s_mov_b32 s55, 131072
L_h_poll:
  s_waitcnt vmcnt(0)
  v_readfirstlane_b32 s54, v208
  s_nop 0
  s_cmp_ge_u32 s54, 18
  s_cbranch_scc1 L_h_got
  s_sub_u32 s55, s55, 1
  s_cbranch_scc1 L_h_got
  s_sleep 8
  buffer_load_dword v208, v4, s[56:59], 0 offen sc1
  s_branch L_h_poll
L_h_got:
  s_add_u32 s56, s44, 14163968
  s_addc_u32 s57, s45, 0
  s_mov_b32 s58, 2304
  s_mov_b32 s59, 0x20000
  v_lshrrev_b32 v2, 5, v1
  v_lshlrev_b32 v3, 4, v2
  s_mul_i32 s54, s17, 384
  buffer_load_dwordx4 v[160:163], v3, s[56:59], s54 offen offset:0 sc1
  buffer_load_dwordx4 v[164:167], v3, s[56:59], s54 offen offset:32 sc1
  buffer_load_dwordx4 v[168:171], v3, s[56:59], s54 offen offset:64 sc1
  buffer_load_dwordx4 v[172:175], v3, s[56:59], s54 offen offset:96 sc1
  buffer_load_dwordx4 v[176:179], v3, s[56:59], s54 offen offset:128 sc1
  buffer_load_dwordx4 v[180:183], v3, s[56:59], s54 offen offset:160 sc1
  buffer_load_dwordx4 v[184:187], v3, s[56:59], s54 offen offset:192 sc1
  buffer_load_dwordx4 v[188:191], v3, s[56:59], s54 offen offset:224 sc1
  buffer_load_dwordx4 v[192:195], v3, s[56:59], s54 offen offset:256 sc1
  buffer_load_dwordx4 v[196:199], v3, s[56:59], s54 offen offset:288 sc1
  buffer_load_dwordx4 v[200:203], v3, s[56:59], s54 offen offset:320 sc1
  buffer_load_dwordx4 v[204:207], v3, s[56:59], s54 offen offset:352 sc1
  s_waitcnt vmcnt(11)
  v_mul_f32 v160, v226, v160
  v_fma_f32 v16, v16, v224, v160
  v_mul_f32 v161, v226, v161
  v_fma_f32 v17, v17, v224, v161
  v_mul_f32 v162, v226, v162
  v_fma_f32 v18, v18, v224, v162
  v_mul_f32 v163, v226, v163
  v_fma_f32 v19, v19, v224, v163
  s_waitcnt vmcnt(10)
  v_mul_f32 v164, v226, v164
  v_fma_f32 v20, v20, v224, v164
  v_mul_f32 v165, v226, v165
  v_fma_f32 v21, v21, v224, v165
  v_mul_f32 v166, v226, v166
  v_fma_f32 v22, v22, v224, v166
  v_mul_f32 v167, v226, v167
  v_fma_f32 v23, v23, v224, v167
  s_waitcnt vmcnt(9)
  v_mul_f32 v168, v226, v168
  v_fma_f32 v24, v24, v224, v168
  v_mul_f32 v169, v226, v169
  v_fma_f32 v25, v25, v224, v169
  v_mul_f32 v170, v226, v170
  v_fma_f32 v26, v26, v224, v170
  v_mul_f32 v171, v226, v171
  v_fma_f32 v27, v27, v224, v171
  s_waitcnt vmcnt(8)
  v_mul_f32 v172, v226, v172
  v_fma_f32 v28, v28, v224, v172
  v_mul_f32 v173, v226, v173
  v_fma_f32 v29, v29, v224, v173
  v_mul_f32 v174, v226, v174
  v_fma_f32 v30, v30, v224, v174
  v_mul_f32 v175, v226, v175
  v_fma_f32 v31, v31, v224, v175
  v_mul_f32 v152, v16, v16
  v_mul_f32 v153, v17, v17
  v_mul_f32 v154, v18, v18
  v_mul_f32 v155, v19, v19
  v_fma_f32 v152, v152, v15, v14
  v_fma_f32 v153, v153, v15, v14
  v_fma_f32 v154, v154, v15, v14
  v_fma_f32 v155, v155, v15, v14
  v_mul_f32 v152, v16, v152
  v_mul_f32 v153, v17, v153
  v_mul_f32 v154, v18, v154
  v_mul_f32 v155, v19, v155
  v_exp_f32 v152, v152
  v_exp_f32 v153, v153
  v_exp_f32 v154, v154
  v_exp_f32 v155, v155
  v_add_f32 v152, 1.0, v152
  v_add_f32 v153, 1.0, v153
  v_add_f32 v154, 1.0, v154
  v_add_f32 v155, 1.0, v155
  v_rcp_f32 v152, v152
  v_rcp_f32 v153, v153
  v_rcp_f32 v154, v154
  v_rcp_f32 v155, v155
  v_mul_f32 v16, v16, v152
  v_mul_f32 v17, v17, v153
  v_mul_f32 v18, v18, v154
  v_mul_f32 v19, v19, v155
  v_cvt_pk_bf16_f32 v144, v16, v17
  v_cvt_pk_bf16_f32 v145, v18, v19
  v_mul_f32 v152, v20, v20
  v_mul_f32 v153, v21, v21
  v_mul_f32 v154, v22, v22
  v_mul_f32 v155, v23, v23
  v_fma_f32 v152, v152, v15, v14
  v_fma_f32 v153, v153, v15, v14
  v_fma_f32 v154, v154, v15, v14
  v_fma_f32 v155, v155, v15, v14
  v_mul_f32 v152, v20, v152
  v_mul_f32 v153, v21, v153
  v_mul_f32 v154, v22, v154
  v_mul_f32 v155, v23, v155
  v_exp_f32 v152, v152
  v_exp_f32 v153, v153
  v_exp_f32 v154, v154
  v_exp_f32 v155, v155
  v_add_f32 v152, 1.0, v152
  v_add_f32 v153, 1.0, v153
  v_add_f32 v154, 1.0, v154
  v_add_f32 v155, 1.0, v155
  v_rcp_f32 v152, v152
  v_rcp_f32 v153, v153
  v_rcp_f32 v154, v154
  v_rcp_f32 v155, v155
  v_mul_f32 v20, v20, v152
  v_mul_f32 v21, v21, v153
  v_mul_f32 v22, v22, v154
  v_mul_f32 v23, v23, v155
  v_cvt_pk_bf16_f32 v146, v20, v21
  v_cvt_pk_bf16_f32 v147, v22, v23
  v_mul_f32 v152, v24, v24
  v_mul_f32 v153, v25, v25
  v_mul_f32 v154, v26, v26
  v_mul_f32 v155, v27, v27
  v_fma_f32 v152, v152, v15, v14
  v_fma_f32 v153, v153, v15, v14
  v_fma_f32 v154, v154, v15, v14
  v_fma_f32 v155, v155, v15, v14
  v_mul_f32 v152, v24, v152
  v_mul_f32 v153, v25, v153
  v_mul_f32 v154, v26, v154
  v_mul_f32 v155, v27, v155
  v_exp_f32 v152, v152
  v_exp_f32 v153, v153
  v_exp_f32 v154, v154
  v_exp_f32 v155, v155
  v_add_f32 v152, 1.0, v152
  v_add_f32 v153, 1.0, v153
  v_add_f32 v154, 1.0, v154
  v_add_f32 v155, 1.0, v155
  v_rcp_f32 v152, v152
  v_rcp_f32 v153, v153
  v_rcp_f32 v154, v154
  v_rcp_f32 v155, v155
  v_mul_f32 v24, v24, v152
  v_mul_f32 v25, v25, v153
  v_mul_f32 v26, v26, v154
  v_mul_f32 v27, v27, v155
  v_cvt_pk_bf16_f32 v148, v24, v25
  v_cvt_pk_bf16_f32 v149, v26, v27
  v_mul_f32 v152, v28, v28
  v_mul_f32 v153, v29, v29
  v_mul_f32 v154, v30, v30
  v_mul_f32 v155, v31, v31
  v_fma_f32 v152, v152, v15, v14
  v_fma_f32 v153, v153, v15, v14
  v_fma_f32 v154, v154, v15, v14
  v_fma_f32 v155, v155, v15, v14
  v_mul_f32 v152, v28, v152
  v_mul_f32 v153, v29, v153
  v_mul_f32 v154, v30, v154
  v_mul_f32 v155, v31, v155
  v_exp_f32 v152, v152
  v_exp_f32 v153, v153
  v_exp_f32 v154, v154
  v_exp_f32 v155, v155
  v_add_f32 v152, 1.0, v152
  v_add_f32 v153, 1.0, v153
  v_add_f32 v154, 1.0, v154
  v_add_f32 v155, 1.0, v155
  v_rcp_f32 v152, v152
  v_rcp_f32 v153, v153
  v_rcp_f32 v154, v154
  v_rcp_f32 v155, v155
  v_mul_f32 v28, v28, v152
  v_mul_f32 v29, v29, v153
  v_mul_f32 v30, v30, v154
  v_mul_f32 v31, v31, v155
  v_cvt_pk_bf16_f32 v150, v28, v29
  v_cvt_pk_bf16_f32 v151, v30, v31
  buffer_store_dwordx4 v[144:147], v13, s[12:15], s23 offen offset:0 sc1
  buffer_store_dwordx4 v[148:151], v13, s[12:15], s23 offen offset:1024 sc1
  s_waitcnt vmcnt(9)
  v_mul_f32 v176, v226, v176
  v_fma_f32 v32, v32, v224, v176
  v_mul_f32 v177, v226, v177
  v_fma_f32 v33, v33, v224, v177
  v_mul_f32 v178, v226, v178
  v_fma_f32 v34, v34, v224, v178
  v_mul_f32 v179, v226, v179
  v_fma_f32 v35, v35, v224, v179
  s_waitcnt vmcnt(8)
  v_mul_f32 v180, v226, v180
  v_fma_f32 v36, v36, v224, v180
  v_mul_f32 v181, v226, v181
  v_fma_f32 v37, v37, v224, v181
  v_mul_f32 v182, v226, v182
  v_fma_f32 v38, v38, v224, v182
  v_mul_f32 v183, v226, v183
  v_fma_f32 v39, v39, v224, v183
  s_waitcnt vmcnt(7)
  v_mul_f32 v184, v226, v184
  v_fma_f32 v40, v40, v224, v184
  v_mul_f32 v185, v226, v185
  v_fma_f32 v41, v41, v224, v185
  v_mul_f32 v186, v226, v186
  v_fma_f32 v42, v42, v224, v186
  v_mul_f32 v187, v226, v187
  v_fma_f32 v43, v43, v224, v187
  s_waitcnt vmcnt(6)
  v_mul_f32 v188, v226, v188
  v_fma_f32 v44, v44, v224, v188
  v_mul_f32 v189, v226, v189
  v_fma_f32 v45, v45, v224, v189
  v_mul_f32 v190, v226, v190
  v_fma_f32 v46, v46, v224, v190
  v_mul_f32 v191, v226, v191
  v_fma_f32 v47, v47, v224, v191
  v_mul_f32 v152, v32, v32
  v_mul_f32 v153, v33, v33
  v_mul_f32 v154, v34, v34
  v_mul_f32 v155, v35, v35
  v_fma_f32 v152, v152, v15, v14
  v_fma_f32 v153, v153, v15, v14
  v_fma_f32 v154, v154, v15, v14
  v_fma_f32 v155, v155, v15, v14
  v_mul_f32 v152, v32, v152
  v_mul_f32 v153, v33, v153
  v_mul_f32 v154, v34, v154
  v_mul_f32 v155, v35, v155
  v_exp_f32 v152, v152
  v_exp_f32 v153, v153
  v_exp_f32 v154, v154
  v_exp_f32 v155, v155
  v_add_f32 v152, 1.0, v152
  v_add_f32 v153, 1.0, v153
  v_add_f32 v154, 1.0, v154
  v_add_f32 v155, 1.0, v155
  v_rcp_f32 v152, v152
  v_rcp_f32 v153, v153
  v_rcp_f32 v154, v154
  v_rcp_f32 v155, v155
  v_mul_f32 v32, v32, v152
  v_mul_f32 v33, v33, v153
  v_mul_f32 v34, v34, v154
  v_mul_f32 v35, v35, v155
  v_cvt_pk_bf16_f32 v144, v32, v33
  v_cvt_pk_bf16_f32 v145, v34, v35
  v_mul_f32 v152, v36, v36
  v_mul_f32 v153, v37, v37
  v_mul_f32 v154, v38, v38
  v_mul_f32 v155, v39, v39
  v_fma_f32 v152, v152, v15, v14
  v_fma_f32 v153, v153, v15, v14
  v_fma_f32 v154, v154, v15, v14
  v_fma_f32 v155, v155, v15, v14
  v_mul_f32 v152, v36, v152
  v_mul_f32 v153, v37, v153
  v_mul_f32 v154, v38, v154
  v_mul_f32 v155, v39, v155
  v_exp_f32 v152, v152
  v_exp_f32 v153, v153
  v_exp_f32 v154, v154
  v_exp_f32 v155, v155
  v_add_f32 v152, 1.0, v152
  v_add_f32 v153, 1.0, v153
  v_add_f32 v154, 1.0, v154
  v_add_f32 v155, 1.0, v155
  v_rcp_f32 v152, v152
  v_rcp_f32 v153, v153
  v_rcp_f32 v154, v154
  v_rcp_f32 v155, v155
  v_mul_f32 v36, v36, v152
  v_mul_f32 v37, v37, v153
  v_mul_f32 v38, v38, v154
  v_mul_f32 v39, v39, v155
  v_cvt_pk_bf16_f32 v146, v36, v37
  v_cvt_pk_bf16_f32 v147, v38, v39
  v_mul_f32 v152, v40, v40
  v_mul_f32 v153, v41, v41
  v_mul_f32 v154, v42, v42
  v_mul_f32 v155, v43, v43
  v_fma_f32 v152, v152, v15, v14
  v_fma_f32 v153, v153, v15, v14
  v_fma_f32 v154, v154, v15, v14
  v_fma_f32 v155, v155, v15, v14
  v_mul_f32 v152, v40, v152
  v_mul_f32 v153, v41, v153
  v_mul_f32 v154, v42, v154
  v_mul_f32 v155, v43, v155
  v_exp_f32 v152, v152
  v_exp_f32 v153, v153
  v_exp_f32 v154, v154
  v_exp_f32 v155, v155
  v_add_f32 v152, 1.0, v152
  v_add_f32 v153, 1.0, v153
  v_add_f32 v154, 1.0, v154
  v_add_f32 v155, 1.0, v155
  v_rcp_f32 v152, v152
  v_rcp_f32 v153, v153
  v_rcp_f32 v154, v154
  v_rcp_f32 v155, v155
  v_mul_f32 v40, v40, v152
  v_mul_f32 v41, v41, v153
  v_mul_f32 v42, v42, v154
  v_mul_f32 v43, v43, v155
  v_cvt_pk_bf16_f32 v148, v40, v41
  v_cvt_pk_bf16_f32 v149, v42, v43
  v_mul_f32 v152, v44, v44
  v_mul_f32 v153, v45, v45
  v_mul_f32 v154, v46, v46
  v_mul_f32 v155, v47, v47
  v_fma_f32 v152, v152, v15, v14
  v_fma_f32 v153, v153, v15, v14
  v_fma_f32 v154, v154, v15, v14
  v_fma_f32 v155, v155, v15, v14
  v_mul_f32 v152, v44, v152
  v_mul_f32 v153, v45, v153
  v_mul_f32 v154, v46, v154
  v_mul_f32 v155, v47, v155
  v_exp_f32 v152, v152
  v_exp_f32 v153, v153
  v_exp_f32 v154, v154
  v_exp_f32 v155, v155
  v_add_f32 v152, 1.0, v152
  v_add_f32 v153, 1.0, v153
  v_add_f32 v154, 1.0, v154
  v_add_f32 v155, 1.0, v155
  v_rcp_f32 v152, v152
  v_rcp_f32 v153, v153
  v_rcp_f32 v154, v154
  v_rcp_f32 v155, v155
  v_mul_f32 v44, v44, v152
  v_mul_f32 v45, v45, v153
  v_mul_f32 v46, v46, v154
  v_mul_f32 v47, v47, v155
  v_cvt_pk_bf16_f32 v150, v44, v45
  v_cvt_pk_bf16_f32 v151, v46, v47
  buffer_store_dwordx4 v[144:147], v13, s[12:15], s23 offen offset:2048 sc1
  buffer_store_dwordx4 v[148:151], v13, s[12:15], s23 offen offset:3072 sc1
  s_waitcnt vmcnt(7)
  v_mul_f32 v192, v226, v192
  v_fma_f32 v48, v48, v224, v192
  v_mul_f32 v193, v226, v193
  v_fma_f32 v49, v49, v224, v193
  v_mul_f32 v194, v226, v194
  v_fma_f32 v50, v50, v224, v194
  v_mul_f32 v195, v226, v195
  v_fma_f32 v51, v51, v224, v195
  s_waitcnt vmcnt(6)
  v_mul_f32 v196, v226, v196
  v_fma_f32 v52, v52, v224, v196
  v_mul_f32 v197, v226, v197
  v_fma_f32 v53, v53, v224, v197
  v_mul_f32 v198, v226, v198
  v_fma_f32 v54, v54, v224, v198
  v_mul_f32 v199, v226, v199
  v_fma_f32 v55, v55, v224, v199
  s_waitcnt vmcnt(5)
  v_mul_f32 v200, v226, v200
  v_fma_f32 v56, v56, v224, v200
  v_mul_f32 v201, v226, v201
  v_fma_f32 v57, v57, v224, v201
  v_mul_f32 v202, v226, v202
  v_fma_f32 v58, v58, v224, v202
  v_mul_f32 v203, v226, v203
  v_fma_f32 v59, v59, v224, v203
  s_waitcnt vmcnt(4)
  v_mul_f32 v204, v226, v204
  v_fma_f32 v60, v60, v224, v204
  v_mul_f32 v205, v226, v205
  v_fma_f32 v61, v61, v224, v205
  v_mul_f32 v206, v226, v206
  v_fma_f32 v62, v62, v224, v206
  v_mul_f32 v207, v226, v207
  v_fma_f32 v63, v63, v224, v207
  v_mul_f32 v152, v48, v48
  v_mul_f32 v153, v49, v49
  v_mul_f32 v154, v50, v50
  v_mul_f32 v155, v51, v51
  v_fma_f32 v152, v152, v15, v14
  v_fma_f32 v153, v153, v15, v14
  v_fma_f32 v154, v154, v15, v14
  v_fma_f32 v155, v155, v15, v14
  v_mul_f32 v152, v48, v152
  v_mul_f32 v153, v49, v153
  v_mul_f32 v154, v50, v154
  v_mul_f32 v155, v51, v155
  v_exp_f32 v152, v152
  v_exp_f32 v153, v153
  v_exp_f32 v154, v154
  v_exp_f32 v155, v155
  v_add_f32 v152, 1.0, v152
  v_add_f32 v153, 1.0, v153
  v_add_f32 v154, 1.0, v154
  v_add_f32 v155, 1.0, v155
  v_rcp_f32 v152, v152
  v_rcp_f32 v153, v153
  v_rcp_f32 v154, v154
  v_rcp_f32 v155, v155
  v_mul_f32 v48, v48, v152
  v_mul_f32 v49, v49, v153
  v_mul_f32 v50, v50, v154
  v_mul_f32 v51, v51, v155
  v_cvt_pk_bf16_f32 v144, v48, v49
  v_cvt_pk_bf16_f32 v145, v50, v51
  v_mul_f32 v152, v52, v52
  v_mul_f32 v153, v53, v53
  v_mul_f32 v154, v54, v54
  v_mul_f32 v155, v55, v55
  v_fma_f32 v152, v152, v15, v14
  v_fma_f32 v153, v153, v15, v14
  v_fma_f32 v154, v154, v15, v14
  v_fma_f32 v155, v155, v15, v14
  v_mul_f32 v152, v52, v152
  v_mul_f32 v153, v53, v153
  v_mul_f32 v154, v54, v154
  v_mul_f32 v155, v55, v155
  v_exp_f32 v152, v152
  v_exp_f32 v153, v153
  v_exp_f32 v154, v154
  v_exp_f32 v155, v155
  v_add_f32 v152, 1.0, v152
  v_add_f32 v153, 1.0, v153
  v_add_f32 v154, 1.0, v154
  v_add_f32 v155, 1.0, v155
  v_rcp_f32 v152, v152
  v_rcp_f32 v153, v153
  v_rcp_f32 v154, v154
  v_rcp_f32 v155, v155
  v_mul_f32 v52, v52, v152
  v_mul_f32 v53, v53, v153
  v_mul_f32 v54, v54, v154
  v_mul_f32 v55, v55, v155
  v_cvt_pk_bf16_f32 v146, v52, v53
  v_cvt_pk_bf16_f32 v147, v54, v55
  v_mul_f32 v152, v56, v56
  v_mul_f32 v153, v57, v57
  v_mul_f32 v154, v58, v58
  v_mul_f32 v155, v59, v59
  v_fma_f32 v152, v152, v15, v14
  v_fma_f32 v153, v153, v15, v14
  v_fma_f32 v154, v154, v15, v14
  v_fma_f32 v155, v155, v15, v14
  v_mul_f32 v152, v56, v152
  v_mul_f32 v153, v57, v153
  v_mul_f32 v154, v58, v154
  v_mul_f32 v155, v59, v155
  v_exp_f32 v152, v152
  v_exp_f32 v153, v153
  v_exp_f32 v154, v154
  v_exp_f32 v155, v155
  v_add_f32 v152, 1.0, v152
  v_add_f32 v153, 1.0, v153
  v_add_f32 v154, 1.0, v154
  v_add_f32 v155, 1.0, v155
  v_rcp_f32 v152, v152
  v_rcp_f32 v153, v153
  v_rcp_f32 v154, v154
  v_rcp_f32 v155, v155
  v_mul_f32 v56, v56, v152
  v_mul_f32 v57, v57, v153
  v_mul_f32 v58, v58, v154
  v_mul_f32 v59, v59, v155
  v_cvt_pk_bf16_f32 v148, v56, v57
  v_cvt_pk_bf16_f32 v149, v58, v59
  v_mul_f32 v152, v60, v60
  v_mul_f32 v153, v61, v61
  v_mul_f32 v154, v62, v62
  v_mul_f32 v155, v63, v63
  v_fma_f32 v152, v152, v15, v14
  v_fma_f32 v153, v153, v15, v14
  v_fma_f32 v154, v154, v15, v14
  v_fma_f32 v155, v155, v15, v14
  v_mul_f32 v152, v60, v152
  v_mul_f32 v153, v61, v153
  v_mul_f32 v154, v62, v154
  v_mul_f32 v155, v63, v155
  v_exp_f32 v152, v152
  v_exp_f32 v153, v153
  v_exp_f32 v154, v154
  v_exp_f32 v155, v155
  v_add_f32 v152, 1.0, v152
  v_add_f32 v153, 1.0, v153
  v_add_f32 v154, 1.0, v154
  v_add_f32 v155, 1.0, v155
  v_rcp_f32 v152, v152
  v_rcp_f32 v153, v153
  v_rcp_f32 v154, v154
  v_rcp_f32 v155, v155
  v_mul_f32 v60, v60, v152
  v_mul_f32 v61, v61, v153
  v_mul_f32 v62, v62, v154
  v_mul_f32 v63, v63, v155
  v_cvt_pk_bf16_f32 v150, v60, v61
  v_cvt_pk_bf16_f32 v151, v62, v63
  buffer_store_dwordx4 v[144:147], v13, s[12:15], s24 offen sc1
  buffer_store_dwordx4 v[148:151], v13, s[12:15], s24 offen offset:1024 sc1
  s_branch L_k1_end
L_k1_gate:
  s_cmp_lt_u32 s18, 18
  s_cbranch_scc0 L_k1_nocs
  s_mov_b64 s[52:53], s[88:89]
  s_mov_b64 s[54:55], s[100:101]
  s_load_dwordx2 s[60:61], s[0:1], 80
  v_lshrrev_b32 v2, 2, v1
  s_mov_b32 s27, 1152
  v_mul_lo_u32 v11, v2, s27
  v_and_b32 v2, 3, v1
  v_lshlrev_b32 v2, 4, v2
  v_add_u32 v11, v11, v2
  s_lshl_b32 s27, s18, 6
  v_add_u32 v11, s27, v11
  s_waitcnt lgkmcnt(0)
  s_mov_b32 s56, s52
  s_mov_b32 s57, s53
  s_mov_b32 s58, 663552
  s_mov_b32 s59, 0x20000
  s_mul_i32 s62, s3, 36864
  s_mov_b32 s63, 0
  s_add_u32 m0, s62, 0
  s_nop 0
  buffer_load_dwordx4 v11, s[56:59], s63 offen lds
  s_add_u32 s63, s63, 18432
  s_add_u32 m0, s62, 1024
  s_nop 0
  buffer_load_dwordx4 v11, s[56:59], s63 offen lds
  s_add_u32 s63, s63, 18432
  s_add_u32 m0, s62, 2048
  s_nop 0
  buffer_load_dwordx4 v11, s[56:59], s63 offen lds
  s_add_u32 s63, s63, 18432
  s_add_u32 m0, s62, 3072
  s_nop 0
  buffer_load_dwordx4 v11, s[56:59], s63 offen lds
  s_add_u32 s63, s63, 18432
  s_add_u32 m0, s62, 4096
  s_nop 0
  buffer_load_dwordx4 v11, s[56:59], s63 offen lds
  s_add_u32 s63, s63, 18432
  s_add_u32 m0, s62, 5120
  s_nop 0
  buffer_load_dwordx4 v11, s[56:59], s63 offen lds
  s_add_u32 s63, s63, 18432
  s_add_u32 m0, s62, 6144
  s_nop 0
  buffer_load_dwordx4 v11, s[56:59], s63 offen lds
  s_add_u32 s63, s63, 18432
  s_add_u32 m0, s62, 7168
  s_nop 0
  buffer_load_dwordx4 v11, s[56:59], s63 offen lds
  s_add_u32 s63, s63, 18432
  s_add_u32 m0, s62, 8192
  s_nop 0
  buffer_load_dwordx4 v11, s[56:59], s63 offen lds
  s_add_u32 s63, s63, 18432
  s_add_u32 m0, s62, 9216
  s_nop 0
  buffer_load_dwordx4 v11, s[56:59], s63 offen lds
  s_add_u32 s63, s63, 18432
  s_add_u32 m0, s62, 10240
  s_nop 0
  buffer_load_dwordx4 v11, s[56:59], s63 offen lds
  s_add_u32 s63, s63, 18432
  s_add_u32 m0, s62, 11264
  s_nop 0
  buffer_load_dwordx4 v11, s[56:59], s63 offen lds
  s_add_u32 s63, s63, 18432
  s_add_u32 m0, s62, 12288
  s_nop 0
  buffer_load_dwordx4 v11, s[56:59], s63 offen lds
  s_add_u32 s63, s63, 18432
  s_add_u32 m0, s62, 13312
  s_nop 0
  buffer_load_dwordx4 v11, s[56:59], s63 offen lds
  s_add_u32 s63, s63, 18432
  s_add_u32 m0, s62, 14336
  s_nop 0
  buffer_load_dwordx4 v11, s[56:59], s63 offen lds
  s_add_u32 s63, s63, 18432
  s_add_u32 m0, s62, 15360
  s_nop 0
  buffer_load_dwordx4 v11, s[56:59], s63 offen lds
  s_add_u32 s63, s63, 18432
  s_add_u32 m0, s62, 16384
  s_nop 0
  buffer_load_dwordx4 v11, s[56:59], s63 offen lds
  s_add_u32 s63, s63, 18432
  s_add_u32 m0, s62, 17408
  s_nop 0
  buffer_load_dwordx4 v11, s[56:59], s63 offen lds
  s_add_u32 s63, s63, 18432
  s_add_u32 m0, s62, 18432
  s_nop 0
  buffer_load_dwordx4 v11, s[56:59], s63 offen lds
  s_add_u32 s63, s63, 18432
  s_add_u32 m0, s62, 19456
  s_nop 0
  buffer_load_dwordx4 v11, s[56:59], s63 offen lds
  s_add_u32 s63, s63, 18432
  s_add_u32 m0, s62, 20480
  s_nop 0
  buffer_load_dwordx4 v11, s[56:59], s63 offen lds
  s_add_u32 s63, s63, 18432
  s_add_u32 m0, s62, 21504
  s_nop 0
  buffer_load_dwordx4 v11, s[56:59], s63 offen lds
  s_add_u32 s63, s63, 18432
  s_add_u32 m0, s62, 22528
  s_nop 0
  buffer_load_dwordx4 v11, s[56:59], s63 offen lds
  s_add_u32 s63, s63, 18432
  s_add_u32 m0, s62, 23552
  s_nop 0
  buffer_load_dwordx4 v11, s[56:59], s63 offen lds
  s_add_u32 s63, s63, 18432
  s_add_u32 m0, s62, 24576
  s_nop 0
  buffer_load_dwordx4 v11, s[56:59], s63 offen lds
  s_add_u32 s63, s63, 18432
  s_add_u32 m0, s62, 25600
  s_nop 0
  buffer_load_dwordx4 v11, s[56:59], s63 offen lds
  s_add_u32 s63, s63, 18432
  s_add_u32 m0, s62, 26624
  s_nop 0
  buffer_load_dwordx4 v11, s[56:59], s63 offen lds
  s_add_u32 s63, s63, 18432
  s_add_u32 m0, s62, 27648
  s_nop 0
  buffer_load_dwordx4 v11, s[56:59], s63 offen lds
  s_add_u32 s63, s63, 18432
  s_add_u32 m0, s62, 28672
  s_nop 0
  buffer_load_dwordx4 v11, s[56:59], s63 offen lds
  s_add_u32 s63, s63, 18432
  s_add_u32 m0, s62, 29696
  s_nop 0
  buffer_load_dwordx4 v11, s[56:59], s63 offen lds
  s_add_u32 s63, s63, 18432
  s_add_u32 m0, s62, 30720
  s_nop 0
  buffer_load_dwordx4 v11, s[56:59], s63 offen lds
  s_add_u32 s63, s63, 18432
  s_add_u32 m0, s62, 31744
  s_nop 0
  buffer_load_dwordx4 v11, s[56:59], s63 offen lds
  s_add_u32 s63, s63, 18432
  s_add_u32 m0, s62, 32768
  s_nop 0
  buffer_load_dwordx4 v11, s[56:59], s63 offen lds
  s_add_u32 s63, s63, 18432
  s_add_u32 m0, s62, 33792
  s_nop 0
  buffer_load_dwordx4 v11, s[56:59], s63 offen lds
  s_add_u32 s63, s63, 18432
  s_add_u32 m0, s62, 34816
  s_nop 0
  buffer_load_dwordx4 v11, s[56:59], s63 offen lds
  s_add_u32 s63, s63, 18432
  s_add_u32 m0, s62, 35840
  s_nop 0
  buffer_load_dwordx4 v11, s[56:59], s63 offen lds
  s_add_u32 s63, s63, 18432
  v_bfe_u32 v2, v1, 2, 2
  v_lshrrev_b32 v3, 5, v1
  v_lshlrev_b32 v3, 3, v3
  v_add_u32 v2, v2, v3
  v_lshlrev_b32 v5, 6, v2
  v_bfe_u32 v2, v1, 4, 1
  v_lshlrev_b32 v2, 5, v2
  v_add_u32 v5, v5, v2
  v_and_b32 v2, 3, v1
  v_lshlrev_b32 v2, 3, v2
  v_add_u32 v5, v5, v2
  v_add_u32 v5, s62, v5
  v_mov_b32 v156, 0x3f803f80
  v_mov_b32 v157, 0x3f803f80
  v_mov_b32 v158, 0x3f803f80
  v_mov_b32 v159, 0x3f803f80
  s_waitcnt vmcnt(0)
  ds_read_b64_tr_b16 v[112:113], v5 offset:0
  ds_read_b64_tr_b16 v[114:115], v5 offset:256
  ds_read_b64_tr_b16 v[116:117], v5 offset:1024
  ds_read_b64_tr_b16 v[118:119], v5 offset:1280
  ds_read_b64_tr_b16 v[120:121], v5 offset:2048
  ds_read_b64_tr_b16 v[122:123], v5 offset:2304
  ds_read_b64_tr_b16 v[124:125], v5 offset:3072
  ds_read_b64_tr_b16 v[126:127], v5 offset:3328
  s_waitcnt lgkmcnt(6)
  v_mfma_f32_32x32x16_bf16 v[16:31], v[112:115], v[156:159], 0
  ds_read_b64_tr_b16 v[128:129], v5 offset:4096
  ds_read_b64_tr_b16 v[130:131], v5 offset:4352
  s_waitcnt lgkmcnt(6)
  v_mfma_f32_32x32x16_bf16 v[16:31], v[116:119], v[156:159], v[16:31]
  ds_read_b64_tr_b16 v[132:133], v5 offset:5120
  ds_read_b64_tr_b16 v[134:135], v5 offset:5376
  s_waitcnt lgkmcnt(6)
  v_mfma_f32_32x32x16_bf16 v[16:31], v[120:123], v[156:159], v[16:31]
  ds_read_b64_tr_b16 v[112:113], v5 offset:6144
  ds_read_b64_tr_b16 v[114:115], v5 offset:6400
  s_waitcnt lgkmcnt(6)
  v_mfma_f32_32x32x16_bf16 v[16:31], v[124:127], v[156:159], v[16:31]
  ds_read_b64_tr_b16 v[116:117], v5 offset:7168
  ds_read_b64_tr_b16 v[118:119], v5 offset:7424
  s_waitcnt lgkmcnt(6)
  v_mfma_f32_32x32x16_bf16 v[16:31], v[128:131], v[156:159], v[16:31]
  ds_read_b64_tr_b16 v[120:121], v5 offset:8192
  ds_read_b64_tr_b16 v[122:123], v5 offset:8448
  s_waitcnt lgkmcnt(6)
  v_mfma_f32_32x32x16_bf16 v[16:31], v[132:135], v[156:159], v[16:31]
  ds_read_b64_tr_b16 v[124:125], v5 offset:9216
  ds_read_b64_tr_b16 v[126:127], v5 offset:9472
  s_waitcnt lgkmcnt(6)
  v_mfma_f32_32x32x16_bf16 v[16:31], v[112:115], v[156:159], v[16:31]
  ds_read_b64_tr_b16 v[128:129], v5 offset:10240
  ds_read_b64_tr_b16 v[130:131], v5 offset:10496
  s_waitcnt lgkmcnt(6)
  v_mfma_f32_32x32x16_bf16 v[16:31], v[116:119], v[156:159], v[16:31]
  ds_read_b64_tr_b16 v[132:133], v5 offset:11264
  ds_read_b64_tr_b16 v[134:135], v5 offset:11520
  s_waitcnt lgkmcnt(6)
  v_mfma_f32_32x32x16_bf16 v[16:31], v[120:123], v[156:159], v[16:31]
  ds_read_b64_tr_b16 v[112:113], v5 offset:12288
  ds_read_b64_tr_b16 v[114:115], v5 offset:12544
  s_waitcnt lgkmcnt(6)
  v_mfma_f32_32x32x16_bf16 v[16:31], v[124:127], v[156:159], v[16:31]
  ds_read_b64_tr_b16 v[116:117], v5 offset:13312
  ds_read_b64_tr_b16 v[118:119], v5 offset:13568
  s_waitcnt lgkmcnt(6)
  v_mfma_f32_32x32x16_bf16 v[16:31], v[128:131], v[156:159], v[16:31]
  ds_read_b64_tr_b16 v[120:121], v5 offset:14336
  ds_read_b64_tr_b16 v[122:123], v5 offset:14592
  s_waitcnt lgkmcnt(6)
  v_mfma_f32_32x32x16_bf16 v[16:31], v[132:135], v[156:159], v[16:31]
  ds_read_b64_tr_b16 v[124:125], v5 offset:15360
  ds_read_b64_tr_b16 v[126:127], v5 offset:15616
  s_waitcnt lgkmcnt(6)
  v_mfma_f32_32x32x16_bf16 v[16:31], v[112:115], v[156:159], v[16:31]
  ds_read_b64_tr_b16 v[128:129], v5 offset:16384
  ds_read_b64_tr_b16 v[130:131], v5 offset:16640
  s_waitcnt lgkmcnt(6)
  v_mfma_f32_32x32x16_bf16 v[16:31], v[116:119], v[156:159], v[16:31]
  ds_read_b64_tr_b16 v[132:133], v5 offset:17408
  ds_read_b64_tr_b16 v[134:135], v5 offset:17664
  s_waitcnt lgkmcnt(6)
  v_mfma_f32_32x32x16_bf16 v[16:31], v[120:123], v[156:159], v[16:31]
  ds_read_b64_tr_b16 v[112:113], v5 offset:18432
  ds_read_b64_tr_b16 v[114:115], v5 offset:18688
  s_waitcnt lgkmcnt(6)
  v_mfma_f32_32x32x16_bf16 v[16:31], v[124:127], v[156:159], v[16:31]
  ds_read_b64_tr_b16 v[116:117], v5 offset:19456
  ds_read_b64_tr_b16 v[118:119], v5 offset:19712
  s_waitcnt lgkmcnt(6)
  v_mfma_f32_32x32x16_bf16 v[16:31], v[128:131], v[156:159], v[16:31]
  ds_read_b64_tr_b16 v[120:121], v5 offset:20480
  ds_read_b64_tr_b16 v[122:123], v5 offset:20736
  s_waitcnt lgkmcnt(6)
  v_mfma_f32_32x32x16_bf16 v[16:31], v[132:135], v[156:159], v[16:31]
  ds_read_b64_tr_b16 v[124:125], v5 offset:21504
  ds_read_b64_tr_b16 v[126:127], v5 offset:21760
  s_waitcnt lgkmcnt(6)
  v_mfma_f32_32x32x16_bf16 v[16:31], v[112:115], v[156:159], v[16:31]
  ds_read_b64_tr_b16 v[128:129], v5 offset:22528
  ds_read_b64_tr_b16 v[130:131], v5 offset:22784
  s_waitcnt lgkmcnt(6)
  v_mfma_f32_32x32x16_bf16 v[16:31], v[116:119], v[156:159], v[16:31]
  ds_read_b64_tr_b16 v[132:133], v5 offset:23552
  ds_read_b64_tr_b16 v[134:135], v5 offset:23808
  s_waitcnt lgkmcnt(6)
  v_mfma_f32_32x32x16_bf16 v[16:31], v[120:123], v[156:159], v[16:31]
  ds_read_b64_tr_b16 v[112:113], v5 offset:24576
  ds_read_b64_tr_b16 v[114:115], v5 offset:24832
  s_waitcnt lgkmcnt(6)
  v_mfma_f32_32x32x16_bf16 v[16:31], v[124:127], v[156:159], v[16:31]
  ds_read_b64_tr_b16 v[116:117], v5 offset:25600
  ds_read_b64_tr_b16 v[118:119], v5 offset:25856
  s_waitcnt lgkmcnt(6)
  v_mfma_f32_32x32x16_bf16 v[16:31], v[128:131], v[156:159], v[16:31]
  ds_read_b64_tr_b16 v[120:121], v5 offset:26624
  ds_read_b64_tr_b16 v[122:123], v5 offset:26880
  s_waitcnt lgkmcnt(6)
  v_mfma_f32_32x32x16_bf16 v[16:31], v[132:135], v[156:159], v[16:31]
  ds_read_b64_tr_b16 v[124:125], v5 offset:27648
  ds_read_b64_tr_b16 v[126:127], v5 offset:27904
  s_waitcnt lgkmcnt(6)
  v_mfma_f32_32x32x16_bf16 v[16:31], v[112:115], v[156:159], v[16:31]
  ds_read_b64_tr_b16 v[128:129], v5 offset:28672
  ds_read_b64_tr_b16 v[130:131], v5 offset:28928
  s_waitcnt lgkmcnt(6)
  v_mfma_f32_32x32x16_bf16 v[16:31], v[116:119], v[156:159], v[16:31]
  ds_read_b64_tr_b16 v[132:133], v5 offset:29696
  ds_read_b64_tr_b16 v[134:135], v5 offset:29952
  s_waitcnt lgkmcnt(6)
  v_mfma_f32_32x32x16_bf16 v[16:31], v[120:123], v[156:159], v[16:31]
  ds_read_b64_tr_b16 v[112:113], v5 offset:30720
  ds_read_b64_tr_b16 v[114:115], v5 offset:30976
  s_waitcnt lgkmcnt(6)
  v_mfma_f32_32x32x16_bf16 v[16:31], v[124:127], v[156:159], v[16:31]
  ds_read_b64_tr_b16 v[116:117], v5 offset:31744
  ds_read_b64_tr_b16 v[118:119], v5 offset:32000
  s_waitcnt lgkmcnt(6)
  v_mfma_f32_32x32x16_bf16 v[16:31], v[128:131], v[156:159], v[16:31]
  ds_read_b64_tr_b16 v[120:121], v5 offset:32768
  ds_read_b64_tr_b16 v[122:123], v5 offset:33024
  s_waitcnt lgkmcnt(6)
  v_mfma_f32_32x32x16_bf16 v[16:31], v[132:135], v[156:159], v[16:31]
  ds_read_b64_tr_b16 v[124:125], v5 offset:33792
  ds_read_b64_tr_b16 v[126:127], v5 offset:34048
  s_waitcnt lgkmcnt(6)
  v_mfma_f32_32x32x16_bf16 v[16:31], v[112:115], v[156:159], v[16:31]
  ds_read_b64_tr_b16 v[128:129], v5 offset:34816
  ds_read_b64_tr_b16 v[130:131], v5 offset:35072
  s_waitcnt lgkmcnt(6)
  v_mfma_f32_32x32x16_bf16 v[16:31], v[116:119], v[156:159], v[16:31]
  ds_read_b64_tr_b16 v[132:133], v5 offset:35840
  ds_read_b64_tr_b16 v[134:135], v5 offset:36096
  s_waitcnt lgkmcnt(6)
  v_mfma_f32_32x32x16_bf16 v[16:31], v[120:123], v[156:159], v[16:31]
  s_waitcnt lgkmcnt(4)
  v_mfma_f32_32x32x16_bf16 v[16:31], v[124:127], v[156:159], v[16:31]
  s_waitcnt lgkmcnt(2)
  v_mfma_f32_32x32x16_bf16 v[16:31], v[128:131], v[156:159], v[16:31]
  s_waitcnt lgkmcnt(0)
  v_mfma_f32_32x32x16_bf16 v[16:31], v[132:135], v[156:159], v[16:31]
  s_add_u32 s56, s54, 14163968
  s_addc_u32 s57, s55, 0
  s_mov_b32 s58, 2304
  s_mov_b32 s59, 0x20000
  v_lshrrev_b32 v2, 5, v1
  v_lshlrev_b32 v2, 4, v2
  v_and_b32 v3, 31, v1
  v_cmp_eq_u32 vcc, 0, v3
  v_mov_b32 v3, 0x40000000
  s_nop 0
  v_cndmask_b32 v2, v3, v2, vcc
  s_lshl_b32 s63, s18, 7
  buffer_store_dwordx4 v[16:19], v2, s[56:59], s63 offen offset:0 sc1
  buffer_store_dwordx4 v[20:23], v2, s[56:59], s63 offen offset:32 sc1
  buffer_store_dwordx4 v[24:27], v2, s[56:59], s63 offen offset:64 sc1
  buffer_store_dwordx4 v[28:31], v2, s[56:59], s63 offen offset:96 sc1
  s_mov_b32 s56, s60
  s_mov_b32 s57, s61
  s_mov_b32 s58, 256
  s_mov_b32 s59, 0x20000
  v_mov_b32 v3, 0x40000000
  v_cmp_eq_u32 vcc, 0, v1
  v_mov_b32 v4, 1
  s_nop 0
  v_cndmask_b32 v2, v3, 0, vcc
  s_waitcnt vmcnt(0)
  buffer_atomic_add v4, v2, s[56:59], 0 offen sc1
L_k1_nocs:
  s_mov_b64 s[70:71], s[80:81]
  s_mov_b64 s[72:73], s[82:83]
  s_lshr_b32 s74, s2, 3
  s_lshl_b32 s74, s74, 2
  s_add_u32 s74, s74, s3
  v_lshlrev_b32 v3, 4, v1
  s_mov_b32 m0, 155648
  s_bfe_u32 s75, s2, 0x20001
  s_mul_i32 s75, s75, 589824
  s_lshl_b32 s76, s74, 10
  s_add_u32 s75, s75, s76
  s_lshr_b32 s76, s74, 1
  s_mul_i32 s76, s76, 3456
  s_and_b32 s77, s74, 1
  s_bitcmp1_b32 s2, 0
  s_movk_i32 s68, 896
  s_cselect_b32 s68, 512, s68
  s_cselect_b32 s69, 1920, 0
  s_mul_i32 s77, s77, s68
  s_add_u32 s76, s76, s77
  s_add_u32 s76, s76, s69
  s_waitcnt lgkmcnt(0)
  s_mov_b32 s64, s70
  s_mov_b32 s65, s71
  s_mov_b32 s66, 2359296
  s_mov_b32 s67, 0x20000
  buffer_load_dwordx4 v3, s[64:67], s75 offen lds
  s_add_u32 s75, s75, 131072
  buffer_load_dwordx4 v3, s[64:67], s75 offen lds
  s_add_u32 s75, s75, 131072
  buffer_load_dwordx4 v3, s[64:67], s75 offen lds
  s_add_u32 s75, s75, 131072
  buffer_load_dwordx4 v3, s[64:67], s75 offen lds
  s_add_u32 s75, s75, 131072
  buffer_load_dwordx4 v3, s[64:67], s75 offen lds
  s_add_u32 s75, s75, 131072
  s_mov_b32 s64, s72
  s_mov_b32 s65, s73
  s_mov_b32 s66, 1990656
  s_mov_b32 s67, 0x20000
  buffer_load_dwordx4 v3, s[64:67], s76 offen lds
  s_add_u32 s76, s76, 221184
  buffer_load_dwordx4 v3, s[64:67], s76 offen lds
  s_add_u32 s76, s76, 221184
  buffer_load_dwordx4 v3, s[64:67], s76 offen lds
  s_add_u32 s76, s76, 221184
  buffer_load_dwordx4 v3, s[64:67], s76 offen lds
  s_add_u32 s76, s76, 221184
  buffer_load_dwordx4 v3, s[64:67], s76 offen lds
  s_add_u32 s76, s76, 221184
  buffer_load_dwordx4 v3, s[64:67], s76 offen lds
  s_add_u32 s76, s76, 221184
  buffer_load_dwordx4 v3, s[64:67], s76 offen lds
  s_add_u32 s76, s76, 221184
  buffer_load_dwordx4 v3, s[64:67], s76 offen lds
  s_add_u32 s76, s76, 221184
  buffer_load_dwordx4 v3, s[64:67], s76 offen lds
  s_add_u32 s76, s76, 221184
  s_mov_b64 s[40:41], s[80:81]
  s_mov_b64 s[42:43], s[96:97]
  s_mov_b64 s[44:45], s[100:101]
  v_lshrrev_b32 v2, 2, v1
  v_mul_u32_u24 v12, 1152, v2
  v_and_b32 v3, 3, v1
  v_lshlrev_b32 v3, 4, v3
  v_add_u32 v12, v12, v3
  s_mul_i32 s29, s18, 36864
  s_add_u32 s30, s29, 18432
  s_waitcnt lgkmcnt(0)
  s_mov_b32 s4, s40
  s_mov_b32 s5, s41
  s_mov_b32 s6, 2359296
  s_mov_b32 s7, 0x20000
  s_mov_b32 s8, s42
  s_mov_b32 s9, s43
  s_mov_b32 s10, 1152
  s_mov_b32 s11, 0x20000
  s_add_u32 s12, s44, 14155776
  s_addc_u32 s13, s45, 0
  s_mov_b32 s14, 8192
  s_mov_b32 s15, 0x20000
  buffer_load_dwordx4 v[160:163], v3, s[8:11], 0 offen offset:0
  buffer_load_dwordx4 v[164:167], v3, s[8:11], 0 offen offset:64
  buffer_load_dwordx4 v[168:171], v3, s[8:11], 0 offen offset:128
  buffer_load_dwordx4 v[172:175], v3, s[8:11], 0 offen offset:192
  buffer_load_dwordx4 v[176:179], v3, s[8:11], 0 offen offset:256
  buffer_load_dwordx4 v[180:183], v3, s[8:11], 0 offen offset:320
  buffer_load_dwordx4 v[184:187], v3, s[8:11], 0 offen offset:384
  buffer_load_dwordx4 v[188:191], v3, s[8:11], 0 offen offset:448
  buffer_load_dwordx4 v[192:195], v3, s[8:11], 0 offen offset:512
  buffer_load_dwordx4 v[196:199], v3, s[8:11], 0 offen offset:576
  buffer_load_dwordx4 v[200:203], v3, s[8:11], 0 offen offset:640
  buffer_load_dwordx4 v[204:207], v3, s[8:11], 0 offen offset:704
  buffer_load_dwordx4 v[208:211], v3, s[8:11], 0 offen offset:768
  buffer_load_dwordx4 v[212:215], v3, s[8:11], 0 offen offset:832
  buffer_load_dwordx4 v[216:219], v3, s[8:11], 0 offen offset:896
  buffer_load_dwordx4 v[220:223], v3, s[8:11], 0 offen offset:960
  buffer_load_dwordx4 v[224:227], v3, s[8:11], 0 offen offset:1024
  buffer_load_dwordx4 v[228:231], v3, s[8:11], 0 offen offset:1088
  buffer_load_dwordx4 v[16:19], v12, s[4:7], s29 offen offset:0
  buffer_load_dwordx4 v[20:23], v12, s[4:7], s29 offen offset:64
  buffer_load_dwordx4 v[24:27], v12, s[4:7], s29 offen offset:128
  buffer_load_dwordx4 v[28:31], v12, s[4:7], s29 offen offset:192
  buffer_load_dwordx4 v[32:35], v12, s[4:7], s29 offen offset:256
  buffer_load_dwordx4 v[36:39], v12, s[4:7], s29 offen offset:320
  buffer_load_dwordx4 v[40:43], v12, s[4:7], s29 offen offset:384
  buffer_load_dwordx4 v[44:47], v12, s[4:7], s29 offen offset:448
  buffer_load_dwordx4 v[48:51], v12, s[4:7], s29 offen offset:512
  buffer_load_dwordx4 v[52:55], v12, s[4:7], s29 offen offset:576
  buffer_load_dwordx4 v[56:59], v12, s[4:7], s29 offen offset:640
  buffer_load_dwordx4 v[60:63], v12, s[4:7], s29 offen offset:704
  buffer_load_dwordx4 v[64:67], v12, s[4:7], s29 offen offset:768
  buffer_load_dwordx4 v[68:71], v12, s[4:7], s29 offen offset:832
  buffer_load_dwordx4 v[72:75], v12, s[4:7], s29 offen offset:896
  buffer_load_dwordx4 v[76:79], v12, s[4:7], s29 offen offset:960
  buffer_load_dwordx4 v[80:83], v12, s[4:7], s29 offen offset:1024
  buffer_load_dwordx4 v[84:87], v12, s[4:7], s29 offen offset:1088
  buffer_load_dwordx4 v[88:91], v12, s[4:7], s30 offen offset:0
  buffer_load_dwordx4 v[92:95], v12, s[4:7], s30 offen offset:64
  buffer_load_dwordx4 v[96:99], v12, s[4:7], s30 offen offset:128
  buffer_load_dwordx4 v[100:103], v12, s[4:7], s30 offen offset:192
  buffer_load_dwordx4 v[104:107], v12, s[4:7], s30 offen offset:256
  buffer_load_dwordx4 v[108:111], v12, s[4:7], s30 offen offset:320
  buffer_load_dwordx4 v[112:115], v12, s[4:7], s30 offen offset:384
  buffer_load_dwordx4 v[116:119], v12, s[4:7], s30 offen offset:448
  buffer_load_dwordx4 v[120:123], v12, s[4:7], s30 offen offset:512
  buffer_load_dwordx4 v[124:127], v12, s[4:7], s30 offen offset:576
  buffer_load_dwordx4 v[128:131], v12, s[4:7], s30 offen offset:640
  buffer_load_dwordx4 v[132:135], v12, s[4:7], s30 offen offset:704
  buffer_load_dwordx4 v[136:139], v12, s[4:7], s30 offen offset:768
  buffer_load_dwordx4 v[140:143], v12, s[4:7], s30 offen offset:832
  buffer_load_dwordx4 v[144:147], v12, s[4:7], s30 offen offset:896
  buffer_load_dwordx4 v[148:151], v12, s[4:7], s30 offen offset:960
  buffer_load_dwordx4 v[152:155], v12, s[4:7], s30 offen offset:1024
  buffer_load_dwordx4 v[156:159], v12, s[4:7], s30 offen offset:1088
  v_mov_b32 v8, 0
  v_mov_b32 v9, 0
  v_mov_b32 v10, 0
  v_mov_b32 v11, 0
  s_waitcnt vmcnt(35)
  v_dot2c_f32_bf16 v8, v16, v160
  v_dot2c_f32_bf16 v9, v17, v161
  v_dot2c_f32_bf16 v8, v18, v162
  v_dot2c_f32_bf16 v9, v19, v163
  s_waitcnt vmcnt(34)
  v_dot2c_f32_bf16 v8, v20, v164
  v_dot2c_f32_bf16 v9, v21, v165
  v_dot2c_f32_bf16 v8, v22, v166
  v_dot2c_f32_bf16 v9, v23, v167
  s_waitcnt vmcnt(33)
  v_dot2c_f32_bf16 v8, v24, v168
  v_dot2c_f32_bf16 v9, v25, v169
  v_dot2c_f32_bf16 v8, v26, v170
  v_dot2c_f32_bf16 v9, v27, v171
  s_waitcnt vmcnt(32)
  v_dot2c_f32_bf16 v8, v28, v172
  v_dot2c_f32_bf16 v9, v29, v173
  v_dot2c_f32_bf16 v8, v30, v174
  v_dot2c_f32_bf16 v9, v31, v175
  s_waitcnt vmcnt(31)
  v_dot2c_f32_bf16 v8, v32, v176
  v_dot2c_f32_bf16 v9, v33, v177
  v_dot2c_f32_bf16 v8, v34, v178
  v_dot2c_f32_bf16 v9, v35, v179
  s_waitcnt vmcnt(30)
  v_dot2c_f32_bf16 v8, v36, v180
  v_dot2c_f32_bf16 v9, v37, v181
  v_dot2c_f32_bf16 v8, v38, v182
  v_dot2c_f32_bf16 v9, v39, v183
  s_waitcnt vmcnt(29)
  v_dot2c_f32_bf16 v8, v40, v184
  v_dot2c_f32_bf16 v9, v41, v185
  v_dot2c_f32_bf16 v8, v42, v186
  v_dot2c_f32_bf16 v9, v43, v187
  s_waitcnt vmcnt(28)
  v_dot2c_f32_bf16 v8, v44, v188
  v_dot2c_f32_bf16 v9, v45, v189
  v_dot2c_f32_bf16 v8, v46, v190
  v_dot2c_f32_bf16 v9, v47, v191
  s_waitcnt vmcnt(27)
  v_dot2c_f32_bf16 v8, v48, v192
  v_dot2c_f32_bf16 v9, v49, v193
  v_dot2c_f32_bf16 v8, v50, v194
  v_dot2c_f32_bf16 v9, v51, v195
  s_waitcnt vmcnt(26)
  v_dot2c_f32_bf16 v8, v52, v196
  v_dot2c_f32_bf16 v9, v53, v197
  v_dot2c_f32_bf16 v8, v54, v198
  v_dot2c_f32_bf16 v9, v55, v199
  s_waitcnt vmcnt(25)
  v_dot2c_f32_bf16 v8, v56, v200
  v_dot2c_f32_bf16 v9, v57, v201
  v_dot2c_f32_bf16 v8, v58, v202
  v_dot2c_f32_bf16 v9, v59, v203
  s_waitcnt vmcnt(24)
  v_dot2c_f32_bf16 v8, v60, v204
  v_dot2c_f32_bf16 v9, v61, v205
  v_dot2c_f32_bf16 v8, v62, v206
  v_dot2c_f32_bf16 v9, v63, v207
  s_waitcnt vmcnt(23)
  v_dot2c_f32_bf16 v8, v64, v208
  v_dot2c_f32_bf16 v9, v65, v209
  v_dot2c_f32_bf16 v8, v66, v210
  v_dot2c_f32_bf16 v9, v67, v211
  s_waitcnt vmcnt(22)
  v_dot2c_f32_bf16 v8, v68, v212
  v_dot2c_f32_bf16 v9, v69, v213
  v_dot2c_f32_bf16 v8, v70, v214
  v_dot2c_f32_bf16 v9, v71, v215
  s_waitcnt vmcnt(21)
  v_dot2c_f32_bf16 v8, v72, v216
  v_dot2c_f32_bf16 v9, v73, v217
  v_dot2c_f32_bf16 v8, v74, v218
  v_dot2c_f32_bf16 v9, v75, v219
  s_waitcnt vmcnt(20)
  v_dot2c_f32_bf16 v8, v76, v220
  v_dot2c_f32_bf16 v9, v77, v221
  v_dot2c_f32_bf16 v8, v78, v222
  v_dot2c_f32_bf16 v9, v79, v223
  s_waitcnt vmcnt(19)
  v_dot2c_f32_bf16 v8, v80, v224
  v_dot2c_f32_bf16 v9, v81, v225
  v_dot2c_f32_bf16 v8, v82, v226
  v_dot2c_f32_bf16 v9, v83, v227
  s_waitcnt vmcnt(18)
  v_dot2c_f32_bf16 v8, v84, v228
  v_dot2c_f32_bf16 v9, v85, v229
  v_dot2c_f32_bf16 v8, v86, v230
  v_dot2c_f32_bf16 v9, v87, v231
  s_waitcnt vmcnt(17)
  v_dot2c_f32_bf16 v10, v88, v160
  v_dot2c_f32_bf16 v11, v89, v161
  v_dot2c_f32_bf16 v10, v90, v162
  v_dot2c_f32_bf16 v11, v91, v163
  s_waitcnt vmcnt(16)
  v_dot2c_f32_bf16 v10, v92, v164
  v_dot2c_f32_bf16 v11, v93, v165
  v_dot2c_f32_bf16 v10, v94, v166
  v_dot2c_f32_bf16 v11, v95, v167
  s_waitcnt vmcnt(15)
  v_dot2c_f32_bf16 v10, v96, v168
  v_dot2c_f32_bf16 v11, v97, v169
  v_dot2c_f32_bf16 v10, v98, v170
  v_dot2c_f32_bf16 v11, v99, v171
  s_waitcnt vmcnt(14)
  v_dot2c_f32_bf16 v10, v100, v172
  v_dot2c_f32_bf16 v11, v101, v173
  v_dot2c_f32_bf16 v10, v102, v174
  v_dot2c_f32_bf16 v11, v103, v175
  s_waitcnt vmcnt(13)
  v_dot2c_f32_bf16 v10, v104, v176
  v_dot2c_f32_bf16 v11, v105, v177
  v_dot2c_f32_bf16 v10, v106, v178
  v_dot2c_f32_bf16 v11, v107, v179
  s_waitcnt vmcnt(12)
  v_dot2c_f32_bf16 v10, v108, v180
  v_dot2c_f32_bf16 v11, v109, v181
  v_dot2c_f32_bf16 v10, v110, v182
  v_dot2c_f32_bf16 v11, v111, v183
  s_waitcnt vmcnt(11)
  v_dot2c_f32_bf16 v10, v112, v184
  v_dot2c_f32_bf16 v11, v113, v185
  v_dot2c_f32_bf16 v10, v114, v186
  v_dot2c_f32_bf16 v11, v115, v187
  s_waitcnt vmcnt(10)
  v_dot2c_f32_bf16 v10, v116, v188
  v_dot2c_f32_bf16 v11, v117, v189
  v_dot2c_f32_bf16 v10, v118, v190
  v_dot2c_f32_bf16 v11, v119, v191
  s_waitcnt vmcnt(9)
  v_dot2c_f32_bf16 v10, v120, v192
  v_dot2c_f32_bf16 v11, v121, v193
  v_dot2c_f32_bf16 v10, v122, v194
  v_dot2c_f32_bf16 v11, v123, v195
  s_waitcnt vmcnt(8)
  v_dot2c_f32_bf16 v10, v124, v196
  v_dot2c_f32_bf16 v11, v125, v197
  v_dot2c_f32_bf16 v10, v126, v198
  v_dot2c_f32_bf16 v11, v127, v199
  s_waitcnt vmcnt(7)
  v_dot2c_f32_bf16 v10, v128, v200
  v_dot2c_f32_bf16 v11, v129, v201
  v_dot2c_f32_bf16 v10, v130, v202
  v_dot2c_f32_bf16 v11, v131, v203
  s_waitcnt vmcnt(6)
  v_dot2c_f32_bf16 v10, v132, v204
  v_dot2c_f32_bf16 v11, v133, v205
  v_dot2c_f32_bf16 v10, v134, v206
  v_dot2c_f32_bf16 v11, v135, v207
  s_waitcnt vmcnt(5)
  v_dot2c_f32_bf16 v10, v136, v208
  v_dot2c_f32_bf16 v11, v137, v209
  v_dot2c_f32_bf16 v10, v138, v210
  v_dot2c_f32_bf16 v11, v139, v211
  s_waitcnt vmcnt(4)
  v_dot2c_f32_bf16 v10, v140, v212
  v_dot2c_f32_bf16 v11, v141, v213
  v_dot2c_f32_bf16 v10, v142, v214
  v_dot2c_f32_bf16 v11, v143, v215
  s_waitcnt vmcnt(3)
  v_dot2c_f32_bf16 v10, v144, v216
  v_dot2c_f32_bf16 v11, v145, v217
  v_dot2c_f32_bf16 v10, v146, v218
  v_dot2c_f32_bf16 v11, v147, v219
  s_waitcnt vmcnt(2)
  v_dot2c_f32_bf16 v10, v148, v220
  v_dot2c_f32_bf16 v11, v149, v221
  v_dot2c_f32_bf16 v10, v150, v222
  v_dot2c_f32_bf16 v11, v151, v223
  s_waitcnt vmcnt(1)
  v_dot2c_f32_bf16 v10, v152, v224
  v_dot2c_f32_bf16 v11, v153, v225
  v_dot2c_f32_bf16 v10, v154, v226
  v_dot2c_f32_bf16 v11, v155, v227
  s_waitcnt vmcnt(0)
  v_dot2c_f32_bf16 v10, v156, v228
  v_dot2c_f32_bf16 v11, v157, v229
  v_dot2c_f32_bf16 v10, v158, v230
  v_dot2c_f32_bf16 v11, v159, v231
  v_add_f32 v8, v8, v9
  s_nop 1
  v_add_f32_dpp v8, v8, v8 quad_perm:[1,0,3,2] row_mask:0xf bank_mask:0xf
  s_nop 1
  v_add_f32_dpp v8, v8, v8 quad_perm:[2,3,0,1] row_mask:0xf bank_mask:0xf
  v_mul_f32 v8, 0xbfb8aa3b, v8
  v_exp_f32 v8, v8
  s_nop 0
  v_add_f32 v8, 1.0, v8
  v_rcp_f32 v8, v8
  v_add_f32 v10, v10, v11
  s_nop 1
  v_add_f32_dpp v10, v10, v10 quad_perm:[1,0,3,2] row_mask:0xf bank_mask:0xf
  s_nop 1
  v_add_f32_dpp v10, v10, v10 quad_perm:[2,3,0,1] row_mask:0xf bank_mask:0xf
  v_mul_f32 v10, 0xbfb8aa3b, v10
  v_exp_f32 v10, v10
  s_nop 0
  v_add_f32 v10, 1.0, v10
  v_rcp_f32 v10, v10
  v_lshrrev_b32 v2, 2, v1
  s_lshl_b32 s27, s18, 5
  v_add_u32 v2, s27, v2
  v_lshlrev_b32 v2, 2, v2
  buffer_store_dword v8, v2, s[12:15], 0 offen
  buffer_store_dword v10, v2, s[12:15], 0 offen offset:64
  s_add_u32 s56, s44, 14352384
  s_addc_u32 s57, s45, 0
  s_mov_b32 s58, 65536
  s_mov_b32 s59, 0x20000
  v_mov_b32 v16, 0
  v_mov_b32 v17, 0
  v_mov_b32 v18, 0
  v_mov_b32 v19, 0
  v_lshlrev_b32 v3, 4, v1
  s_lshl_b32 s27, s18, 10
  buffer_store_dwordx4 v[16:19], v3, s[56:59], s27 offen
  s_cmp_lt_u32 s18, 20
  s_cbranch_scc1 L_k1_nopf
  s_sub_u32 s20, s18, 20
  v_lshlrev_b32 v3, 4, v1
  s_mov_b64 s[24:25], s[90:91]
  s_waitcnt lgkmcnt(0)
  s_mov_b32 s4, s24
  s_mov_b32 s5, s25
  s_mov_b32 s6, 663552
  s_mov_b32 s7, 0x20000
  s_lshl_b32 s24, s20, 10
  s_mov_b32 s25, 15
  s_mov_b32 m0, 155648
L_pf_w2:
  s_nop 0
  buffer_load_dwordx4 v3, s[4:7], s24 offen lds
  s_add_u32 s24, s24, 45056
  s_sub_u32 s25, s25, 1
  s_cmp_lg_u32 s25, 0
  s_cbranch_scc1 L_pf_w2
  s_mov_b64 s[24:25], s[84:85]
  s_waitcnt lgkmcnt(0)
  s_mov_b32 s8, s24
  s_mov_b32 s9, s25
  s_mov_b32 s10, 663552
  s_mov_b32 s11, 0x20000
  s_lshl_b32 s24, s20, 10
  s_mov_b32 s25, 15
  s_mov_b32 m0, 155648
L_pf_wo:
  s_nop 0
  buffer_load_dwordx4 v3, s[8:11], s24 offen lds
  s_add_u32 s24, s24, 45056
  s_sub_u32 s25, s25, 1
  s_cmp_lg_u32 s25, 0
  s_cbranch_scc1 L_pf_wo
L_k1_nopf:
L_k1_end:
  s_endpgm

.globl k234_kernel
.p2align 8
.type k234_kernel,@function
k234_kernel:
  s_cmp_ge_u32 s2, 256
  s_cbranch_scc1 L_k3_end
  s_load_dwordx16 s[80:95], s[0:1], 0
  s_load_dwordx4 s[96:99], s[0:1], 64
  s_load_dwordx2 s[100:101], s[0:1], 88
  v_lshrrev_b32 v2, 6, v0
  v_and_b32 v1, 63, v0
  v_readfirstlane_b32 s3, v2
  s_getpc_b64 s[64:65]
L_pc_k234_kernel_1:
  s_sub_u32 s64, s64, L_pc_k234_kernel_1-k234_kernel
  s_subb_u32 s65, s65, 0
  s_mov_b32 s66, L_k3_end-k234_kernel
  s_mov_b32 s67, 0x20000
  s_lshr_b32 s68, s2, 3
  s_lshl_b32 s68, s68, 2
  s_add_u32 s68, s68, s3
  s_lshl_b32 s68, s68, 10
  v_lshlrev_b32 v2, 4, v1
  buffer_load_dwordx4 v[252:255], v2, s[64:67], s68 offen
  s_waitcnt lgkmcnt(0)
  s_mov_b64 s[76:77], s[100:101]
  s_waitcnt lgkmcnt(0)
  s_add_u32 s72, s76, 14352384
  s_addc_u32 s73, s77, 0
  s_mov_b32 s74, 65536
  s_mov_b32 s75, 0x20000
  s_and_b32 s38, s2, 7
  s_lshr_b32 s39, s2, 3
  s_bitcmp1_b32 s39, 0
  s_cbranch_scc1 L_k3_b
  s_lshr_b32 s39, s39, 1
  s_mov_b64 s[40:41], s[100:101]
  s_lshl_b32 s16, s38, 2
  s_lshr_b32 s19, s39, 2
  s_add_u32 s16, s16, s19
  s_and_b32 s17, s39, 3
  s_lshl_b32 s18, s17, 4
  s_lshl_b32 s19, s3, 2
  s_add_u32 s18, s18, s19
  v_add_u32 v2, 0, v1
  v_mul_u32_u24 v3, 911, v2
  v_lshrrev_b32 v3, 16, v3
  v_mul_u32_u24 v4, 72, v3
  v_sub_u32 v2, v2, v4
  v_mul_u32_u24 v4, 73728, v3
  v_lshl_add_u32 v192, v2, 4, v4
  v_mul_u32_u24 v4, 3641, v2
  v_lshrrev_b32 v4, 16, v4
  v_mul_u32_u24 v5, 18, v4
  v_sub_u32 v2, v2, v5
  v_mul_u32_u24 v4, 9216, v4
  v_lshl_add_u32 v2, v2, 4, v4
  v_mul_u32_u24 v3, 36864, v3
  v_add_u32 v201, v2, v3
  v_add_u32 v2, 64, v1
  v_mul_u32_u24 v3, 911, v2
  v_lshrrev_b32 v3, 16, v3
  v_mul_u32_u24 v4, 72, v3
  v_sub_u32 v2, v2, v4
  v_mul_u32_u24 v4, 73728, v3
  v_lshl_add_u32 v193, v2, 4, v4
  v_mul_u32_u24 v4, 3641, v2
  v_lshrrev_b32 v4, 16, v4
  v_mul_u32_u24 v5, 18, v4
  v_sub_u32 v2, v2, v5
  v_mul_u32_u24 v4, 9216, v4
  v_lshl_add_u32 v2, v2, 4, v4
  v_mul_u32_u24 v3, 36864, v3
  v_add_u32 v202, v2, v3
  v_add_u32 v2, 128, v1
  v_mul_u32_u24 v3, 911, v2
  v_lshrrev_b32 v3, 16, v3
  v_mul_u32_u24 v4, 72, v3
  v_sub_u32 v2, v2, v4
  v_mul_u32_u24 v4, 73728, v3
  v_lshl_add_u32 v194, v2, 4, v4
  v_mul_u32_u24 v4, 3641, v2
  v_lshrrev_b32 v4, 16, v4
  v_mul_u32_u24 v5, 18, v4
  v_sub_u32 v2, v2, v5
  v_mul_u32_u24 v4, 9216, v4
  v_lshl_add_u32 v2, v2, 4, v4
  v_mul_u32_u24 v3, 36864, v3
  v_add_u32 v203, v2, v3
  v_add_u32 v2, 192, v1
  v_mul_u32_u24 v3, 911, v2
  v_lshrrev_b32 v3, 16, v3
  v_mul_u32_u24 v4, 72, v3
  v_sub_u32 v2, v2, v4
  v_mul_u32_u24 v4, 73728, v3
  v_lshl_add_u32 v195, v2, 4, v4
  v_mul_u32_u24 v4, 3641, v2
  v_lshrrev_b32 v4, 16, v4
  v_mul_u32_u24 v5, 18, v4
  v_sub_u32 v2, v2, v5
  v_mul_u32_u24 v4, 9216, v4
  v_lshl_add_u32 v2, v2, 4, v4
  v_mul_u32_u24 v3, 36864, v3
  v_add_u32 v204, v2, v3
  v_add_u32 v2, 256, v1
  v_mul_u32_u24 v3, 911, v2
  v_lshrrev_b32 v3, 16, v3
  v_mul_u32_u24 v4, 72, v3
  v_sub_u32 v2, v2, v4
  v_mul_u32_u24 v4, 73728, v3
  v_lshl_add_u32 v196, v2, 4, v4
  v_mul_u32_u24 v4, 3641, v2
  v_lshrrev_b32 v4, 16, v4
  v_mul_u32_u24 v5, 18, v4
  v_sub_u32 v2, v2, v5
  v_mul_u32_u24 v4, 9216, v4
  v_lshl_add_u32 v2, v2, 4, v4
  v_mul_u32_u24 v3, 36864, v3
  v_add_u32 v205, v2, v3
  v_add_u32 v2, 320, v1
  v_mul_u32_u24 v3, 911, v2
  v_lshrrev_b32 v3, 16, v3
  v_mul_u32_u24 v4, 72, v3
  v_sub_u32 v2, v2, v4
  v_mul_u32_u24 v4, 73728, v3
  v_lshl_add_u32 v197, v2, 4, v4
  v_mul_u32_u24 v4, 3641, v2
  v_lshrrev_b32 v4, 16, v4
  v_mul_u32_u24 v5, 18, v4
  v_sub_u32 v2, v2, v5
  v_mul_u32_u24 v4, 9216, v4
  v_lshl_add_u32 v2, v2, 4, v4
  v_mul_u32_u24 v3, 36864, v3
  v_add_u32 v206, v2, v3
  v_add_u32 v2, 384, v1
  v_mul_u32_u24 v3, 911, v2
  v_lshrrev_b32 v3, 16, v3
  v_mul_u32_u24 v4, 72, v3
  v_sub_u32 v2, v2, v4
  v_mul_u32_u24 v4, 73728, v3
  v_lshl_add_u32 v198, v2, 4, v4
  v_mul_u32_u24 v4, 3641, v2
  v_lshrrev_b32 v4, 16, v4
  v_mul_u32_u24 v5, 18, v4
  v_sub_u32 v2, v2, v5
  v_mul_u32_u24 v4, 9216, v4
  v_lshl_add_u32 v2, v2, 4, v4
  v_mul_u32_u24 v3, 36864, v3
  v_add_u32 v207, v2, v3
  v_add_u32 v2, 448, v1
  v_mul_u32_u24 v3, 911, v2
  v_lshrrev_b32 v3, 16, v3
  v_mul_u32_u24 v4, 72, v3
  v_sub_u32 v2, v2, v4
  v_mul_u32_u24 v4, 73728, v3
  v_lshl_add_u32 v199, v2, 4, v4
  v_mul_u32_u24 v4, 3641, v2
  v_lshrrev_b32 v4, 16, v4
  v_mul_u32_u24 v5, 18, v4
  v_sub_u32 v2, v2, v5
  v_mul_u32_u24 v4, 9216, v4
  v_lshl_add_u32 v2, v2, 4, v4
  v_mul_u32_u24 v3, 36864, v3
  v_add_u32 v208, v2, v3
  v_add_u32 v2, 512, v1
  v_mul_u32_u24 v3, 911, v2
  v_lshrrev_b32 v3, 16, v3
  v_mul_u32_u24 v4, 72, v3
  v_sub_u32 v2, v2, v4
  v_mul_u32_u24 v4, 73728, v3
  v_lshl_add_u32 v200, v2, 4, v4
  v_mul_u32_u24 v4, 3641, v2
  v_lshrrev_b32 v4, 16, v4
  v_mul_u32_u24 v5, 18, v4
  v_sub_u32 v2, v2, v5
  v_mul_u32_u24 v4, 9216, v4
  v_lshl_add_u32 v2, v2, 4, v4
  v_mul_u32_u24 v3, 36864, v3
  v_add_u32 v209, v2, v3
  s_waitcnt lgkmcnt(0)
  s_mov_b32 s4, s40
  s_mov_b32 s5, s41
  s_mov_b32 s6, 4718592
  s_mov_b32 s7, 0x20000
  s_add_u32 s8, s40, 4718592
  s_addc_u32 s9, s41, 0
  s_mov_b32 s10, 2359296
  s_mov_b32 s11, 0x20000
  s_add_u32 s12, s40, 11796480
  s_addc_u32 s13, s41, 0
  s_mov_b32 s14, 2359296
  s_mov_b32 s15, 0x20000
  s_add_u32 s28, s40, 14417920
  s_addc_u32 s29, s41, 0
  s_mov_b32 s30, 262144
  s_mov_b32 s31, 0x20000
  s_add_u32 s19, s3, 0
  s_mul_i32 s23, s19, 589824
  s_mul_i32 s22, s16, 1152
  s_add_u32 s23, s23, s22
  s_add_u32 s23, s23, 36864
  s_mul_i32 s24, s19, 294912
  s_mul_i32 s22, s16, 288
  s_add_u32 s24, s24, s22
  s_mul_i32 s22, s19, 9216
  s_add_u32 m0, s22, 0
  s_nop 0
  buffer_load_dwordx4 v192, s[4:7], s23 offen lds
  s_add_u32 m0, s22, 1024
  s_nop 0
  buffer_load_dwordx4 v193, s[4:7], s23 offen lds
  s_add_u32 m0, s22, 2048
  s_nop 0
  buffer_load_dwordx4 v194, s[4:7], s23 offen lds
  s_add_u32 m0, s22, 3072
  s_nop 0
  buffer_load_dwordx4 v195, s[4:7], s23 offen lds
  s_add_u32 m0, s22, 4096
  s_nop 0
  buffer_load_dwordx4 v196, s[4:7], s23 offen lds
  s_add_u32 m0, s22, 5120
  s_nop 0
  buffer_load_dwordx4 v197, s[4:7], s23 offen lds
  s_add_u32 m0, s22, 6144
  s_nop 0
  buffer_load_dwordx4 v198, s[4:7], s23 offen lds
  s_add_u32 m0, s22, 7168
  s_nop 0
  buffer_load_dwordx4 v199, s[4:7], s23 offen lds
  s_add_u32 m0, s22, 8192
  s_nop 0
  buffer_load_dwordx4 v200, s[4:7], s23 offen lds
  s_add_u32 m0, s22, 73728
  s_nop 0
  buffer_load_dwordx4 v201, s[8:11], s24 offen lds
  s_add_u32 m0, s22, 74752
  s_nop 0
  buffer_load_dwordx4 v202, s[8:11], s24 offen lds
  s_add_u32 m0, s22, 75776
  s_nop 0
  buffer_load_dwordx4 v203, s[8:11], s24 offen lds
  s_add_u32 m0, s22, 76800
  s_nop 0
  buffer_load_dwordx4 v204, s[8:11], s24 offen lds
  s_add_u32 m0, s22, 77824
  s_nop 0
  buffer_load_dwordx4 v205, s[8:11], s24 offen lds
  s_add_u32 m0, s22, 78848
  s_nop 0
  buffer_load_dwordx4 v206, s[8:11], s24 offen lds
  s_add_u32 m0, s22, 79872
  s_nop 0
  buffer_load_dwordx4 v207, s[8:11], s24 offen lds
  s_add_u32 m0, s22, 80896
  s_nop 0
  buffer_load_dwordx4 v208, s[8:11], s24 offen lds
  s_add_u32 m0, s22, 81920
  s_nop 0
  buffer_load_dwordx4 v209, s[8:11], s24 offen lds
  v_and_b32 v2, 31, v1
  v_lshlrev_b32 v2, 2, v2
  v_lshrrev_b32 v3, 5, v1
  v_lshl_add_u32 v3, v3, 9, v2
  s_add_u32 s19, s18, 0
  s_mul_i32 s19, s19, 73728
  s_mul_i32 s23, s16, 1152
  s_add_u32 s19, s19, s23
  buffer_load_dword v16, v3, s[4:7], s19 offen offset:0
  buffer_load_dword v17, v3, s[4:7], s19 offen offset:128
  buffer_load_dword v18, v3, s[4:7], s19 offen offset:256
  buffer_load_dword v19, v3, s[4:7], s19 offen offset:384
  buffer_load_dword v20, v2, s[4:7], s19 offen offset:1024
  s_add_u32 s19, s18, 1
  s_mul_i32 s19, s19, 73728
  s_mul_i32 s23, s16, 1152
  s_add_u32 s19, s19, s23
  buffer_load_dword v24, v3, s[4:7], s19 offen offset:0
  buffer_load_dword v25, v3, s[4:7], s19 offen offset:128
  buffer_load_dword v26, v3, s[4:7], s19 offen offset:256
  buffer_load_dword v27, v3, s[4:7], s19 offen offset:384
  buffer_load_dword v28, v2, s[4:7], s19 offen offset:1024
  s_add_u32 s19, s18, 2
  s_mul_i32 s19, s19, 73728
  s_mul_i32 s23, s16, 1152
  s_add_u32 s19, s19, s23
  buffer_load_dword v32, v3, s[4:7], s19 offen offset:0
  buffer_load_dword v33, v3, s[4:7], s19 offen offset:128
  buffer_load_dword v34, v3, s[4:7], s19 offen offset:256
  buffer_load_dword v35, v3, s[4:7], s19 offen offset:384
  buffer_load_dword v36, v2, s[4:7], s19 offen offset:1024
  s_add_u32 s19, s18, 3
  s_mul_i32 s19, s19, 73728
  s_mul_i32 s23, s16, 1152
  s_add_u32 s19, s19, s23
  buffer_load_dword v40, v3, s[4:7], s19 offen offset:0
  buffer_load_dword v41, v3, s[4:7], s19 offen offset:128
  buffer_load_dword v42, v3, s[4:7], s19 offen offset:256
  buffer_load_dword v43, v3, s[4:7], s19 offen offset:384
  buffer_load_dword v44, v2, s[4:7], s19 offen offset:1024
  s_add_u32 s19, s3, 4
  s_mul_i32 s23, s19, 589824
  s_mul_i32 s22, s16, 1152
  s_add_u32 s23, s23, s22
  s_add_u32 s23, s23, 36864
  s_mul_i32 s24, s19, 294912
  s_mul_i32 s22, s16, 288
  s_add_u32 s24, s24, s22
  s_mul_i32 s22, s19, 9216
  s_add_u32 m0, s22, 0
  s_nop 0
  buffer_load_dwordx4 v192, s[4:7], s23 offen lds
  s_add_u32 m0, s22, 1024
  s_nop 0
  buffer_load_dwordx4 v193, s[4:7], s23 offen lds
  s_add_u32 m0, s22, 2048
  s_nop 0
  buffer_load_dwordx4 v194, s[4:7], s23 offen lds
  s_add_u32 m0, s22, 3072
  s_nop 0
  buffer_load_dwordx4 v195, s[4:7], s23 offen lds
  s_add_u32 m0, s22, 4096
  s_nop 0
  buffer_load_dwordx4 v196, s[4:7], s23 offen lds
  s_add_u32 m0, s22, 5120
  s_nop 0
  buffer_load_dwordx4 v197, s[4:7], s23 offen lds
  s_add_u32 m0, s22, 6144
  s_nop 0
  buffer_load_dwordx4 v198, s[4:7], s23 offen lds
  s_add_u32 m0, s22, 7168
  s_nop 0
  buffer_load_dwordx4 v199, s[4:7], s23 offen lds
  s_add_u32 m0, s22, 8192
  s_nop 0
  buffer_load_dwordx4 v200, s[4:7], s23 offen lds
  s_add_u32 m0, s22, 73728
  s_nop 0
  buffer_load_dwordx4 v201, s[8:11], s24 offen lds
  s_add_u32 m0, s22, 74752
  s_nop 0
  buffer_load_dwordx4 v202, s[8:11], s24 offen lds
  s_add_u32 m0, s22, 75776
  s_nop 0
  buffer_load_dwordx4 v203, s[8:11], s24 offen lds
  s_add_u32 m0, s22, 76800
  s_nop 0
  buffer_load_dwordx4 v204, s[8:11], s24 offen lds
  s_add_u32 m0, s22, 77824
  s_nop 0
  buffer_load_dwordx4 v205, s[8:11], s24 offen lds
  s_add_u32 m0, s22, 78848
  s_nop 0
  buffer_load_dwordx4 v206, s[8:11], s24 offen lds
  s_add_u32 m0, s22, 79872
  s_nop 0
  buffer_load_dwordx4 v207, s[8:11], s24 offen lds
  s_add_u32 m0, s22, 80896
  s_nop 0
  buffer_load_dwordx4 v208, s[8:11], s24 offen lds
  s_add_u32 m0, s22, 81920
  s_nop 0
  buffer_load_dwordx4 v209, s[8:11], s24 offen lds
  v_lshlrev_b32 v2, 4, v1
  v_mov_b32 v80, 0x3f803f80
  v_mov_b32 v81, 0x3f803f80
  v_mov_b32 v82, 0x3f803f80
  v_mov_b32 v83, 0x3f803f80
  v_mov_b32 v84, 0
  v_mov_b32 v85, 0
  v_mov_b32 v86, 0
  v_mov_b32 v87, 0
  s_cmp_eq_u32 s3, 0
  s_cbranch_scc0 L_att_noconst
  v_add_u32 v3, 147456, v2
  ds_write_b128 v3, v[80:83]
  ds_write_b128 v3, v[84:87] offset:1024
  s_waitcnt lgkmcnt(0)
L_att_noconst:
  v_mov_b32 v53, 0x3f803f80
  v_mov_b32 v54, 0x3f803f80
  v_mov_b32 v55, 0
  v_mov_b32 v61, 0x3f803f80
  v_mov_b32 v62, 0x3f803f80
  v_mov_b32 v63, 0
  v_cmp_gt_u32 vcc, 32, v1
  s_waitcnt vmcnt(18)
  s_nop 0
  v_cndmask_b32 v20, 0, v20, vcc
  v_mov_b32 v21, 0
  v_mov_b32 v22, 0
  v_mov_b32 v23, 0
  v_cndmask_b32 v28, 0, v28, vcc
  v_mov_b32 v29, 0
  v_mov_b32 v30, 0
  v_mov_b32 v31, 0
  v_cndmask_b32 v36, 0, v36, vcc
  v_mov_b32 v37, 0
  v_mov_b32 v38, 0
  v_mov_b32 v39, 0
  v_cndmask_b32 v44, 0, v44, vcc
  v_mov_b32 v45, 0
  v_mov_b32 v46, 0
  v_mov_b32 v47, 0
  s_mov_b32 s21, 0
  s_barrier
  s_mov_b64 s[32:33], s[92:93]
  s_mov_b64 s[34:35], s[94:95]
  s_lshl_b32 s36, s39, 3
  s_add_u32 s36, s36, s38
  s_lshl_b32 s36, s36, 2
  s_add_u32 s36, s36, s3
  s_and_b32 s37, s36, 7
  s_mul_i32 s37, s37, 663552
  s_waitcnt lgkmcnt(0)
  s_mov_b32 s44, s32
  s_mov_b32 s45, s33
  s_mov_b32 s46, 5308416
  s_mov_b32 s47, 0x20000
  s_add_u32 s48, s34, s37
  s_addc_u32 s49, s35, 0
  s_mov_b32 s50, 663552
  s_mov_b32 s51, 0x20000
  s_lshl_b32 s52, s36, 10
  s_lshr_b32 s53, s36, 3
  s_lshl_b32 s53, s53, 10
  v_lshlrev_b32 v12, 4, v1
  s_mov_b32 m0, 155648
L_att_main:
  v_and_b32 v2, 31, v1
  v_lshlrev_b32 v9, 2, v2
  v_lshrrev_b32 v3, 5, v1
  v_lshlrev_b32 v4, 9, v3
  v_add_u32 v8, v9, v4
  v_mul_u32_u24 v4, 288, v3
  v_lshlrev_b32 v5, 4, v2
  v_add_u32 v10, v4, v5
  v_add_u32 v10, 73728, v10
  v_mov_b32 v11, 1152
  v_cmp_gt_u32 vcc, 18, v2
  v_mov_b32 v4, 148480
  s_nop 0
  v_cndmask_b32 v10, v4, v10, vcc
  v_cndmask_b32 v11, 0, v11, vcc
  v_cmp_eq_u32 vcc, 18, v2
  v_mov_b32 v4, 147456
  s_nop 0
  v_cndmask_b32 v10, v10, v4, vcc
  v_mov_b32 v128, 0
  v_mov_b32 v129, 0
  v_mov_b32 v130, 0
  v_mov_b32 v131, 0
  v_mov_b32 v132, 0
  v_mov_b32 v133, 0
  v_mov_b32 v134, 0
  v_mov_b32 v135, 0
  v_mov_b32 v136, 0
  v_mov_b32 v137, 0
  v_mov_b32 v138, 0
  v_mov_b32 v139, 0
  v_mov_b32 v140, 0
  v_mov_b32 v141, 0
  v_mov_b32 v142, 0
  v_mov_b32 v143, 0
  v_mov_b32 v144, 0
  v_mov_b32 v145, 0
  v_mov_b32 v146, 0
  v_mov_b32 v147, 0
  v_mov_b32 v148, 0
  v_mov_b32 v149, 0
  v_mov_b32 v150, 0
  v_mov_b32 v151, 0
  v_mov_b32 v152, 0
  v_mov_b32 v153, 0
  v_mov_b32 v154, 0
  v_mov_b32 v155, 0
  v_mov_b32 v156, 0
  v_mov_b32 v157, 0
  v_mov_b32 v158, 0
  v_mov_b32 v159, 0
  v_mov_b32 v160, 0
  v_mov_b32 v161, 0
  v_mov_b32 v162, 0
  v_mov_b32 v163, 0
  v_mov_b32 v164, 0
  v_mov_b32 v165, 0
  v_mov_b32 v166, 0
  v_mov_b32 v167, 0
  v_mov_b32 v168, 0
  v_mov_b32 v169, 0
  v_mov_b32 v170, 0
  v_mov_b32 v171, 0
  v_mov_b32 v172, 0
  v_mov_b32 v173, 0
  v_mov_b32 v174, 0
  v_mov_b32 v175, 0
  v_mov_b32 v176, 0
  v_mov_b32 v177, 0
  v_mov_b32 v178, 0
  v_mov_b32 v179, 0
  v_mov_b32 v180, 0
  v_mov_b32 v181, 0
  v_mov_b32 v182, 0
  v_mov_b32 v183, 0
  v_mov_b32 v184, 0
  v_mov_b32 v185, 0
  v_mov_b32 v186, 0
  v_mov_b32 v187, 0
  v_mov_b32 v188, 0
  v_mov_b32 v189, 0
  v_mov_b32 v190, 0
  v_mov_b32 v191, 0
  v_mov_b32 v72, 0
  v_mov_b32 v73, 0
  v_mov_b32 v74, 0
  v_mov_b32 v75, 0
  v_mov_b32 v76, 0
  v_mov_b32 v77, 0
  v_mov_b32 v78, 0
  v_mov_b32 v79, 0
  v_mov_b32 v116, 0
  v_mov_b32 v117, 0
  v_mov_b32 v118, 0
  v_mov_b32 v119, 0
  ds_read2_b32 v[48:49], v8 offset0:0 offset1:32
  ds_read2_b32 v[50:51], v8 offset0:64 offset1:96
  ds_read_b32 v52, v8 offset:1024
  v_add_u32 v8, 1152, v8
  ds_read_b128 v[64:67], v10
  ds_read_b128 v[68:71], v10 offset:576
  v_add_u32 v10, v10, v11
  s_waitcnt lgkmcnt(3)
  v_mfma_f32_32x32x16_bf16 v[80:95], v[48:51], v[16:19], 0
  s_waitcnt lgkmcnt(2)
  v_mfma_f32_32x32x16_bf16 v[80:95], v[52:55], v[20:23], v[80:95]
  s_nop 7
  s_mov_b32 s20, 14
  s_mov_b32 s23, 0
L_att_loop:
  v_mfma_f32_32x32x16_bf16 v[96:111], v[48:51], v[24:27], 0
  ds_read2_b32 v[56:57], v8 offset0:0 offset1:32
  v_exp_f32 v80, v80
  v_exp_f32 v81, v81
  v_exp_f32 v82, v82
  v_exp_f32 v83, v83
  v_mfma_f32_32x32x16_bf16 v[176:191], v[76:79], v[116:119], v[176:191]
  ds_read2_b32 v[58:59], v8 offset0:64 offset1:96
  v_exp_f32 v84, v84
  v_exp_f32 v85, v85
  v_cvt_pk_bf16_f32 v112, v80, v81
  v_cvt_pk_bf16_f32 v113, v82, v83
  v_exp_f32 v86, v86
  v_exp_f32 v87, v87
  v_mfma_f32_32x32x16_bf16 v[96:111], v[52:55], v[28:31], v[96:111]
  ds_read_b32 v60, v8 offset:1024
  v_cvt_pk_bf16_f32 v114, v84, v85
  v_cvt_pk_bf16_f32 v115, v86, v87
  v_exp_f32 v88, v88
  v_exp_f32 v89, v89
  v_exp_f32 v90, v90
  s_waitcnt lgkmcnt(4)
  v_mfma_f32_32x32x16_bf16 v[128:143], v[64:67], v[112:115], v[128:143]
  v_add_u32 v8, 1152, v8
  v_exp_f32 v91, v91
  v_exp_f32 v92, v92
  v_cvt_pk_bf16_f32 v116, v88, v89
  v_exp_f32 v93, v93
  v_exp_f32 v94, v94
  v_cvt_pk_bf16_f32 v117, v90, v91
  v_exp_f32 v95, v95
  v_cvt_pk_bf16_f32 v118, v92, v93
  v_cvt_pk_bf16_f32 v119, v94, v95
  v_mfma_f32_32x32x16_bf16 v[80:95], v[48:51], v[32:35], 0
  ds_read_b128 v[72:75], v10
  v_exp_f32 v96, v96
  v_exp_f32 v97, v97
  v_exp_f32 v98, v98
  v_exp_f32 v99, v99
  s_waitcnt lgkmcnt(4)
  v_mfma_f32_32x32x16_bf16 v[128:143], v[68:71], v[116:119], v[128:143]
  ds_read_b128 v[76:79], v10 offset:576
  v_exp_f32 v100, v100
  v_exp_f32 v101, v101
  v_cvt_pk_bf16_f32 v112, v96, v97
  v_cvt_pk_bf16_f32 v113, v98, v99
  v_exp_f32 v102, v102
  v_exp_f32 v103, v103
  v_mfma_f32_32x32x16_bf16 v[80:95], v[52:55], v[36:39], v[80:95]
  v_add_u32 v10, v10, v11
  v_cvt_pk_bf16_f32 v114, v100, v101
  v_cvt_pk_bf16_f32 v115, v102, v103
  v_exp_f32 v104, v104
  v_exp_f32 v105, v105
  v_exp_f32 v106, v106
  v_mfma_f32_32x32x16_bf16 v[144:159], v[64:67], v[112:115], v[144:159]
  v_exp_f32 v107, v107
  v_exp_f32 v108, v108
  v_cvt_pk_bf16_f32 v116, v104, v105
  v_exp_f32 v109, v109
  v_exp_f32 v110, v110
  v_cvt_pk_bf16_f32 v117, v106, v107
  v_exp_f32 v111, v111
  v_cvt_pk_bf16_f32 v118, v108, v109
  v_cvt_pk_bf16_f32 v119, v110, v111
  v_mfma_f32_32x32x16_bf16 v[96:111], v[48:51], v[40:43], 0
  buffer_load_dwordx4 v12, s[44:47], s52 offen lds
  v_exp_f32 v80, v80
  v_exp_f32 v81, v81
  v_exp_f32 v82, v82
  v_exp_f32 v83, v83
  v_mfma_f32_32x32x16_bf16 v[144:159], v[68:71], v[116:119], v[144:159]
  s_add_u32 s52, s52, 524288
  v_exp_f32 v84, v84
  v_exp_f32 v85, v85
  v_cvt_pk_bf16_f32 v112, v80, v81
  v_cvt_pk_bf16_f32 v113, v82, v83
  v_exp_f32 v86, v86
  v_exp_f32 v87, v87
  v_mfma_f32_32x32x16_bf16 v[96:111], v[52:55], v[44:47], v[96:111]
  v_cvt_pk_bf16_f32 v114, v84, v85
  v_cvt_pk_bf16_f32 v115, v86, v87
  v_exp_f32 v88, v88
  v_exp_f32 v89, v89
  v_exp_f32 v90, v90
  v_mfma_f32_32x32x16_bf16 v[160:175], v[64:67], v[112:115], v[160:175]
  v_exp_f32 v91, v91
  v_exp_f32 v92, v92
  v_cvt_pk_bf16_f32 v116, v88, v89
  v_exp_f32 v93, v93
  v_exp_f32 v94, v94
  v_cvt_pk_bf16_f32 v117, v90, v91
  v_exp_f32 v95, v95
  v_cvt_pk_bf16_f32 v118, v92, v93
  v_cvt_pk_bf16_f32 v119, v94, v95
  s_waitcnt lgkmcnt(3)
  v_mfma_f32_32x32x16_bf16 v[80:95], v[56:59], v[16:19], 0
  buffer_load_dwordx4 v12, s[48:51], s53 offen lds
  v_exp_f32 v96, v96
  v_exp_f32 v97, v97
  v_exp_f32 v98, v98
  v_exp_f32 v99, v99
  v_mfma_f32_32x32x16_bf16 v[160:175], v[68:71], v[116:119], v[160:175]
  s_add_u32 s53, s53, 65536
  v_exp_f32 v100, v100
  v_exp_f32 v101, v101
  v_cvt_pk_bf16_f32 v112, v96, v97
  v_cvt_pk_bf16_f32 v113, v98, v99
  v_exp_f32 v102, v102
  v_exp_f32 v103, v103
  s_waitcnt lgkmcnt(2)
  v_mfma_f32_32x32x16_bf16 v[80:95], v[60:63], v[20:23], v[80:95]
  v_cvt_pk_bf16_f32 v114, v100, v101
  v_cvt_pk_bf16_f32 v115, v102, v103
  v_exp_f32 v104, v104
  v_exp_f32 v105, v105
  v_exp_f32 v106, v106
  v_mfma_f32_32x32x16_bf16 v[176:191], v[64:67], v[112:115], v[176:191]
  v_exp_f32 v107, v107
  v_exp_f32 v108, v108
  v_cvt_pk_bf16_f32 v116, v104, v105
  v_exp_f32 v109, v109
  v_exp_f32 v110, v110
  v_cvt_pk_bf16_f32 v117, v106, v107
  v_exp_f32 v111, v111
  v_cvt_pk_bf16_f32 v118, v108, v109
  v_cvt_pk_bf16_f32 v119, v110, v111
  v_mfma_f32_32x32x16_bf16 v[96:111], v[56:59], v[24:27], 0
  ds_read2_b32 v[48:49], v8 offset0:0 offset1:32
  v_exp_f32 v80, v80
  v_exp_f32 v81, v81
  v_exp_f32 v82, v82
  v_exp_f32 v83, v83
  v_mfma_f32_32x32x16_bf16 v[176:191], v[68:71], v[116:119], v[176:191]
  ds_read2_b32 v[50:51], v8 offset0:64 offset1:96
  v_exp_f32 v84, v84
  v_exp_f32 v85, v85
  v_cvt_pk_bf16_f32 v112, v80, v81
  v_cvt_pk_bf16_f32 v113, v82, v83
  v_exp_f32 v86, v86
  v_exp_f32 v87, v87
  v_mfma_f32_32x32x16_bf16 v[96:111], v[60:63], v[28:31], v[96:111]
  ds_read_b32 v52, v8 offset:1024
  v_cvt_pk_bf16_f32 v114, v84, v85
  v_cvt_pk_bf16_f32 v115, v86, v87
  v_exp_f32 v88, v88
  v_exp_f32 v89, v89
  v_exp_f32 v90, v90
  s_waitcnt lgkmcnt(4)
  v_mfma_f32_32x32x16_bf16 v[128:143], v[72:75], v[112:115], v[128:143]
  v_add_u32 v8, 1152, v8
  v_exp_f32 v91, v91
  v_exp_f32 v92, v92
  v_cvt_pk_bf16_f32 v116, v88, v89
  v_exp_f32 v93, v93
  v_exp_f32 v94, v94
  v_cvt_pk_bf16_f32 v117, v90, v91
  v_exp_f32 v95, v95
  v_cvt_pk_bf16_f32 v118, v92, v93
  v_cvt_pk_bf16_f32 v119, v94, v95
  v_mfma_f32_32x32x16_bf16 v[80:95], v[56:59], v[32:35], 0
  ds_read_b128 v[64:67], v10
  v_exp_f32 v96, v96
  v_exp_f32 v97, v97
  v_exp_f32 v98, v98
  v_exp_f32 v99, v99
  s_waitcnt lgkmcnt(4)
  v_mfma_f32_32x32x16_bf16 v[128:143], v[76:79], v[116:119], v[128:143]
  ds_read_b128 v[68:71], v10 offset:576
  v_exp_f32 v100, v100
  v_exp_f32 v101, v101
  v_cvt_pk_bf16_f32 v112, v96, v97
  v_cvt_pk_bf16_f32 v113, v98, v99
  v_exp_f32 v102, v102
  v_exp_f32 v103, v103
  v_mfma_f32_32x32x16_bf16 v[80:95], v[60:63], v[36:39], v[80:95]
  v_add_u32 v10, v10, v11
  v_cvt_pk_bf16_f32 v114, v100, v101
  v_cvt_pk_bf16_f32 v115, v102, v103
  v_exp_f32 v104, v104
  v_exp_f32 v105, v105
  v_exp_f32 v106, v106
  v_mfma_f32_32x32x16_bf16 v[144:159], v[72:75], v[112:115], v[144:159]
  v_exp_f32 v107, v107
  v_exp_f32 v108, v108
  v_cvt_pk_bf16_f32 v116, v104, v105
  v_exp_f32 v109, v109
  v_exp_f32 v110, v110
  v_cvt_pk_bf16_f32 v117, v106, v107
  v_exp_f32 v111, v111
  v_cvt_pk_bf16_f32 v118, v108, v109
  v_cvt_pk_bf16_f32 v119, v110, v111
  v_mfma_f32_32x32x16_bf16 v[96:111], v[56:59], v[40:43], 0
  v_exp_f32 v80, v80
  v_exp_f32 v81, v81
  v_exp_f32 v82, v82
  v_exp_f32 v83, v83
  v_mfma_f32_32x32x16_bf16 v[144:159], v[76:79], v[116:119], v[144:159]
  v_exp_f32 v84, v84
  v_exp_f32 v85, v85
  v_cvt_pk_bf16_f32 v112, v80, v81
  v_cvt_pk_bf16_f32 v113, v82, v83
  v_exp_f32 v86, v86
  v_exp_f32 v87, v87
  v_mfma_f32_32x32x16_bf16 v[96:111], v[60:63], v[44:47], v[96:111]
  v_cvt_pk_bf16_f32 v114, v84, v85
  v_cvt_pk_bf16_f32 v115, v86, v87
  v_exp_f32 v88, v88
  v_exp_f32 v89, v89
  v_exp_f32 v90, v90
  v_mfma_f32_32x32x16_bf16 v[160:175], v[72:75], v[112:115], v[160:175]
  v_exp_f32 v91, v91
  v_exp_f32 v92, v92
  v_cvt_pk_bf16_f32 v116, v88, v89
  v_exp_f32 v93, v93
  v_exp_f32 v94, v94
  v_cvt_pk_bf16_f32 v117, v90, v91
  v_exp_f32 v95, v95
  v_cvt_pk_bf16_f32 v118, v92, v93
  v_cvt_pk_bf16_f32 v119, v94, v95
  s_waitcnt lgkmcnt(3)
  v_mfma_f32_32x32x16_bf16 v[80:95], v[48:51], v[16:19], 0
  v_exp_f32 v96, v96
  v_exp_f32 v97, v97
  v_exp_f32 v98, v98
  v_exp_f32 v99, v99
  v_mfma_f32_32x32x16_bf16 v[160:175], v[76:79], v[116:119], v[160:175]
  v_exp_f32 v100, v100
  v_exp_f32 v101, v101
  v_cvt_pk_bf16_f32 v112, v96, v97
  v_cvt_pk_bf16_f32 v113, v98, v99
  v_exp_f32 v102, v102
  v_exp_f32 v103, v103
  s_waitcnt lgkmcnt(2)
  v_mfma_f32_32x32x16_bf16 v[80:95], v[52:55], v[20:23], v[80:95]
  v_cvt_pk_bf16_f32 v114, v100, v101
  v_cvt_pk_bf16_f32 v115, v102, v103
  v_exp_f32 v104, v104
  v_exp_f32 v105, v105
  v_exp_f32 v106, v106
  v_mfma_f32_32x32x16_bf16 v[176:191], v[72:75], v[112:115], v[176:191]
  v_exp_f32 v107, v107
  v_exp_f32 v108, v108
  v_cvt_pk_bf16_f32 v116, v104, v105
  v_exp_f32 v109, v109
  v_exp_f32 v110, v110
  v_cvt_pk_bf16_f32 v117, v106, v107
  v_exp_f32 v111, v111
  v_cvt_pk_bf16_f32 v118, v108, v109
  v_cvt_pk_bf16_f32 v119, v110, v111
  s_sub_u32 s20, s20, 1
  s_cbranch_scc0 L_att_loop
  s_cmp_eq_u32 s23, 0
  s_cbranch_scc0 L_att_done
  s_mov_b32 s23, 1
  s_mov_b32 s20, 16
  s_cmp_eq_u32 s21, 0
  s_cbranch_scc0 L_att_loop
  s_waitcnt vmcnt(0)
  s_barrier
  s_branch L_att_loop
L_att_done:
  v_mfma_f32_32x32x16_bf16 v[176:191], v[76:79], v[116:119], v[176:191]
  s_mov_b64 s[26:27], 0
  v_mov_b32 v2, v138
  s_nop 1
  v_permlane32_swap_b32 v138, v2
  v_add_f32 v3, abs(v128), abs(v129)
  v_add_f32 v3, v3, abs(v130)
  v_add_f32 v3, v3, abs(v131)
  v_add_f32 v3, v3, abs(v132)
  v_add_f32 v3, v3, abs(v133)
  v_add_f32 v3, v3, abs(v134)
  v_add_f32 v3, v3, abs(v135)
  v_add_f32 v3, v3, abs(v136)
  v_add_f32 v3, v3, abs(v137)
  v_mov_b32 v4, 0x1f800000
  v_mov_b32 v5, 0x5f800000
  v_cmp_nge_f32 vcc, v138, v4
  s_nop 0
  s_or_b64 s[26:27], s[26:27], vcc
  v_cmp_nle_f32 vcc, v138, v5
  s_nop 0
  s_or_b64 s[26:27], s[26:27], vcc
  v_mov_b32 v5, 0x7f7fffff
  v_cmp_nle_f32 vcc, v3, v5
  s_nop 0
  s_or_b64 s[26:27], s[26:27], vcc
  v_mov_b32 v2, v154
  s_nop 1
  v_permlane32_swap_b32 v154, v2
  v_add_f32 v3, abs(v144), abs(v145)
  v_add_f32 v3, v3, abs(v146)
  v_add_f32 v3, v3, abs(v147)
  v_add_f32 v3, v3, abs(v148)
  v_add_f32 v3, v3, abs(v149)
  v_add_f32 v3, v3, abs(v150)
  v_add_f32 v3, v3, abs(v151)
  v_add_f32 v3, v3, abs(v152)
  v_add_f32 v3, v3, abs(v153)
  v_mov_b32 v4, 0x1f800000
  v_mov_b32 v5, 0x5f800000
  v_cmp_nge_f32 vcc, v154, v4
  s_nop 0
  s_or_b64 s[26:27], s[26:27], vcc
  v_cmp_nle_f32 vcc, v154, v5
  s_nop 0
  s_or_b64 s[26:27], s[26:27], vcc
  v_mov_b32 v5, 0x7f7fffff
  v_cmp_nle_f32 vcc, v3, v5
  s_nop 0
  s_or_b64 s[26:27], s[26:27], vcc
  v_mov_b32 v2, v170
  s_nop 1
  v_permlane32_swap_b32 v170, v2
  v_add_f32 v3, abs(v160), abs(v161)
  v_add_f32 v3, v3, abs(v162)
  v_add_f32 v3, v3, abs(v163)
  v_add_f32 v3, v3, abs(v164)
  v_add_f32 v3, v3, abs(v165)
  v_add_f32 v3, v3, abs(v166)
  v_add_f32 v3, v3, abs(v167)
  v_add_f32 v3, v3, abs(v168)
  v_add_f32 v3, v3, abs(v169)
  v_mov_b32 v4, 0x1f800000
  v_mov_b32 v5, 0x5f800000
  v_cmp_nge_f32 vcc, v170, v4
  s_nop 0
  s_or_b64 s[26:27], s[26:27], vcc
  v_cmp_nle_f32 vcc, v170, v5
  s_nop 0
  s_or_b64 s[26:27], s[26:27], vcc
  v_mov_b32 v5, 0x7f7fffff
  v_cmp_nle_f32 vcc, v3, v5
  s_nop 0
  s_or_b64 s[26:27], s[26:27], vcc
  v_mov_b32 v2, v186
  s_nop 1
  v_permlane32_swap_b32 v186, v2
  v_add_f32 v3, abs(v176), abs(v177)
  v_add_f32 v3, v3, abs(v178)
  v_add_f32 v3, v3, abs(v179)
  v_add_f32 v3, v3, abs(v180)
  v_add_f32 v3, v3, abs(v181)
  v_add_f32 v3, v3, abs(v182)
  v_add_f32 v3, v3, abs(v183)
  v_add_f32 v3, v3, abs(v184)
  v_add_f32 v3, v3, abs(v185)
  v_mov_b32 v4, 0x1f800000
  v_mov_b32 v5, 0x5f800000
  v_cmp_nge_f32 vcc, v186, v4
  s_nop 0
  s_or_b64 s[26:27], s[26:27], vcc
  v_cmp_nle_f32 vcc, v186, v5
  s_nop 0
  s_or_b64 s[26:27], s[26:27], vcc
  v_mov_b32 v5, 0x7f7fffff
  v_cmp_nle_f32 vcc, v3, v5
  s_nop 0
  s_or_b64 s[26:27], s[26:27], vcc
  s_cmp_eq_u64 s[26:27], 0
  s_cbranch_scc1 L_att_store
  s_cmp_eq_u32 s21, 0
  s_cbranch_scc0 L_att_store
  s_mov_b32 s21, 1
  s_waitcnt vmcnt(0) lgkmcnt(0)
  v_and_b32 v2, 31, v1
  v_lshlrev_b32 v9, 2, v2
  v_lshrrev_b32 v3, 5, v1
  v_lshlrev_b32 v4, 9, v3
  v_add_u32 v8, v9, v4
  v_mul_u32_u24 v4, 288, v3
  v_lshlrev_b32 v5, 4, v2
  v_add_u32 v10, v4, v5
  v_add_u32 v10, 73728, v10
  v_mov_b32 v11, 1152
  v_cmp_gt_u32 vcc, 18, v2
  v_mov_b32 v4, 148480
  s_nop 0
  v_cndmask_b32 v10, v4, v10, vcc
  v_cndmask_b32 v11, 0, v11, vcc
  v_cmp_eq_u32 vcc, 18, v2
  v_mov_b32 v4, 147456
  s_nop 0
  v_cndmask_b32 v10, v10, v4, vcc
  v_mov_b32 v120, 0xff7fffff
  v_mov_b32 v21, 0
  v_mov_b32 v22, 0
  v_mov_b32 v23, 0
  v_mov_b32 v121, 0xff7fffff
  v_mov_b32 v29, 0
  v_mov_b32 v30, 0
  v_mov_b32 v31, 0
  v_mov_b32 v122, 0xff7fffff
  v_mov_b32 v37, 0
  v_mov_b32 v38, 0
  v_mov_b32 v39, 0
  v_mov_b32 v123, 0xff7fffff
  v_mov_b32 v45, 0
  v_mov_b32 v46, 0
  v_mov_b32 v47, 0
  s_mov_b32 s20, 0
L_att_max:
  ds_read2_b32 v[48:49], v8 offset0:0 offset1:32
  ds_read2_b32 v[50:51], v8 offset0:64 offset1:96
  ds_read_b32 v52, v8 offset:1024
  v_add_u32 v8, 1152, v8
  s_waitcnt lgkmcnt(1)
  v_mfma_f32_32x32x16_bf16 v[80:95], v[48:51], v[16:19], 0
  s_waitcnt lgkmcnt(0)
  v_mfma_f32_32x32x16_bf16 v[80:95], v[52:55], v[20:23], v[80:95]
  s_nop 11
  v_max3_f32 v120, v120, v80, v81
  v_max3_f32 v120, v120, v82, v83
  v_max3_f32 v120, v120, v84, v85
  v_max3_f32 v120, v120, v86, v87
  v_max3_f32 v120, v120, v88, v89
  v_max3_f32 v120, v120, v90, v91
  v_max3_f32 v120, v120, v92, v93
  v_max3_f32 v120, v120, v94, v95
  v_mfma_f32_32x32x16_bf16 v[80:95], v[48:51], v[24:27], 0
  v_mfma_f32_32x32x16_bf16 v[80:95], v[52:55], v[28:31], v[80:95]
  s_nop 11
  v_max3_f32 v121, v121, v80, v81
  v_max3_f32 v121, v121, v82, v83
  v_max3_f32 v121, v121, v84, v85
  v_max3_f32 v121, v121, v86, v87
  v_max3_f32 v121, v121, v88, v89
  v_max3_f32 v121, v121, v90, v91
  v_max3_f32 v121, v121, v92, v93
  v_max3_f32 v121, v121, v94, v95
  v_mfma_f32_32x32x16_bf16 v[80:95], v[48:51], v[32:35], 0
  v_mfma_f32_32x32x16_bf16 v[80:95], v[52:55], v[36:39], v[80:95]
  s_nop 11
  v_max3_f32 v122, v122, v80, v81
  v_max3_f32 v122, v122, v82, v83
  v_max3_f32 v122, v122, v84, v85
  v_max3_f32 v122, v122, v86, v87
  v_max3_f32 v122, v122, v88, v89
  v_max3_f32 v122, v122, v90, v91
  v_max3_f32 v122, v122, v92, v93
  v_max3_f32 v122, v122, v94, v95
  v_mfma_f32_32x32x16_bf16 v[80:95], v[48:51], v[40:43], 0
  v_mfma_f32_32x32x16_bf16 v[80:95], v[52:55], v[44:47], v[80:95]
  s_nop 11
  v_max3_f32 v123, v123, v80, v81
  v_max3_f32 v123, v123, v82, v83
  v_max3_f32 v123, v123, v84, v85
  v_max3_f32 v123, v123, v86, v87
  v_max3_f32 v123, v123, v88, v89
  v_max3_f32 v123, v123, v90, v91
  v_max3_f32 v123, v123, v92, v93
  v_max3_f32 v123, v123, v94, v95
  s_add_u32 s20, s20, 1
  s_cmp_lt_u32 s20, 64
  s_cbranch_scc1 L_att_max
  v_cmp_gt_u32 vcc, 32, v1
  v_mov_b32 v2, v120
  s_nop 1
  v_permlane32_swap_b32 v120, v2
  v_max_f32 v120, v120, v2
  v_sub_f32 v120, 0, v120
  v_and_b32 v2, 0xffff0000, v120
  v_sub_f32 v3, v120, v2
  v_and_b32 v4, 0xffff0000, v3
  v_sub_f32 v3, v3, v4
  v_lshrrev_b32 v2, 16, v2
  v_or_b32 v2, v2, v4
  v_lshrrev_b32 v3, 16, v3
  v_cndmask_b32 v21, 0, v2, vcc
  v_cndmask_b32 v22, 0, v3, vcc
  v_mov_b32 v2, v121
  s_nop 1
  v_permlane32_swap_b32 v121, v2
  v_max_f32 v121, v121, v2
  v_sub_f32 v121, 0, v121
  v_and_b32 v2, 0xffff0000, v121
  v_sub_f32 v3, v121, v2
  v_and_b32 v4, 0xffff0000, v3
  v_sub_f32 v3, v3, v4
  v_lshrrev_b32 v2, 16, v2
  v_or_b32 v2, v2, v4
  v_lshrrev_b32 v3, 16, v3
  v_cndmask_b32 v29, 0, v2, vcc
  v_cndmask_b32 v30, 0, v3, vcc
  v_mov_b32 v2, v122
  s_nop 1
  v_permlane32_swap_b32 v122, v2
  v_max_f32 v122, v122, v2
  v_sub_f32 v122, 0, v122
  v_and_b32 v2, 0xffff0000, v122
  v_sub_f32 v3, v122, v2
  v_and_b32 v4, 0xffff0000, v3
  v_sub_f32 v3, v3, v4
  v_lshrrev_b32 v2, 16, v2
  v_or_b32 v2, v2, v4
  v_lshrrev_b32 v3, 16, v3
  v_cndmask_b32 v37, 0, v2, vcc
  v_cndmask_b32 v38, 0, v3, vcc
  v_mov_b32 v2, v123
  s_nop 1
  v_permlane32_swap_b32 v123, v2
  v_max_f32 v123, v123, v2
  v_sub_f32 v123, 0, v123
  v_and_b32 v2, 0xffff0000, v123
  v_sub_f32 v3, v123, v2
  v_and_b32 v4, 0xffff0000, v3
  v_sub_f32 v3, v3, v4
  v_lshrrev_b32 v2, 16, v2
  v_or_b32 v2, v2, v4
  v_lshrrev_b32 v3, 16, v3
  v_cndmask_b32 v45, 0, v2, vcc
  v_cndmask_b32 v46, 0, v3, vcc
  s_nop 4
  s_branch L_att_main
L_att_store:
  v_lshlrev_b32 v4, 4, v1
  s_lshl_b32 s24, s16, 13
  s_lshl_b32 s23, s16, 10
  v_lshlrev_b32 v3, 2, v1
  v_mov_b32 v5, 0x40000000
  v_cmp_gt_u32 vcc, 32, v1
  s_nop 1
  v_cndmask_b32 v5, v5, v3, vcc
  v_rcp_f32 v2, v138
  s_nop 0
  v_mul_f32 v128, v128, v2
  v_mul_f32 v129, v129, v2
  v_mul_f32 v130, v130, v2
  v_mul_f32 v131, v131, v2
  v_mul_f32 v132, v132, v2
  v_mul_f32 v133, v133, v2
  v_mul_f32 v134, v134, v2
  v_mul_f32 v135, v135, v2
  v_mul_f32 v136, v136, v2
  v_mul_f32 v137, v137, v2
  v_cvt_pk_bf16_f32 v128, v128, v129
  v_cvt_pk_bf16_f32 v129, v130, v131
  v_cvt_pk_bf16_f32 v130, v132, v133
  v_cvt_pk_bf16_f32 v131, v134, v135
  v_cvt_pk_bf16_f32 v132, v136, v137
  s_add_u32 s19, s18, 0
  s_mul_i32 s19, s19, 36864
  s_add_u32 s22, s19, s23
  buffer_store_dwordx4 v[128:131], v4, s[12:15], s22 offen sc1
  s_add_u32 s22, s18, 0
  s_lshl_b32 s22, s22, 7
  s_add_u32 s22, s22, s24
  buffer_store_dword v132, v5, s[28:31], s22 offen sc1
  v_rcp_f32 v2, v154
  s_nop 0
  v_mul_f32 v144, v144, v2
  v_mul_f32 v145, v145, v2
  v_mul_f32 v146, v146, v2
  v_mul_f32 v147, v147, v2
  v_mul_f32 v148, v148, v2
  v_mul_f32 v149, v149, v2
  v_mul_f32 v150, v150, v2
  v_mul_f32 v151, v151, v2
  v_mul_f32 v152, v152, v2
  v_mul_f32 v153, v153, v2
  v_cvt_pk_bf16_f32 v144, v144, v145
  v_cvt_pk_bf16_f32 v145, v146, v147
  v_cvt_pk_bf16_f32 v146, v148, v149
  v_cvt_pk_bf16_f32 v147, v150, v151
  v_cvt_pk_bf16_f32 v148, v152, v153
  s_add_u32 s19, s18, 1
  s_mul_i32 s19, s19, 36864
  s_add_u32 s22, s19, s23
  buffer_store_dwordx4 v[144:147], v4, s[12:15], s22 offen sc1
  s_add_u32 s22, s18, 1
  s_lshl_b32 s22, s22, 7
  s_add_u32 s22, s22, s24
  buffer_store_dword v148, v5, s[28:31], s22 offen sc1
  v_rcp_f32 v2, v170
  s_nop 0
  v_mul_f32 v160, v160, v2
  v_mul_f32 v161, v161, v2
  v_mul_f32 v162, v162, v2
  v_mul_f32 v163, v163, v2
  v_mul_f32 v164, v164, v2
  v_mul_f32 v165, v165, v2
  v_mul_f32 v166, v166, v2
  v_mul_f32 v167, v167, v2
  v_mul_f32 v168, v168, v2
  v_mul_f32 v169, v169, v2
  v_cvt_pk_bf16_f32 v160, v160, v161
  v_cvt_pk_bf16_f32 v161, v162, v163
  v_cvt_pk_bf16_f32 v162, v164, v165
  v_cvt_pk_bf16_f32 v163, v166, v167
  v_cvt_pk_bf16_f32 v164, v168, v169
  s_add_u32 s19, s18, 2
  s_mul_i32 s19, s19, 36864
  s_add_u32 s22, s19, s23
  buffer_store_dwordx4 v[160:163], v4, s[12:15], s22 offen sc1
  s_add_u32 s22, s18, 2
  s_lshl_b32 s22, s22, 7
  s_add_u32 s22, s22, s24
  buffer_store_dword v164, v5, s[28:31], s22 offen sc1
  v_rcp_f32 v2, v186
  s_nop 0
  v_mul_f32 v176, v176, v2
  v_mul_f32 v177, v177, v2
  v_mul_f32 v178, v178, v2
  v_mul_f32 v179, v179, v2
  v_mul_f32 v180, v180, v2
  v_mul_f32 v181, v181, v2
  v_mul_f32 v182, v182, v2
  v_mul_f32 v183, v183, v2
  v_mul_f32 v184, v184, v2
  v_mul_f32 v185, v185, v2
  v_cvt_pk_bf16_f32 v176, v176, v177
  v_cvt_pk_bf16_f32 v177, v178, v179
  v_cvt_pk_bf16_f32 v178, v180, v181
  v_cvt_pk_bf16_f32 v179, v182, v183
  v_cvt_pk_bf16_f32 v180, v184, v185
  s_add_u32 s19, s18, 3
  s_mul_i32 s19, s19, 36864
  s_add_u32 s22, s19, s23
  buffer_store_dwordx4 v[176:179], v4, s[12:15], s22 offen sc1
  s_add_u32 s22, s18, 3
  s_lshl_b32 s22, s22, 7
  s_add_u32 s22, s22, s24
  buffer_store_dword v180, v5, s[28:31], s22 offen sc1
  s_lshl_b32 s27, s17, 2
  s_add_u32 s27, s27, s3
  s_add_u32 s27, s27, 16
  s_lshl_b32 s27, s27, 7
  v_mov_b32 v2, s27
  v_mov_b32 v3, 0x40000000
  v_cmp_eq_u32 vcc, 0, v1
  s_nop 1
  v_cndmask_b32 v2, v3, v2, vcc
  v_mov_b32 v3, 1
  s_waitcnt vmcnt(0)
  buffer_atomic_add v3, v2, s[72:75], 0 offen offset:0 sc1
  s_barrier
  s_cmp_ge_u32 s39, 12
  s_cbranch_scc1 L_k3_a_end
  s_cmp_ge_u32 s39, 6
  s_cselect_b32 s23, 1, 0
  s_lshl_b32 s20, s38, 1
  s_add_u32 s20, s20, s23
  s_mul_i32 s23, s23, 6
  s_sub_u32 s21, s39, s23
  s_lshl_b32 s22, s20, 2
  s_add_u32 s22, s22, s3
  s_mov_b64 s[50:51], s[84:85]
  s_mov_b64 s[52:53], s[100:101]
  s_mov_b64 s[54:55], s[98:99]
  v_lshrrev_b32 v2, 2, v1
  s_mov_b32 s23, 1152
  v_mul_lo_u32 v8, v2, s23
  v_and_b32 v2, 3, v1
  v_lshlrev_b32 v2, 4, v2
  v_add_u32 v8, v8, v2
  s_mul_i32 s23, s21, 192
  v_add_u32 v8, s23, v8
  v_bfe_u32 v2, v1, 4, 1
  v_lshlrev_b32 v2, 2, v2
  v_bfe_u32 v3, v1, 3, 1
  v_add_u32 v2, v2, v3
  v_bfe_u32 v3, v1, 5, 1
  v_lshlrev_b32 v3, 1, v3
  v_add_u32 v2, v2, v3
  v_mul_u32_u24 v2, 18, v2
  v_bfe_u32 v3, v1, 2, 1
  v_add3_u32 v2, v2, v3, 16
  v_mul_u32_u24 v9, 1152, v2
  v_and_b32 v2, 3, v1
  v_lshlrev_b32 v2, 4, v2
  v_add3_u32 v9, v9, v2, s23
  s_mul_i32 s26, s3, 186624
  s_add_u32 s28, s26, 0
  s_add_u32 s29, s26, 20736
  s_add_u32 s30, s26, 41472
  s_add_u32 s31, s26, 62208
  s_add_u32 s32, s26, 82944
  s_add_u32 s33, s26, 103680
  s_add_u32 s34, s26, 124416
  s_add_u32 s35, s26, 145152
  s_add_u32 s36, s26, 165888
  s_cmp_eq_u32 s3, 3
  s_cselect_b32 s33, 0, s33
  s_cselect_b32 s34, 165888, s34
  s_cselect_b32 s35, 331776, s35
  s_cselect_b32 s36, 497664, s36
  s_cselect_b64 vcc, -1, 0
  v_cndmask_b32 v9, v8, v9, vcc
  s_mov_b32 s40, 0
  s_mov_b32 s41, 4096
  s_mov_b32 s42, 8192
  s_mov_b32 s43, 12288
  s_mov_b32 s44, 16384
  s_mov_b32 s45, 20480
  s_mov_b32 s46, 24576
  s_mov_b32 s47, 28672
  s_mov_b32 s48, 32768
  v_lshlrev_b32 v11, 4, v1
  v_and_b32 v2, 31, v1
  s_lshl_b32 s23, s22, 5
  v_add_u32 v2, s23, v2
  v_lshlrev_b32 v4, 2, v2
  v_lshrrev_b32 v3, 5, v1
  v_lshlrev_b32 v3, 15, v3
  v_add_u32 v14, v4, v3
  v_mul_u32_u24 v10, 1152, v2
  v_lshrrev_b32 v2, 5, v1
  v_lshlrev_b32 v2, 4, v2
  s_mul_i32 s23, s21, 192
  v_add3_u32 v10, v10, v2, s23
  s_waitcnt lgkmcnt(0)
  s_mov_b32 s8, s50
  s_mov_b32 s9, s51
  s_mov_b32 s10, 663552
  s_mov_b32 s11, 0x20000
  s_add_u32 s4, s52, 11796480
  s_addc_u32 s5, s53, 0
  s_mov_b32 s6, 2359296
  s_mov_b32 s7, 0x20000
  s_add_u32 s16, s52, 14680064
  s_addc_u32 s17, s53, 0
  s_mov_b32 s18, 18874368
  s_mov_b32 s19, 0x20000
  s_add_u32 s60, s52, 9437184
  s_addc_u32 s61, s53, 0
  s_mov_b32 s62, 2359296
  s_mov_b32 s63, 0x20000
  s_add_u32 s64, s52, 14155776
  s_addc_u32 s65, s53, 0
  s_mov_b32 s66, 8192
  s_mov_b32 s67, 0x20000
  s_add_u32 s68, s52, 14417920
  s_addc_u32 s69, s53, 0
  s_mov_b32 s70, 262144
  s_mov_b32 s71, 0x20000
  s_mov_b32 s12, s54
  s_mov_b32 s13, s55
  s_mov_b32 s14, 2359296
  s_mov_b32 s15, 0x20000
  s_add_u32 s26, s20, 16
  s_lshl_b32 s26, s26, 7
  v_mov_b32 v13, s26
  buffer_load_dword v13, v13, s[72:75], 0 offen sc1
  s_mul_i32 s24, s3, 9216
  s_add_u32 s24, s24, 0
  s_add_u32 m0, s24, 0
  s_nop 0
  buffer_load_dwordx4 v8, s[8:11], s28 offen lds
  s_add_u32 m0, s24, 1024
  s_nop 0
  buffer_load_dwordx4 v8, s[8:11], s29 offen lds
  s_add_u32 m0, s24, 2048
  s_nop 0
  buffer_load_dwordx4 v8, s[8:11], s30 offen lds
  s_add_u32 m0, s24, 3072
  s_nop 0
  buffer_load_dwordx4 v8, s[8:11], s31 offen lds
  s_add_u32 m0, s24, 4096
  s_nop 0
  buffer_load_dwordx4 v8, s[8:11], s32 offen lds
  s_add_u32 m0, s24, 5120
  s_nop 0
  buffer_load_dwordx4 v9, s[8:11], s33 offen lds
  s_add_u32 m0, s24, 6144
  s_nop 0
  buffer_load_dwordx4 v9, s[8:11], s34 offen lds
  s_add_u32 m0, s24, 7168
  s_nop 0
  buffer_load_dwordx4 v9, s[8:11], s35 offen lds
  s_add_u32 m0, s24, 8192
  s_nop 0
  buffer_load_dwordx4 v9, s[8:11], s36 offen lds
  v_add_u32 v8, 64, v8
  v_add_u32 v9, 64, v9
  s_mul_i32 s24, s3, 9216
  s_add_u32 s24, s24, 36864
  s_add_u32 m0, s24, 0
  s_nop 0
  buffer_load_dwordx4 v8, s[8:11], s28 offen lds
  s_add_u32 m0, s24, 1024
  s_nop 0
  buffer_load_dwordx4 v8, s[8:11], s29 offen lds
  s_add_u32 m0, s24, 2048
  s_nop 0
  buffer_load_dwordx4 v8, s[8:11], s30 offen lds
  s_add_u32 m0, s24, 3072
  s_nop 0
  buffer_load_dwordx4 v8, s[8:11], s31 offen lds
  s_add_u32 m0, s24, 4096
  s_nop 0
  buffer_load_dwordx4 v8, s[8:11], s32 offen lds
  s_add_u32 m0, s24, 5120
  s_nop 0
  buffer_load_dwordx4 v9, s[8:11], s33 offen lds
  s_add_u32 m0, s24, 6144
  s_nop 0
  buffer_load_dwordx4 v9, s[8:11], s34 offen lds
  s_add_u32 m0, s24, 7168
  s_nop 0
  buffer_load_dwordx4 v9, s[8:11], s35 offen lds
  s_add_u32 m0, s24, 8192
  s_nop 0
  buffer_load_dwordx4 v9, s[8:11], s36 offen lds
  v_add_u32 v8, 64, v8
  v_add_u32 v9, 64, v9
  s_mul_i32 s24, s3, 9216
  s_add_u32 s24, s24, 73728
  s_add_u32 m0, s24, 0
  s_nop 0
  buffer_load_dwordx4 v8, s[8:11], s28 offen lds
  s_add_u32 m0, s24, 1024
  s_nop 0
  buffer_load_dwordx4 v8, s[8:11], s29 offen lds
  s_add_u32 m0, s24, 2048
  s_nop 0
  buffer_load_dwordx4 v8, s[8:11], s30 offen lds
  s_add_u32 m0, s24, 3072
  s_nop 0
  buffer_load_dwordx4 v8, s[8:11], s31 offen lds
  s_add_u32 m0, s24, 4096
  s_nop 0
  buffer_load_dwordx4 v8, s[8:11], s32 offen lds
  s_add_u32 m0, s24, 5120
  s_nop 0
  buffer_load_dwordx4 v9, s[8:11], s33 offen lds
  s_add_u32 m0, s24, 6144
  s_nop 0
  buffer_load_dwordx4 v9, s[8:11], s34 offen lds
  s_add_u32 m0, s24, 7168
  s_nop 0
  buffer_load_dwordx4 v9, s[8:11], s35 offen lds
  s_add_u32 m0, s24, 8192
  s_nop 0
  buffer_load_dwordx4 v9, s[8:11], s36 offen lds
  v_add_u32 v8, 64, v8
  v_add_u32 v9, 64, v9
  buffer_load_dword v12, v4, s[64:67], 0 offen
  v_and_b32 v2, 31, v1
  v_lshrrev_b32 v3, 5, v1
  v_lshlrev_b32 v3, 2, v3
  v_sub_u32 v2, v2, v3
  v_mov_b32 v240, 0
  v_cmp_eq_u32 vcc, 0, v2
  v_mov_b32 v3, 0x3f80
  s_nop 0
  v_cndmask_b32 v240, v240, v3, vcc
  v_cmp_eq_u32 vcc, 1, v2
  v_mov_b32 v3, 0x3f800000
  s_nop 0
  v_cndmask_b32 v240, v240, v3, vcc
  v_mov_b32 v241, 0
  v_cmp_eq_u32 vcc, 2, v2
  v_mov_b32 v3, 0x3f80
  s_nop 0
  v_cndmask_b32 v241, v241, v3, vcc
  v_cmp_eq_u32 vcc, 3, v2
  v_mov_b32 v3, 0x3f800000
  s_nop 0
  v_cndmask_b32 v241, v241, v3, vcc
  v_mov_b32 v242, 0
  v_cmp_eq_u32 vcc, 8, v2
  v_mov_b32 v3, 0x3f80
  s_nop 0
  v_cndmask_b32 v242, v242, v3, vcc
  v_cmp_eq_u32 vcc, 9, v2
  v_mov_b32 v3, 0x3f800000
  s_nop 0
  v_cndmask_b32 v242, v242, v3, vcc
  v_mov_b32 v243, 0
  v_cmp_eq_u32 vcc, 10, v2
  v_mov_b32 v3, 0x3f80
  s_nop 0
  v_cndmask_b32 v243, v243, v3, vcc
  v_cmp_eq_u32 vcc, 11, v2
  v_mov_b32 v3, 0x3f800000
  s_nop 0
  v_cndmask_b32 v243, v243, v3, vcc
  v_mov_b32 v244, 0
  v_cmp_eq_u32 vcc, 16, v2
  v_mov_b32 v3, 0x3f80
  s_nop 0
  v_cndmask_b32 v244, v244, v3, vcc
  v_cmp_eq_u32 vcc, 17, v2
  v_mov_b32 v3, 0x3f800000
  s_nop 0
  v_cndmask_b32 v244, v244, v3, vcc
  v_mov_b32 v245, 0
  v_cmp_eq_u32 vcc, 18, v2
  v_mov_b32 v3, 0x3f80
  s_nop 0
  v_cndmask_b32 v245, v245, v3, vcc
  v_cmp_eq_u32 vcc, 19, v2
  v_mov_b32 v3, 0x3f800000
  s_nop 0
  v_cndmask_b32 v245, v245, v3, vcc
  v_mov_b32 v246, 0
  v_cmp_eq_u32 vcc, 24, v2
  v_mov_b32 v3, 0x3f80
  s_nop 0
  v_cndmask_b32 v246, v246, v3, vcc
  v_cmp_eq_u32 vcc, 25, v2
  v_mov_b32 v3, 0x3f800000
  s_nop 0
  v_cndmask_b32 v246, v246, v3, vcc
  v_mov_b32 v247, 0
  v_cmp_eq_u32 vcc, 26, v2
  v_mov_b32 v3, 0x3f80
  s_nop 0
  v_cndmask_b32 v247, v247, v3, vcc
  v_cmp_eq_u32 vcc, 27, v2
  v_mov_b32 v3, 0x3f800000
  s_nop 0
  v_cndmask_b32 v247, v247, v3, vcc
  v_bfe_u32 v2, v1, 2, 2
  v_lshrrev_b32 v3, 5, v1
  v_lshlrev_b32 v3, 2, v3
  v_add_u32 v2, v2, v3
  v_lshlrev_b32 v5, 6, v2
  v_bfe_u32 v2, v1, 4, 1
  v_lshlrev_b32 v2, 5, v2
  v_add_u32 v5, v5, v2
  v_and_b32 v2, 3, v1
  v_lshlrev_b32 v2, 3, v2
  v_add_u32 v5, v5, v2
  v_add_u32 v6, 36864, v5
  v_add_u32 v7, 73728, v5
  s_waitcnt vmcnt(28)
  v_readfirstlane_b32 s76, v13
  s_nop 0
  s_cmp_ge_u32 s76, 32
  s_cbranch_scc1 L_fin_o_ready
  s_add_u32 s26, s20, 16
  s_lshl_b32 s26, s26, 7
  v_mov_b32 v2, s26
  s_mov_b32 s77, 131072
L_wpoll_2:
  buffer_load_dword v3, v2, s[72:75], 0 offen sc1
  s_waitcnt vmcnt(0)
  v_readfirstlane_b32 s76, v3
  s_nop 0
  s_cmp_ge_u32 s76, 32
  s_cbranch_scc1 L_wgot_3
  s_sub_u32 s77, s77, 1
  s_cbranch_scc1 L_wgot_3
  s_sleep 8
  s_branch L_wpoll_2
L_wgot_3:
L_fin_o_ready:
  s_mul_i32 s25, s22, 36864
  s_add_u32 s23, s25, s40
  buffer_load_dwordx4 v[16:19], v11, s[4:7], s23 offen offset:0 sc1
  buffer_load_dwordx4 v[20:23], v11, s[4:7], s23 offen offset:1024 sc1
  buffer_load_dwordx4 v[24:27], v11, s[4:7], s23 offen offset:2048 sc1
  buffer_load_dwordx4 v[28:31], v11, s[4:7], s23 offen offset:3072 sc1
  s_add_u32 s23, s25, s41
  buffer_load_dwordx4 v[32:35], v11, s[4:7], s23 offen offset:0 sc1
  buffer_load_dwordx4 v[36:39], v11, s[4:7], s23 offen offset:1024 sc1
  buffer_load_dwordx4 v[40:43], v11, s[4:7], s23 offen offset:2048 sc1
  buffer_load_dwordx4 v[44:47], v11, s[4:7], s23 offen offset:3072 sc1
  s_add_u32 s23, s25, s42
  buffer_load_dwordx4 v[48:51], v11, s[4:7], s23 offen offset:0 sc1
  buffer_load_dwordx4 v[52:55], v11, s[4:7], s23 offen offset:1024 sc1
  buffer_load_dwordx4 v[56:59], v11, s[4:7], s23 offen offset:2048 sc1
  buffer_load_dwordx4 v[60:63], v11, s[4:7], s23 offen offset:3072 sc1
  s_add_u32 s23, s25, s43
  buffer_load_dwordx4 v[64:67], v11, s[4:7], s23 offen offset:0 sc1
  buffer_load_dwordx4 v[68:71], v11, s[4:7], s23 offen offset:1024 sc1
  buffer_load_dwordx4 v[72:75], v11, s[4:7], s23 offen offset:2048 sc1
  buffer_load_dwordx4 v[76:79], v11, s[4:7], s23 offen offset:3072 sc1
  s_waitcnt vmcnt(16)
  s_barrier
  ds_read_b64_tr_b16 v[208:209], v5 offset:0
  ds_read_b64_tr_b16 v[210:211], v5 offset:512
  ds_read_b64_tr_b16 v[212:213], v6 offset:0
  ds_read_b64_tr_b16 v[214:215], v6 offset:512
  ds_read_b64_tr_b16 v[216:217], v7 offset:0
  ds_read_b64_tr_b16 v[218:219], v7 offset:512
  ds_read_b64_tr_b16 v[220:221], v5 offset:1024
  ds_read_b64_tr_b16 v[222:223], v5 offset:1536
  ds_read_b64_tr_b16 v[224:225], v6 offset:1024
  ds_read_b64_tr_b16 v[226:227], v6 offset:1536
  ds_read_b64_tr_b16 v[228:229], v7 offset:1024
  ds_read_b64_tr_b16 v[230:231], v7 offset:1536
  s_waitcnt vmcnt(15) lgkmcnt(10)
  v_mfma_f32_32x32x16_bf16 v[160:175], v[208:211], v[16:19], 0
  ds_read_b64_tr_b16 v[208:209], v5 offset:2048
  ds_read_b64_tr_b16 v[210:211], v5 offset:2560
  s_add_u32 s23, s25, s44
  buffer_load_dwordx4 v[80:83], v11, s[4:7], s23 offen offset:0 sc1
  s_waitcnt lgkmcnt(10)
  v_mfma_f32_32x32x16_bf16 v[176:191], v[212:215], v[16:19], 0
  ds_read_b64_tr_b16 v[212:213], v6 offset:2048
  ds_read_b64_tr_b16 v[214:215], v6 offset:2560
  s_waitcnt lgkmcnt(10)
  v_mfma_f32_32x32x16_bf16 v[192:207], v[216:219], v[16:19], 0
  ds_read_b64_tr_b16 v[216:217], v7 offset:2048
  ds_read_b64_tr_b16 v[218:219], v7 offset:2560
  s_waitcnt vmcnt(15) lgkmcnt(10)
  v_mfma_f32_32x32x16_bf16 v[160:175], v[220:223], v[20:23], v[160:175]
  ds_read_b64_tr_b16 v[220:221], v5 offset:3072
  ds_read_b64_tr_b16 v[222:223], v5 offset:3584
  buffer_load_dwordx4 v[84:87], v11, s[4:7], s23 offen offset:1024 sc1
  s_waitcnt lgkmcnt(10)
  v_mfma_f32_32x32x16_bf16 v[176:191], v[224:227], v[20:23], v[176:191]
  ds_read_b64_tr_b16 v[224:225], v6 offset:3072
  ds_read_b64_tr_b16 v[226:227], v6 offset:3584
  s_waitcnt lgkmcnt(10)
  v_mfma_f32_32x32x16_bf16 v[192:207], v[228:231], v[20:23], v[192:207]
  ds_read_b64_tr_b16 v[228:229], v7 offset:3072
  ds_read_b64_tr_b16 v[230:231], v7 offset:3584
  s_waitcnt vmcnt(15) lgkmcnt(10)
  v_mfma_f32_32x32x16_bf16 v[160:175], v[208:211], v[24:27], v[160:175]
  ds_read_b64_tr_b16 v[208:209], v5 offset:4096
  ds_read_b64_tr_b16 v[210:211], v5 offset:4608
  buffer_load_dwordx4 v[88:91], v11, s[4:7], s23 offen offset:2048 sc1
  s_waitcnt lgkmcnt(10)
  v_mfma_f32_32x32x16_bf16 v[176:191], v[212:215], v[24:27], v[176:191]
  ds_read_b64_tr_b16 v[212:213], v6 offset:4096
  ds_read_b64_tr_b16 v[214:215], v6 offset:4608
  s_waitcnt lgkmcnt(10)
  v_mfma_f32_32x32x16_bf16 v[192:207], v[216:219], v[24:27], v[192:207]
  ds_read_b64_tr_b16 v[216:217], v7 offset:4096
  ds_read_b64_tr_b16 v[218:219], v7 offset:4608
  s_waitcnt vmcnt(15) lgkmcnt(10)
  v_mfma_f32_32x32x16_bf16 v[160:175], v[220:223], v[28:31], v[160:175]
  ds_read_b64_tr_b16 v[220:221], v5 offset:5120
  ds_read_b64_tr_b16 v[222:223], v5 offset:5632
  buffer_load_dwordx4 v[92:95], v11, s[4:7], s23 offen offset:3072 sc1
  s_waitcnt lgkmcnt(10)
  v_mfma_f32_32x32x16_bf16 v[176:191], v[224:227], v[28:31], v[176:191]
  ds_read_b64_tr_b16 v[224:225], v6 offset:5120
  ds_read_b64_tr_b16 v[226:227], v6 offset:5632
  s_waitcnt lgkmcnt(10)
  v_mfma_f32_32x32x16_bf16 v[192:207], v[228:231], v[28:31], v[192:207]
  ds_read_b64_tr_b16 v[228:229], v7 offset:5120
  ds_read_b64_tr_b16 v[230:231], v7 offset:5632
  s_waitcnt vmcnt(15) lgkmcnt(10)
  v_mfma_f32_32x32x16_bf16 v[160:175], v[208:211], v[32:35], v[160:175]
  ds_read_b64_tr_b16 v[208:209], v5 offset:6144
  ds_read_b64_tr_b16 v[210:211], v5 offset:6656
  s_add_u32 s23, s25, s45
  buffer_load_dwordx4 v[96:99], v11, s[4:7], s23 offen offset:0 sc1
  s_waitcnt lgkmcnt(10)
  v_mfma_f32_32x32x16_bf16 v[176:191], v[212:215], v[32:35], v[176:191]
  ds_read_b64_tr_b16 v[212:213], v6 offset:6144
  ds_read_b64_tr_b16 v[214:215], v6 offset:6656
  s_waitcnt lgkmcnt(10)
  v_mfma_f32_32x32x16_bf16 v[192:207], v[216:219], v[32:35], v[192:207]
  ds_read_b64_tr_b16 v[216:217], v7 offset:6144
  ds_read_b64_tr_b16 v[218:219], v7 offset:6656
  s_waitcnt vmcnt(15) lgkmcnt(10)
  v_mfma_f32_32x32x16_bf16 v[160:175], v[220:223], v[36:39], v[160:175]
  ds_read_b64_tr_b16 v[220:221], v5 offset:7168
  ds_read_b64_tr_b16 v[222:223], v5 offset:7680
  buffer_load_dwordx4 v[100:103], v11, s[4:7], s23 offen offset:1024 sc1
  s_waitcnt lgkmcnt(10)
  v_mfma_f32_32x32x16_bf16 v[176:191], v[224:227], v[36:39], v[176:191]
  ds_read_b64_tr_b16 v[224:225], v6 offset:7168
  ds_read_b64_tr_b16 v[226:227], v6 offset:7680
  s_waitcnt lgkmcnt(10)
  v_mfma_f32_32x32x16_bf16 v[192:207], v[228:231], v[36:39], v[192:207]
  ds_read_b64_tr_b16 v[228:229], v7 offset:7168
  ds_read_b64_tr_b16 v[230:231], v7 offset:7680
  s_waitcnt vmcnt(15) lgkmcnt(10)
  v_mfma_f32_32x32x16_bf16 v[160:175], v[208:211], v[40:43], v[160:175]
  ds_read_b64_tr_b16 v[208:209], v5 offset:8192
  ds_read_b64_tr_b16 v[210:211], v5 offset:8704
  buffer_load_dwordx4 v[104:107], v11, s[4:7], s23 offen offset:2048 sc1
  s_waitcnt lgkmcnt(10)
  v_mfma_f32_32x32x16_bf16 v[176:191], v[212:215], v[40:43], v[176:191]
  ds_read_b64_tr_b16 v[212:213], v6 offset:8192
  ds_read_b64_tr_b16 v[214:215], v6 offset:8704
  s_waitcnt lgkmcnt(10)
  v_mfma_f32_32x32x16_bf16 v[192:207], v[216:219], v[40:43], v[192:207]
  ds_read_b64_tr_b16 v[216:217], v7 offset:8192
  ds_read_b64_tr_b16 v[218:219], v7 offset:8704
  s_waitcnt vmcnt(15) lgkmcnt(10)
  v_mfma_f32_32x32x16_bf16 v[160:175], v[220:223], v[44:47], v[160:175]
  ds_read_b64_tr_b16 v[220:221], v5 offset:9216
  ds_read_b64_tr_b16 v[222:223], v5 offset:9728
  buffer_load_dwordx4 v[108:111], v11, s[4:7], s23 offen offset:3072 sc1
  s_waitcnt lgkmcnt(10)
  v_mfma_f32_32x32x16_bf16 v[176:191], v[224:227], v[44:47], v[176:191]
  ds_read_b64_tr_b16 v[224:225], v6 offset:9216
  ds_read_b64_tr_b16 v[226:227], v6 offset:9728
  s_waitcnt lgkmcnt(10)
  v_mfma_f32_32x32x16_bf16 v[192:207], v[228:231], v[44:47], v[192:207]
  ds_read_b64_tr_b16 v[228:229], v7 offset:9216
  ds_read_b64_tr_b16 v[230:231], v7 offset:9728
  s_waitcnt vmcnt(15) lgkmcnt(10)
  v_mfma_f32_32x32x16_bf16 v[160:175], v[208:211], v[48:51], v[160:175]
  ds_read_b64_tr_b16 v[208:209], v5 offset:10240
  ds_read_b64_tr_b16 v[210:211], v5 offset:10752
  s_add_u32 s23, s25, s46
  buffer_load_dwordx4 v[112:115], v11, s[4:7], s23 offen offset:0 sc1
  s_waitcnt lgkmcnt(10)
  v_mfma_f32_32x32x16_bf16 v[176:191], v[212:215], v[48:51], v[176:191]
  ds_read_b64_tr_b16 v[212:213], v6 offset:10240
  ds_read_b64_tr_b16 v[214:215], v6 offset:10752
  s_waitcnt lgkmcnt(10)
  v_mfma_f32_32x32x16_bf16 v[192:207], v[216:219], v[48:51], v[192:207]
  ds_read_b64_tr_b16 v[216:217], v7 offset:10240
  ds_read_b64_tr_b16 v[218:219], v7 offset:10752
  s_waitcnt vmcnt(15) lgkmcnt(10)
  v_mfma_f32_32x32x16_bf16 v[160:175], v[220:223], v[52:55], v[160:175]
  ds_read_b64_tr_b16 v[220:221], v5 offset:11264
  ds_read_b64_tr_b16 v[222:223], v5 offset:11776
  buffer_load_dwordx4 v[116:119], v11, s[4:7], s23 offen offset:1024 sc1
  s_waitcnt lgkmcnt(10)
  v_mfma_f32_32x32x16_bf16 v[176:191], v[224:227], v[52:55], v[176:191]
  ds_read_b64_tr_b16 v[224:225], v6 offset:11264
  ds_read_b64_tr_b16 v[226:227], v6 offset:11776
  s_waitcnt lgkmcnt(10)
  v_mfma_f32_32x32x16_bf16 v[192:207], v[228:231], v[52:55], v[192:207]
  ds_read_b64_tr_b16 v[228:229], v7 offset:11264
  ds_read_b64_tr_b16 v[230:231], v7 offset:11776
  s_waitcnt vmcnt(15) lgkmcnt(10)
  v_mfma_f32_32x32x16_bf16 v[160:175], v[208:211], v[56:59], v[160:175]
  ds_read_b64_tr_b16 v[208:209], v5 offset:12288
  ds_read_b64_tr_b16 v[210:211], v5 offset:12800
  buffer_load_dwordx4 v[120:123], v11, s[4:7], s23 offen offset:2048 sc1
  s_waitcnt lgkmcnt(10)
  v_mfma_f32_32x32x16_bf16 v[176:191], v[212:215], v[56:59], v[176:191]
  ds_read_b64_tr_b16 v[212:213], v6 offset:12288
  ds_read_b64_tr_b16 v[214:215], v6 offset:12800
  s_waitcnt lgkmcnt(10)
  v_mfma_f32_32x32x16_bf16 v[192:207], v[216:219], v[56:59], v[192:207]
  ds_read_b64_tr_b16 v[216:217], v7 offset:12288
  ds_read_b64_tr_b16 v[218:219], v7 offset:12800
  s_waitcnt vmcnt(15) lgkmcnt(10)
  v_mfma_f32_32x32x16_bf16 v[160:175], v[220:223], v[60:63], v[160:175]
  ds_read_b64_tr_b16 v[220:221], v5 offset:13312
  ds_read_b64_tr_b16 v[222:223], v5 offset:13824
  buffer_load_dwordx4 v[124:127], v11, s[4:7], s23 offen offset:3072 sc1
  s_waitcnt lgkmcnt(10)
  v_mfma_f32_32x32x16_bf16 v[176:191], v[224:227], v[60:63], v[176:191]
  ds_read_b64_tr_b16 v[224:225], v6 offset:13312
  ds_read_b64_tr_b16 v[226:227], v6 offset:13824
  s_waitcnt lgkmcnt(10)
  v_mfma_f32_32x32x16_bf16 v[192:207], v[228:231], v[60:63], v[192:207]
  ds_read_b64_tr_b16 v[228:229], v7 offset:13312
  ds_read_b64_tr_b16 v[230:231], v7 offset:13824
  s_waitcnt vmcnt(15) lgkmcnt(10)
  v_mfma_f32_32x32x16_bf16 v[160:175], v[208:211], v[64:67], v[160:175]
  ds_read_b64_tr_b16 v[208:209], v5 offset:14336
  ds_read_b64_tr_b16 v[210:211], v5 offset:14848
  s_add_u32 s23, s25, s47
  buffer_load_dwordx4 v[128:131], v11, s[4:7], s23 offen offset:0 sc1
  s_waitcnt lgkmcnt(10)
  v_mfma_f32_32x32x16_bf16 v[176:191], v[212:215], v[64:67], v[176:191]
  ds_read_b64_tr_b16 v[212:213], v6 offset:14336
  ds_read_b64_tr_b16 v[214:215], v6 offset:14848
  s_waitcnt lgkmcnt(10)
  v_mfma_f32_32x32x16_bf16 v[192:207], v[216:219], v[64:67], v[192:207]
  ds_read_b64_tr_b16 v[216:217], v7 offset:14336
  ds_read_b64_tr_b16 v[218:219], v7 offset:14848
  s_waitcnt vmcnt(15) lgkmcnt(10)
  v_mfma_f32_32x32x16_bf16 v[160:175], v[220:223], v[68:71], v[160:175]
  ds_read_b64_tr_b16 v[220:221], v5 offset:15360
  ds_read_b64_tr_b16 v[222:223], v5 offset:15872
  buffer_load_dwordx4 v[132:135], v11, s[4:7], s23 offen offset:1024 sc1
  s_waitcnt lgkmcnt(10)
  v_mfma_f32_32x32x16_bf16 v[176:191], v[224:227], v[68:71], v[176:191]
  ds_read_b64_tr_b16 v[224:225], v6 offset:15360
  ds_read_b64_tr_b16 v[226:227], v6 offset:15872
  s_waitcnt lgkmcnt(10)
  v_mfma_f32_32x32x16_bf16 v[192:207], v[228:231], v[68:71], v[192:207]
  ds_read_b64_tr_b16 v[228:229], v7 offset:15360
  ds_read_b64_tr_b16 v[230:231], v7 offset:15872
  s_waitcnt vmcnt(15) lgkmcnt(10)
  v_mfma_f32_32x32x16_bf16 v[160:175], v[208:211], v[72:75], v[160:175]
  ds_read_b64_tr_b16 v[208:209], v5 offset:16384
  ds_read_b64_tr_b16 v[210:211], v5 offset:16896
  buffer_load_dwordx4 v[136:139], v11, s[4:7], s23 offen offset:2048 sc1
  s_waitcnt lgkmcnt(10)
  v_mfma_f32_32x32x16_bf16 v[176:191], v[212:215], v[72:75], v[176:191]
  ds_read_b64_tr_b16 v[212:213], v6 offset:16384
  ds_read_b64_tr_b16 v[214:215], v6 offset:16896
  s_waitcnt lgkmcnt(10)
  v_mfma_f32_32x32x16_bf16 v[192:207], v[216:219], v[72:75], v[192:207]
  ds_read_b64_tr_b16 v[216:217], v7 offset:16384
  ds_read_b64_tr_b16 v[218:219], v7 offset:16896
  s_waitcnt vmcnt(15) lgkmcnt(10)
  v_mfma_f32_32x32x16_bf16 v[160:175], v[220:223], v[76:79], v[160:175]
  ds_read_b64_tr_b16 v[220:221], v5 offset:17408
  ds_read_b64_tr_b16 v[222:223], v5 offset:17920
  buffer_load_dwordx4 v[140:143], v11, s[4:7], s23 offen offset:3072 sc1
  s_waitcnt lgkmcnt(10)
  v_mfma_f32_32x32x16_bf16 v[176:191], v[224:227], v[76:79], v[176:191]
  ds_read_b64_tr_b16 v[224:225], v6 offset:17408
  ds_read_b64_tr_b16 v[226:227], v6 offset:17920
  s_waitcnt lgkmcnt(10)
  v_mfma_f32_32x32x16_bf16 v[192:207], v[228:231], v[76:79], v[192:207]
  ds_read_b64_tr_b16 v[228:229], v7 offset:17408
  ds_read_b64_tr_b16 v[230:231], v7 offset:17920
  s_waitcnt vmcnt(15) lgkmcnt(10)
  v_mfma_f32_32x32x16_bf16 v[160:175], v[208:211], v[80:83], v[160:175]
  ds_read_b64_tr_b16 v[208:209], v5 offset:18432
  ds_read_b64_tr_b16 v[210:211], v5 offset:18944
  s_mov_b32 s26, 0
  buffer_load_dword v144, v14, s[68:71], s26 offen sc1
  s_mov_b32 s26, 8192
  buffer_load_dword v145, v14, s[68:71], s26 offen sc1
  s_mov_b32 s26, 16384
  buffer_load_dword v146, v14, s[68:71], s26 offen sc1
  s_mov_b32 s26, 24576
  buffer_load_dword v147, v14, s[68:71], s26 offen sc1
  s_waitcnt lgkmcnt(10)
  v_mfma_f32_32x32x16_bf16 v[176:191], v[212:215], v[80:83], v[176:191]
  ds_read_b64_tr_b16 v[212:213], v6 offset:18432
  ds_read_b64_tr_b16 v[214:215], v6 offset:18944
  s_waitcnt lgkmcnt(10)
  v_mfma_f32_32x32x16_bf16 v[192:207], v[216:219], v[80:83], v[192:207]
  ds_read_b64_tr_b16 v[216:217], v7 offset:18432
  ds_read_b64_tr_b16 v[218:219], v7 offset:18944
  s_waitcnt vmcnt(18) lgkmcnt(10)
  v_mfma_f32_32x32x16_bf16 v[160:175], v[220:223], v[84:87], v[160:175]
  ds_read_b64_tr_b16 v[220:221], v5 offset:19456
  ds_read_b64_tr_b16 v[222:223], v5 offset:19968
  s_mov_b32 s26, 65536
  buffer_load_dword v148, v14, s[68:71], s26 offen sc1
  s_mov_b32 s26, 73728
  buffer_load_dword v149, v14, s[68:71], s26 offen sc1
  s_mov_b32 s26, 81920
  buffer_load_dword v150, v14, s[68:71], s26 offen sc1
  s_mov_b32 s26, 90112
  buffer_load_dword v151, v14, s[68:71], s26 offen sc1
  s_waitcnt lgkmcnt(10)
  v_mfma_f32_32x32x16_bf16 v[176:191], v[224:227], v[84:87], v[176:191]
  ds_read_b64_tr_b16 v[224:225], v6 offset:19456
  ds_read_b64_tr_b16 v[226:227], v6 offset:19968
  s_waitcnt lgkmcnt(10)
  v_mfma_f32_32x32x16_bf16 v[192:207], v[228:231], v[84:87], v[192:207]
  ds_read_b64_tr_b16 v[228:229], v7 offset:19456
  ds_read_b64_tr_b16 v[230:231], v7 offset:19968
  s_waitcnt vmcnt(21) lgkmcnt(10)
  v_mfma_f32_32x32x16_bf16 v[160:175], v[208:211], v[88:91], v[160:175]
  ds_read_b64_tr_b16 v[208:209], v5 offset:20480
  ds_read_b64_tr_b16 v[210:211], v5 offset:20992
  s_mov_b32 s26, 131072
  buffer_load_dword v152, v14, s[68:71], s26 offen sc1
  s_mov_b32 s26, 139264
  buffer_load_dword v153, v14, s[68:71], s26 offen sc1
  s_mov_b32 s26, 147456
  buffer_load_dword v154, v14, s[68:71], s26 offen sc1
  s_mov_b32 s26, 155648
  buffer_load_dword v155, v14, s[68:71], s26 offen sc1
  s_waitcnt lgkmcnt(10)
  v_mfma_f32_32x32x16_bf16 v[176:191], v[212:215], v[88:91], v[176:191]
  ds_read_b64_tr_b16 v[212:213], v6 offset:20480
  ds_read_b64_tr_b16 v[214:215], v6 offset:20992
  s_waitcnt lgkmcnt(10)
  v_mfma_f32_32x32x16_bf16 v[192:207], v[216:219], v[88:91], v[192:207]
  ds_read_b64_tr_b16 v[216:217], v7 offset:20480
  ds_read_b64_tr_b16 v[218:219], v7 offset:20992
  s_waitcnt vmcnt(24) lgkmcnt(10)
  v_mfma_f32_32x32x16_bf16 v[160:175], v[220:223], v[92:95], v[160:175]
  ds_read_b64_tr_b16 v[220:221], v5 offset:21504
  ds_read_b64_tr_b16 v[222:223], v5 offset:22016
  s_mov_b32 s26, 196608
  buffer_load_dword v156, v14, s[68:71], s26 offen sc1
  s_mov_b32 s26, 204800
  buffer_load_dword v157, v14, s[68:71], s26 offen sc1
  s_mov_b32 s26, 212992
  buffer_load_dword v158, v14, s[68:71], s26 offen sc1
  s_mov_b32 s26, 221184
  buffer_load_dword v159, v14, s[68:71], s26 offen sc1
  s_waitcnt lgkmcnt(10)
  v_mfma_f32_32x32x16_bf16 v[176:191], v[224:227], v[92:95], v[176:191]
  ds_read_b64_tr_b16 v[224:225], v6 offset:21504
  ds_read_b64_tr_b16 v[226:227], v6 offset:22016
  s_waitcnt lgkmcnt(10)
  v_mfma_f32_32x32x16_bf16 v[192:207], v[228:231], v[92:95], v[192:207]
  ds_read_b64_tr_b16 v[228:229], v7 offset:21504
  ds_read_b64_tr_b16 v[230:231], v7 offset:22016
  s_waitcnt vmcnt(27) lgkmcnt(10)
  v_mfma_f32_32x32x16_bf16 v[160:175], v[208:211], v[96:99], v[160:175]
  ds_read_b64_tr_b16 v[208:209], v5 offset:22528
  ds_read_b64_tr_b16 v[210:211], v5 offset:23040
  s_waitcnt lgkmcnt(10)
  v_mfma_f32_32x32x16_bf16 v[176:191], v[212:215], v[96:99], v[176:191]
  ds_read_b64_tr_b16 v[212:213], v6 offset:22528
  ds_read_b64_tr_b16 v[214:215], v6 offset:23040
  s_waitcnt lgkmcnt(10)
  v_mfma_f32_32x32x16_bf16 v[192:207], v[216:219], v[96:99], v[192:207]
  ds_read_b64_tr_b16 v[216:217], v7 offset:22528
  ds_read_b64_tr_b16 v[218:219], v7 offset:23040
  s_waitcnt vmcnt(26) lgkmcnt(10)
  v_mfma_f32_32x32x16_bf16 v[160:175], v[220:223], v[100:103], v[160:175]
  ds_read_b64_tr_b16 v[220:221], v5 offset:23552
  ds_read_b64_tr_b16 v[222:223], v5 offset:24064
  s_waitcnt lgkmcnt(10)
  v_mfma_f32_32x32x16_bf16 v[176:191], v[224:227], v[100:103], v[176:191]
  ds_read_b64_tr_b16 v[224:225], v6 offset:23552
  ds_read_b64_tr_b16 v[226:227], v6 offset:24064
  s_waitcnt lgkmcnt(10)
  v_mfma_f32_32x32x16_bf16 v[192:207], v[228:231], v[100:103], v[192:207]
  ds_read_b64_tr_b16 v[228:229], v7 offset:23552
  ds_read_b64_tr_b16 v[230:231], v7 offset:24064
  s_waitcnt vmcnt(25) lgkmcnt(10)
  v_mfma_f32_32x32x16_bf16 v[160:175], v[208:211], v[104:107], v[160:175]
  ds_read_b64_tr_b16 v[208:209], v5 offset:24576
  ds_read_b64_tr_b16 v[210:211], v5 offset:25088
  s_waitcnt lgkmcnt(10)
  v_mfma_f32_32x32x16_bf16 v[176:191], v[212:215], v[104:107], v[176:191]
  ds_read_b64_tr_b16 v[212:213], v6 offset:24576
  ds_read_b64_tr_b16 v[214:215], v6 offset:25088
  s_waitcnt lgkmcnt(10)
  v_mfma_f32_32x32x16_bf16 v[192:207], v[216:219], v[104:107], v[192:207]
  ds_read_b64_tr_b16 v[216:217], v7 offset:24576
  ds_read_b64_tr_b16 v[218:219], v7 offset:25088
  s_waitcnt vmcnt(24) lgkmcnt(10)
  v_mfma_f32_32x32x16_bf16 v[160:175], v[220:223], v[108:111], v[160:175]
  ds_read_b64_tr_b16 v[220:221], v5 offset:25600
  ds_read_b64_tr_b16 v[222:223], v5 offset:26112
  s_waitcnt lgkmcnt(10)
  v_mfma_f32_32x32x16_bf16 v[176:191], v[224:227], v[108:111], v[176:191]
  ds_read_b64_tr_b16 v[224:225], v6 offset:25600
  ds_read_b64_tr_b16 v[226:227], v6 offset:26112
  s_waitcnt lgkmcnt(10)
  v_mfma_f32_32x32x16_bf16 v[192:207], v[228:231], v[108:111], v[192:207]
  ds_read_b64_tr_b16 v[228:229], v7 offset:25600
  ds_read_b64_tr_b16 v[230:231], v7 offset:26112
  s_waitcnt vmcnt(23) lgkmcnt(10)
  v_mfma_f32_32x32x16_bf16 v[160:175], v[208:211], v[112:115], v[160:175]
  ds_read_b64_tr_b16 v[208:209], v5 offset:26624
  ds_read_b64_tr_b16 v[210:211], v5 offset:27136
  s_waitcnt lgkmcnt(10)
  v_mfma_f32_32x32x16_bf16 v[176:191], v[212:215], v[112:115], v[176:191]
  ds_read_b64_tr_b16 v[212:213], v6 offset:26624
  ds_read_b64_tr_b16 v[214:215], v6 offset:27136
  s_waitcnt lgkmcnt(10)
  v_mfma_f32_32x32x16_bf16 v[192:207], v[216:219], v[112:115], v[192:207]
  ds_read_b64_tr_b16 v[216:217], v7 offset:26624
  ds_read_b64_tr_b16 v[218:219], v7 offset:27136
  s_waitcnt vmcnt(22) lgkmcnt(10)
  v_mfma_f32_32x32x16_bf16 v[160:175], v[220:223], v[116:119], v[160:175]
  ds_read_b64_tr_b16 v[220:221], v5 offset:27648
  ds_read_b64_tr_b16 v[222:223], v5 offset:28160
  s_waitcnt lgkmcnt(10)
  v_mfma_f32_32x32x16_bf16 v[176:191], v[224:227], v[116:119], v[176:191]
  ds_read_b64_tr_b16 v[224:225], v6 offset:27648
  ds_read_b64_tr_b16 v[226:227], v6 offset:28160
  s_waitcnt lgkmcnt(10)
  v_mfma_f32_32x32x16_bf16 v[192:207], v[228:231], v[116:119], v[192:207]
  ds_read_b64_tr_b16 v[228:229], v7 offset:27648
  ds_read_b64_tr_b16 v[230:231], v7 offset:28160
  s_waitcnt vmcnt(21) lgkmcnt(10)
  v_mfma_f32_32x32x16_bf16 v[160:175], v[208:211], v[120:123], v[160:175]
  ds_read_b64_tr_b16 v[208:209], v5 offset:28672
  ds_read_b64_tr_b16 v[210:211], v5 offset:29184
  s_waitcnt lgkmcnt(10)
  v_mfma_f32_32x32x16_bf16 v[176:191], v[212:215], v[120:123], v[176:191]
  ds_read_b64_tr_b16 v[212:213], v6 offset:28672
  ds_read_b64_tr_b16 v[214:215], v6 offset:29184
  s_waitcnt lgkmcnt(10)
  v_mfma_f32_32x32x16_bf16 v[192:207], v[216:219], v[120:123], v[192:207]
  ds_read_b64_tr_b16 v[216:217], v7 offset:28672
  ds_read_b64_tr_b16 v[218:219], v7 offset:29184
  s_waitcnt vmcnt(20) lgkmcnt(10)
  v_mfma_f32_32x32x16_bf16 v[160:175], v[220:223], v[124:127], v[160:175]
  ds_read_b64_tr_b16 v[220:221], v5 offset:29696
  ds_read_b64_tr_b16 v[222:223], v5 offset:30208
  s_waitcnt lgkmcnt(10)
  v_mfma_f32_32x32x16_bf16 v[176:191], v[224:227], v[124:127], v[176:191]
  ds_read_b64_tr_b16 v[224:225], v6 offset:29696
  ds_read_b64_tr_b16 v[226:227], v6 offset:30208
  s_waitcnt lgkmcnt(10)
  v_mfma_f32_32x32x16_bf16 v[192:207], v[228:231], v[124:127], v[192:207]
  ds_read_b64_tr_b16 v[228:229], v7 offset:29696
  ds_read_b64_tr_b16 v[230:231], v7 offset:30208
  s_waitcnt vmcnt(19) lgkmcnt(10)
  v_mfma_f32_32x32x16_bf16 v[160:175], v[208:211], v[128:131], v[160:175]
  ds_read_b64_tr_b16 v[208:209], v5 offset:30720
  ds_read_b64_tr_b16 v[210:211], v5 offset:31232
  s_waitcnt lgkmcnt(10)
  v_mfma_f32_32x32x16_bf16 v[176:191], v[212:215], v[128:131], v[176:191]
  ds_read_b64_tr_b16 v[212:213], v6 offset:30720
  ds_read_b64_tr_b16 v[214:215], v6 offset:31232
  s_waitcnt lgkmcnt(10)
  v_mfma_f32_32x32x16_bf16 v[192:207], v[216:219], v[128:131], v[192:207]
  ds_read_b64_tr_b16 v[216:217], v7 offset:30720
  ds_read_b64_tr_b16 v[218:219], v7 offset:31232
  s_waitcnt vmcnt(18) lgkmcnt(10)
  v_mfma_f32_32x32x16_bf16 v[160:175], v[220:223], v[132:135], v[160:175]
  ds_read_b64_tr_b16 v[220:221], v5 offset:31744
  ds_read_b64_tr_b16 v[222:223], v5 offset:32256
  s_waitcnt lgkmcnt(10)
  v_mfma_f32_32x32x16_bf16 v[176:191], v[224:227], v[132:135], v[176:191]
  ds_read_b64_tr_b16 v[224:225], v6 offset:31744
  ds_read_b64_tr_b16 v[226:227], v6 offset:32256
  s_waitcnt lgkmcnt(10)
  v_mfma_f32_32x32x16_bf16 v[192:207], v[228:231], v[132:135], v[192:207]
  ds_read_b64_tr_b16 v[228:229], v7 offset:31744
  ds_read_b64_tr_b16 v[230:231], v7 offset:32256
  s_waitcnt vmcnt(17) lgkmcnt(10)
  v_mfma_f32_32x32x16_bf16 v[160:175], v[208:211], v[136:139], v[160:175]
  ds_read_b64_tr_b16 v[208:209], v5 offset:32768
  ds_read_b64_tr_b16 v[210:211], v5 offset:33280
  s_waitcnt lgkmcnt(10)
  v_mfma_f32_32x32x16_bf16 v[176:191], v[212:215], v[136:139], v[176:191]
  ds_read_b64_tr_b16 v[212:213], v6 offset:32768
  ds_read_b64_tr_b16 v[214:215], v6 offset:33280
  s_waitcnt lgkmcnt(10)
  v_mfma_f32_32x32x16_bf16 v[192:207], v[216:219], v[136:139], v[192:207]
  ds_read_b64_tr_b16 v[216:217], v7 offset:32768
  ds_read_b64_tr_b16 v[218:219], v7 offset:33280
  s_waitcnt vmcnt(16) lgkmcnt(10)
  v_mfma_f32_32x32x16_bf16 v[160:175], v[220:223], v[140:143], v[160:175]
  ds_read_b64_tr_b16 v[220:221], v5 offset:33792
  ds_read_b64_tr_b16 v[222:223], v5 offset:34304
  s_waitcnt lgkmcnt(10)
  v_mfma_f32_32x32x16_bf16 v[176:191], v[224:227], v[140:143], v[176:191]
  ds_read_b64_tr_b16 v[224:225], v6 offset:33792
  ds_read_b64_tr_b16 v[226:227], v6 offset:34304
  s_waitcnt lgkmcnt(10)
  v_mfma_f32_32x32x16_bf16 v[192:207], v[228:231], v[140:143], v[192:207]
  ds_read_b64_tr_b16 v[228:229], v7 offset:33792
  ds_read_b64_tr_b16 v[230:231], v7 offset:34304
  s_waitcnt vmcnt(12) lgkmcnt(10)
  v_mfma_f32_32x32x16_bf16 v[160:175], v[208:211], v[144:147], v[160:175]
  ds_read_b64_tr_b16 v[208:209], v5 offset:34816
  ds_read_b64_tr_b16 v[210:211], v5 offset:35328
  s_waitcnt lgkmcnt(10)
  v_mfma_f32_32x32x16_bf16 v[176:191], v[212:215], v[144:147], v[176:191]
  ds_read_b64_tr_b16 v[212:213], v6 offset:34816
  ds_read_b64_tr_b16 v[214:215], v6 offset:35328
  s_waitcnt lgkmcnt(10)
  v_mfma_f32_32x32x16_bf16 v[192:207], v[216:219], v[144:147], v[192:207]
  ds_read_b64_tr_b16 v[216:217], v7 offset:34816
  ds_read_b64_tr_b16 v[218:219], v7 offset:35328
  s_waitcnt vmcnt(8) lgkmcnt(10)
  v_mfma_f32_32x32x16_bf16 v[160:175], v[220:223], v[148:151], v[160:175]
  ds_read_b64_tr_b16 v[220:221], v5 offset:35840
  ds_read_b64_tr_b16 v[222:223], v5 offset:36352
  s_waitcnt lgkmcnt(10)
  v_mfma_f32_32x32x16_bf16 v[176:191], v[224:227], v[148:151], v[176:191]
  ds_read_b64_tr_b16 v[224:225], v6 offset:35840
  ds_read_b64_tr_b16 v[226:227], v6 offset:36352
  s_waitcnt lgkmcnt(10)
  v_mfma_f32_32x32x16_bf16 v[192:207], v[228:231], v[148:151], v[192:207]
  ds_read_b64_tr_b16 v[228:229], v7 offset:35840
  ds_read_b64_tr_b16 v[230:231], v7 offset:36352
  s_waitcnt vmcnt(4) lgkmcnt(10)
  v_mfma_f32_32x32x16_bf16 v[160:175], v[208:211], v[152:155], v[160:175]
  s_waitcnt lgkmcnt(8)
  v_mfma_f32_32x32x16_bf16 v[176:191], v[212:215], v[152:155], v[176:191]
  s_waitcnt lgkmcnt(6)
  v_mfma_f32_32x32x16_bf16 v[192:207], v[216:219], v[152:155], v[192:207]
  s_waitcnt vmcnt(0) lgkmcnt(4)
  v_mfma_f32_32x32x16_bf16 v[160:175], v[220:223], v[156:159], v[160:175]
  s_waitcnt lgkmcnt(2)
  v_mfma_f32_32x32x16_bf16 v[176:191], v[224:227], v[156:159], v[176:191]
  s_waitcnt lgkmcnt(0)
  v_mfma_f32_32x32x16_bf16 v[192:207], v[228:231], v[156:159], v[192:207]
  s_add_u32 s26, s22, 64
  s_lshl_b32 s26, s26, 7
  v_mov_b32 v2, s26
  s_mov_b32 s77, 131072
L_wpoll_4:
  buffer_load_dword v3, v2, s[72:75], 0 offen sc1
  s_waitcnt vmcnt(0)
  v_readfirstlane_b32 s76, v3
  s_nop 0
  s_cmp_ge_u32 s76, 6
  s_cbranch_scc1 L_wgot_5
  s_sub_u32 s77, s77, 1
  s_cbranch_scc1 L_wgot_5
  s_sleep 8
  s_branch L_wpoll_4
L_wgot_5:
  s_mul_i32 s23, s21, 6144
  s_add_u32 s25, s25, s23
  s_add_u32 s24, s25, 4096
  buffer_load_dwordx4 a[0:3], v11, s[60:63], s25 offen offset:0 sc1
  buffer_load_dwordx4 a[4:7], v11, s[60:63], s25 offen offset:1024 sc1
  buffer_load_dwordx4 a[72:75], v11, s[60:63], s25 offen offset:2048 sc1
  buffer_load_dwordx4 a[76:79], v11, s[60:63], s25 offen offset:3072 sc1
  buffer_load_dwordx4 a[144:147], v11, s[60:63], s24 offen offset:0 sc1
  buffer_load_dwordx4 a[148:151], v11, s[60:63], s24 offen offset:1024 sc1
  v_sub_f32 v13, 1.0, v12
  s_waitcnt vmcnt(5)
  v_mfma_f32_32x32x16_bf16 v[16:31], v[240:243], a[0:3], 0
  s_waitcnt vmcnt(4)
  v_mfma_f32_32x32x16_bf16 v[16:31], v[244:247], a[4:7], v[16:31]
  s_waitcnt vmcnt(3)
  v_mfma_f32_32x32x16_bf16 v[32:47], v[240:243], a[72:75], 0
  s_waitcnt vmcnt(2)
  v_mfma_f32_32x32x16_bf16 v[32:47], v[244:247], a[76:79], v[32:47]
  s_waitcnt vmcnt(1)
  v_mfma_f32_32x32x16_bf16 v[48:63], v[240:243], a[144:147], 0
  s_waitcnt vmcnt(0)
  v_mfma_f32_32x32x16_bf16 v[48:63], v[244:247], a[148:151], v[48:63]
  s_mul_i32 s26, s22, 6
  s_add_u32 s26, s26, s21
  s_add_u32 s26, s26, 128
  s_lshl_b32 s26, s26, 7
  v_mov_b32 v2, s26
  s_mov_b32 s77, 131072
L_wpoll_6:
  buffer_load_dword v3, v2, s[72:75], 0 offen sc1
  s_waitcnt vmcnt(0)
  v_readfirstlane_b32 s76, v3
  s_nop 0
  s_cmp_ge_u32 s76, 8
  s_cbranch_scc1 L_wgot_7
  s_sub_u32 s77, s77, 1
  s_cbranch_scc1 L_wgot_7
  s_sleep 8
  s_branch L_wpoll_6
L_wgot_7:
  s_add_u32 s23, s25, 0
  buffer_load_dwordx4 a[8:11], v11, s[16:19], s23 offen offset:0 sc1
  buffer_load_dwordx4 a[12:15], v11, s[16:19], s23 offen offset:1024 sc1
  s_add_u32 s23, s25, 2359296
  buffer_load_dwordx4 a[16:19], v11, s[16:19], s23 offen offset:0 sc1
  buffer_load_dwordx4 a[20:23], v11, s[16:19], s23 offen offset:1024 sc1
  s_add_u32 s23, s25, 4718592
  buffer_load_dwordx4 a[24:27], v11, s[16:19], s23 offen offset:0 sc1
  buffer_load_dwordx4 a[28:31], v11, s[16:19], s23 offen offset:1024 sc1
  s_add_u32 s23, s25, 7077888
  buffer_load_dwordx4 a[32:35], v11, s[16:19], s23 offen offset:0 sc1
  buffer_load_dwordx4 a[36:39], v11, s[16:19], s23 offen offset:1024 sc1
  s_add_u32 s23, s25, 9437184
  buffer_load_dwordx4 a[40:43], v11, s[16:19], s23 offen offset:0 sc1
  buffer_load_dwordx4 a[44:47], v11, s[16:19], s23 offen offset:1024 sc1
  s_add_u32 s23, s25, 11796480
  buffer_load_dwordx4 a[48:51], v11, s[16:19], s23 offen offset:0 sc1
  buffer_load_dwordx4 a[52:55], v11, s[16:19], s23 offen offset:1024 sc1
  s_add_u32 s23, s25, 14155776
  buffer_load_dwordx4 a[56:59], v11, s[16:19], s23 offen offset:0 sc1
  buffer_load_dwordx4 a[60:63], v11, s[16:19], s23 offen offset:1024 sc1
  s_add_u32 s23, s25, 16515072
  buffer_load_dwordx4 a[64:67], v11, s[16:19], s23 offen offset:0 sc1
  buffer_load_dwordx4 a[68:71], v11, s[16:19], s23 offen offset:1024 sc1
  s_add_u32 s23, s25, 0
  buffer_load_dwordx4 a[80:83], v11, s[16:19], s23 offen offset:2048 sc1
  buffer_load_dwordx4 a[84:87], v11, s[16:19], s23 offen offset:3072 sc1
  s_add_u32 s23, s25, 2359296
  buffer_load_dwordx4 a[88:91], v11, s[16:19], s23 offen offset:2048 sc1
  buffer_load_dwordx4 a[92:95], v11, s[16:19], s23 offen offset:3072 sc1
  s_add_u32 s23, s25, 4718592
  buffer_load_dwordx4 a[96:99], v11, s[16:19], s23 offen offset:2048 sc1
  buffer_load_dwordx4 a[100:103], v11, s[16:19], s23 offen offset:3072 sc1
  s_add_u32 s23, s25, 7077888
  buffer_load_dwordx4 a[104:107], v11, s[16:19], s23 offen offset:2048 sc1
  buffer_load_dwordx4 a[108:111], v11, s[16:19], s23 offen offset:3072 sc1
  s_add_u32 s23, s25, 9437184
  buffer_load_dwordx4 a[112:115], v11, s[16:19], s23 offen offset:2048 sc1
  buffer_load_dwordx4 a[116:119], v11, s[16:19], s23 offen offset:3072 sc1
  s_add_u32 s23, s25, 11796480
  buffer_load_dwordx4 a[120:123], v11, s[16:19], s23 offen offset:2048 sc1
  buffer_load_dwordx4 a[124:127], v11, s[16:19], s23 offen offset:3072 sc1
  s_add_u32 s23, s25, 14155776
  buffer_load_dwordx4 a[128:131], v11, s[16:19], s23 offen offset:2048 sc1
  buffer_load_dwordx4 a[132:135], v11, s[16:19], s23 offen offset:3072 sc1
  s_add_u32 s23, s25, 16515072
  buffer_load_dwordx4 a[136:139], v11, s[16:19], s23 offen offset:2048 sc1
  buffer_load_dwordx4 a[140:143], v11, s[16:19], s23 offen offset:3072 sc1
  s_add_u32 s23, s24, 0
  buffer_load_dwordx4 a[152:155], v11, s[16:19], s23 offen offset:0 sc1
  buffer_load_dwordx4 a[156:159], v11, s[16:19], s23 offen offset:1024 sc1
  s_add_u32 s23, s24, 2359296
  buffer_load_dwordx4 a[160:163], v11, s[16:19], s23 offen offset:0 sc1
  buffer_load_dwordx4 a[164:167], v11, s[16:19], s23 offen offset:1024 sc1
  s_add_u32 s23, s24, 4718592
  buffer_load_dwordx4 a[168:171], v11, s[16:19], s23 offen offset:0 sc1
  buffer_load_dwordx4 a[172:175], v11, s[16:19], s23 offen offset:1024 sc1
  s_add_u32 s23, s24, 7077888
  buffer_load_dwordx4 a[176:179], v11, s[16:19], s23 offen offset:0 sc1
  buffer_load_dwordx4 a[180:183], v11, s[16:19], s23 offen offset:1024 sc1
  s_add_u32 s23, s24, 9437184
  buffer_load_dwordx4 a[184:187], v11, s[16:19], s23 offen offset:0 sc1
  buffer_load_dwordx4 a[188:191], v11, s[16:19], s23 offen offset:1024 sc1
  s_add_u32 s23, s24, 11796480
  buffer_load_dwordx4 a[192:195], v11, s[16:19], s23 offen offset:0 sc1
  buffer_load_dwordx4 a[196:199], v11, s[16:19], s23 offen offset:1024 sc1
  s_add_u32 s23, s24, 14155776
  buffer_load_dwordx4 a[200:203], v11, s[16:19], s23 offen offset:0 sc1
  buffer_load_dwordx4 a[204:207], v11, s[16:19], s23 offen offset:1024 sc1
  s_add_u32 s23, s24, 16515072
  buffer_load_dwordx4 a[208:211], v11, s[16:19], s23 offen offset:0 sc1
  buffer_load_dwordx4 a[212:215], v11, s[16:19], s23 offen offset:1024 sc1
  s_waitcnt vmcnt(47)
  v_mfma_f32_32x32x16_bf16 v[16:31], v[240:243], a[8:11], v[16:31]
  s_waitcnt vmcnt(46)
  v_mfma_f32_32x32x16_bf16 v[16:31], v[244:247], a[12:15], v[16:31]
  s_waitcnt vmcnt(45)
  v_mfma_f32_32x32x16_bf16 v[16:31], v[240:243], a[16:19], v[16:31]
  s_waitcnt vmcnt(44)
  v_mfma_f32_32x32x16_bf16 v[16:31], v[244:247], a[20:23], v[16:31]
  s_waitcnt vmcnt(43)
  v_mfma_f32_32x32x16_bf16 v[16:31], v[240:243], a[24:27], v[16:31]
  s_waitcnt vmcnt(42)
  v_mfma_f32_32x32x16_bf16 v[16:31], v[244:247], a[28:31], v[16:31]
  s_waitcnt vmcnt(41)
  v_mfma_f32_32x32x16_bf16 v[16:31], v[240:243], a[32:35], v[16:31]
  s_waitcnt vmcnt(40)
  v_mfma_f32_32x32x16_bf16 v[16:31], v[244:247], a[36:39], v[16:31]
  s_waitcnt vmcnt(39)
  v_mfma_f32_32x32x16_bf16 v[16:31], v[240:243], a[40:43], v[16:31]
  s_waitcnt vmcnt(38)
  v_mfma_f32_32x32x16_bf16 v[16:31], v[244:247], a[44:47], v[16:31]
  s_waitcnt vmcnt(37)
  v_mfma_f32_32x32x16_bf16 v[16:31], v[240:243], a[48:51], v[16:31]
  s_waitcnt vmcnt(36)
  v_mfma_f32_32x32x16_bf16 v[16:31], v[244:247], a[52:55], v[16:31]
  s_waitcnt vmcnt(35)
  v_mfma_f32_32x32x16_bf16 v[16:31], v[240:243], a[56:59], v[16:31]
  s_waitcnt vmcnt(34)
  v_mfma_f32_32x32x16_bf16 v[16:31], v[244:247], a[60:63], v[16:31]
  s_waitcnt vmcnt(33)
  v_mfma_f32_32x32x16_bf16 v[16:31], v[240:243], a[64:67], v[16:31]
  s_waitcnt vmcnt(32)
  v_mfma_f32_32x32x16_bf16 v[16:31], v[244:247], a[68:71], v[16:31]
  s_nop 11
  v_mul_f32 v16, v13, v16
  v_fma_f32 v16, v160, v12, v16
  v_mul_f32 v17, v13, v17
  v_fma_f32 v17, v161, v12, v17
  v_mul_f32 v18, v13, v18
  v_fma_f32 v18, v162, v12, v18
  v_mul_f32 v19, v13, v19
  v_fma_f32 v19, v163, v12, v19
  v_mul_f32 v20, v13, v20
  v_fma_f32 v20, v164, v12, v20
  v_mul_f32 v21, v13, v21
  v_fma_f32 v21, v165, v12, v21
  v_mul_f32 v22, v13, v22
  v_fma_f32 v22, v166, v12, v22
  v_mul_f32 v23, v13, v23
  v_fma_f32 v23, v167, v12, v23
  v_mul_f32 v24, v13, v24
  v_fma_f32 v24, v168, v12, v24
  v_mul_f32 v25, v13, v25
  v_fma_f32 v25, v169, v12, v25
  v_mul_f32 v26, v13, v26
  v_fma_f32 v26, v170, v12, v26
  v_mul_f32 v27, v13, v27
  v_fma_f32 v27, v171, v12, v27
  v_mul_f32 v28, v13, v28
  v_fma_f32 v28, v172, v12, v28
  v_mul_f32 v29, v13, v29
  v_fma_f32 v29, v173, v12, v29
  v_mul_f32 v30, v13, v30
  v_fma_f32 v30, v174, v12, v30
  v_mul_f32 v31, v13, v31
  v_fma_f32 v31, v175, v12, v31
  v_cvt_pk_bf16_f32 v80, v16, v17
  v_cvt_pk_bf16_f32 v81, v18, v19
  v_cvt_pk_bf16_f32 v82, v20, v21
  v_cvt_pk_bf16_f32 v83, v22, v23
  v_cvt_pk_bf16_f32 v84, v24, v25
  v_cvt_pk_bf16_f32 v85, v26, v27
  v_cvt_pk_bf16_f32 v86, v28, v29
  v_cvt_pk_bf16_f32 v87, v30, v31
  v_permlane32_swap_b32 v80, v82
  v_permlane32_swap_b32 v81, v83
  v_permlane32_swap_b32 v84, v86
  v_permlane32_swap_b32 v85, v87
  buffer_store_dwordx4 v[80:83], v10, s[12:15], 0 offen offset:0
  buffer_store_dwordx4 v[84:87], v10, s[12:15], 0 offen offset:32
  s_waitcnt vmcnt(33)
  v_mfma_f32_32x32x16_bf16 v[32:47], v[240:243], a[80:83], v[32:47]
  s_waitcnt vmcnt(32)
  v_mfma_f32_32x32x16_bf16 v[32:47], v[244:247], a[84:87], v[32:47]
  s_waitcnt vmcnt(31)
  v_mfma_f32_32x32x16_bf16 v[32:47], v[240:243], a[88:91], v[32:47]
  s_waitcnt vmcnt(30)
  v_mfma_f32_32x32x16_bf16 v[32:47], v[244:247], a[92:95], v[32:47]
  s_waitcnt vmcnt(29)
  v_mfma_f32_32x32x16_bf16 v[32:47], v[240:243], a[96:99], v[32:47]
  s_waitcnt vmcnt(28)
  v_mfma_f32_32x32x16_bf16 v[32:47], v[244:247], a[100:103], v[32:47]
  s_waitcnt vmcnt(27)
  v_mfma_f32_32x32x16_bf16 v[32:47], v[240:243], a[104:107], v[32:47]
  s_waitcnt vmcnt(26)
  v_mfma_f32_32x32x16_bf16 v[32:47], v[244:247], a[108:111], v[32:47]
  s_waitcnt vmcnt(25)
  v_mfma_f32_32x32x16_bf16 v[32:47], v[240:243], a[112:115], v[32:47]
  s_waitcnt vmcnt(24)
  v_mfma_f32_32x32x16_bf16 v[32:47], v[244:247], a[116:119], v[32:47]
  s_waitcnt vmcnt(23)
  v_mfma_f32_32x32x16_bf16 v[32:47], v[240:243], a[120:123], v[32:47]
  s_waitcnt vmcnt(22)
  v_mfma_f32_32x32x16_bf16 v[32:47], v[244:247], a[124:127], v[32:47]
  s_waitcnt vmcnt(21)
  v_mfma_f32_32x32x16_bf16 v[32:47], v[240:243], a[128:131], v[32:47]
  s_waitcnt vmcnt(20)
  v_mfma_f32_32x32x16_bf16 v[32:47], v[244:247], a[132:135], v[32:47]
  s_waitcnt vmcnt(19)
  v_mfma_f32_32x32x16_bf16 v[32:47], v[240:243], a[136:139], v[32:47]
  s_waitcnt vmcnt(18)
  v_mfma_f32_32x32x16_bf16 v[32:47], v[244:247], a[140:143], v[32:47]
  s_nop 11
  v_mul_f32 v32, v13, v32
  v_fma_f32 v32, v176, v12, v32
  v_mul_f32 v33, v13, v33
  v_fma_f32 v33, v177, v12, v33
  v_mul_f32 v34, v13, v34
  v_fma_f32 v34, v178, v12, v34
  v_mul_f32 v35, v13, v35
  v_fma_f32 v35, v179, v12, v35
  v_mul_f32 v36, v13, v36
  v_fma_f32 v36, v180, v12, v36
  v_mul_f32 v37, v13, v37
  v_fma_f32 v37, v181, v12, v37
  v_mul_f32 v38, v13, v38
  v_fma_f32 v38, v182, v12, v38
  v_mul_f32 v39, v13, v39
  v_fma_f32 v39, v183, v12, v39
  v_mul_f32 v40, v13, v40
  v_fma_f32 v40, v184, v12, v40
  v_mul_f32 v41, v13, v41
  v_fma_f32 v41, v185, v12, v41
  v_mul_f32 v42, v13, v42
  v_fma_f32 v42, v186, v12, v42
  v_mul_f32 v43, v13, v43
  v_fma_f32 v43, v187, v12, v43
  v_mul_f32 v44, v13, v44
  v_fma_f32 v44, v188, v12, v44
  v_mul_f32 v45, v13, v45
  v_fma_f32 v45, v189, v12, v45
  v_mul_f32 v46, v13, v46
  v_fma_f32 v46, v190, v12, v46
  v_mul_f32 v47, v13, v47
  v_fma_f32 v47, v191, v12, v47
  v_cvt_pk_bf16_f32 v88, v32, v33
  v_cvt_pk_bf16_f32 v89, v34, v35
  v_cvt_pk_bf16_f32 v90, v36, v37
  v_cvt_pk_bf16_f32 v91, v38, v39
  v_cvt_pk_bf16_f32 v92, v40, v41
  v_cvt_pk_bf16_f32 v93, v42, v43
  v_cvt_pk_bf16_f32 v94, v44, v45
  v_cvt_pk_bf16_f32 v95, v46, v47
  v_permlane32_swap_b32 v88, v90
  v_permlane32_swap_b32 v89, v91
  v_permlane32_swap_b32 v92, v94
  v_permlane32_swap_b32 v93, v95
  buffer_store_dwordx4 v[88:91], v10, s[12:15], 0 offen offset:64
  buffer_store_dwordx4 v[92:95], v10, s[12:15], 0 offen offset:96
  s_waitcnt vmcnt(19)
  v_mfma_f32_32x32x16_bf16 v[48:63], v[240:243], a[152:155], v[48:63]
  s_waitcnt vmcnt(18)
  v_mfma_f32_32x32x16_bf16 v[48:63], v[244:247], a[156:159], v[48:63]
  s_waitcnt vmcnt(17)
  v_mfma_f32_32x32x16_bf16 v[48:63], v[240:243], a[160:163], v[48:63]
  s_waitcnt vmcnt(16)
  v_mfma_f32_32x32x16_bf16 v[48:63], v[244:247], a[164:167], v[48:63]
  s_waitcnt vmcnt(15)
  v_mfma_f32_32x32x16_bf16 v[48:63], v[240:243], a[168:171], v[48:63]
  s_waitcnt vmcnt(14)
  v_mfma_f32_32x32x16_bf16 v[48:63], v[244:247], a[172:175], v[48:63]
  s_waitcnt vmcnt(13)
  v_mfma_f32_32x32x16_bf16 v[48:63], v[240:243], a[176:179], v[48:63]
  s_waitcnt vmcnt(12)
  v_mfma_f32_32x32x16_bf16 v[48:63], v[244:247], a[180:183], v[48:63]
  s_waitcnt vmcnt(11)
  v_mfma_f32_32x32x16_bf16 v[48:63], v[240:243], a[184:187], v[48:63]
  s_waitcnt vmcnt(10)
  v_mfma_f32_32x32x16_bf16 v[48:63], v[244:247], a[188:191], v[48:63]
  s_waitcnt vmcnt(9)
  v_mfma_f32_32x32x16_bf16 v[48:63], v[240:243], a[192:195], v[48:63]
  s_waitcnt vmcnt(8)
  v_mfma_f32_32x32x16_bf16 v[48:63], v[244:247], a[196:199], v[48:63]
  s_waitcnt vmcnt(7)
  v_mfma_f32_32x32x16_bf16 v[48:63], v[240:243], a[200:203], v[48:63]
  s_waitcnt vmcnt(6)
  v_mfma_f32_32x32x16_bf16 v[48:63], v[244:247], a[204:207], v[48:63]
  s_waitcnt vmcnt(5)
  v_mfma_f32_32x32x16_bf16 v[48:63], v[240:243], a[208:211], v[48:63]
  s_waitcnt vmcnt(4)
  v_mfma_f32_32x32x16_bf16 v[48:63], v[244:247], a[212:215], v[48:63]
  s_nop 11
  v_mul_f32 v48, v13, v48
  v_fma_f32 v48, v192, v12, v48
  v_mul_f32 v49, v13, v49
  v_fma_f32 v49, v193, v12, v49
  v_mul_f32 v50, v13, v50
  v_fma_f32 v50, v194, v12, v50
  v_mul_f32 v51, v13, v51
  v_fma_f32 v51, v195, v12, v51
  v_mul_f32 v52, v13, v52
  v_fma_f32 v52, v196, v12, v52
  v_mul_f32 v53, v13, v53
  v_fma_f32 v53, v197, v12, v53
  v_mul_f32 v54, v13, v54
  v_fma_f32 v54, v198, v12, v54
  v_mul_f32 v55, v13, v55
  v_fma_f32 v55, v199, v12, v55
  v_mul_f32 v56, v13, v56
  v_fma_f32 v56, v200, v12, v56
  v_mul_f32 v57, v13, v57
  v_fma_f32 v57, v201, v12, v57
  v_mul_f32 v58, v13, v58
  v_fma_f32 v58, v202, v12, v58
  v_mul_f32 v59, v13, v59
  v_fma_f32 v59, v203, v12, v59
  v_mul_f32 v60, v13, v60
  v_fma_f32 v60, v204, v12, v60
  v_mul_f32 v61, v13, v61
  v_fma_f32 v61, v205, v12, v61
  v_mul_f32 v62, v13, v62
  v_fma_f32 v62, v206, v12, v62
  v_mul_f32 v63, v13, v63
  v_fma_f32 v63, v207, v12, v63
  v_cvt_pk_bf16_f32 v96, v48, v49
  v_cvt_pk_bf16_f32 v97, v50, v51
  v_cvt_pk_bf16_f32 v98, v52, v53
  v_cvt_pk_bf16_f32 v99, v54, v55
  v_cvt_pk_bf16_f32 v100, v56, v57
  v_cvt_pk_bf16_f32 v101, v58, v59
  v_cvt_pk_bf16_f32 v102, v60, v61
  v_cvt_pk_bf16_f32 v103, v62, v63
  v_permlane32_swap_b32 v96, v98
  v_permlane32_swap_b32 v97, v99
  v_permlane32_swap_b32 v100, v102
  v_permlane32_swap_b32 v101, v103
  buffer_store_dwordx4 v[96:99], v10, s[12:15], 0 offen offset:128
  buffer_store_dwordx4 v[100:103], v10, s[12:15], 0 offen offset:160
L_k3_a_end:
  s_branch L_k3_end
L_k3_b:
  s_lshr_b32 s39, s39, 1
  s_cmp_lt_u32 s39, 12
  s_cbranch_scc0 L_k3_pf
  s_lshr_b32 s20, s38, 1
  s_lshl_b32 s20, s20, 2
  s_and_b32 s27, s39, 3
  s_add_u32 s20, s20, s27
  s_lshl_b32 s22, s20, 2
  s_add_u32 s22, s22, s3
  s_and_b32 s37, s38, 1
  s_mul_i32 s37, s37, 3
  s_lshr_b32 s27, s39, 2
  s_add_u32 s37, s37, s27
  s_mov_b64 s[50:51], s[90:91]
  s_mov_b64 s[52:53], s[100:101]
  s_mov_b64 s[54:55], s[80:81]
  v_lshrrev_b32 v2, 2, v1
  s_mov_b32 s23, 1152
  v_mul_lo_u32 v8, v2, s23
  v_and_b32 v2, 3, v1
  v_lshlrev_b32 v2, 4, v2
  v_add_u32 v8, v8, v2
  v_mov_b32 v10, v8
  s_mul_i32 s27, s37, 192
  v_add_u32 v8, s27, v8
  s_mul_i32 s23, s3, 165888
  s_add_u32 s28, s23, 0
  s_add_u32 s29, s23, 18432
  s_add_u32 s30, s23, 36864
  s_add_u32 s31, s23, 55296
  s_add_u32 s32, s23, 73728
  s_add_u32 s33, s23, 92160
  s_add_u32 s34, s23, 110592
  s_add_u32 s35, s23, 129024
  s_add_u32 s36, s23, 147456
  s_mov_b32 s40, 0
  s_mov_b32 s41, 4096
  s_mov_b32 s42, 8192
  s_mov_b32 s43, 12288
  s_mov_b32 s44, 16384
  s_mov_b32 s45, 20480
  s_mov_b32 s46, 24576
  s_mov_b32 s47, 28672
  s_mov_b32 s48, 32768
  v_and_b32 v2, 31, v1
  s_lshl_b32 s23, s22, 5
  v_add_u32 v2, s23, v2
  v_lshrrev_b32 v4, 5, v1
  v_lshlrev_b32 v4, 9, v4
  s_mov_b32 s23, 36864
  s_mov_b32 s26, 2048
  v_add_u32 v3, -1, v2
  v_lshrrev_b32 v11, 5, v3
  v_mul_lo_u32 v11, v11, s23
  v_cmp_gt_u32 vcc, s26, v3
  v_and_b32 v3, 31, v3
  v_lshlrev_b32 v3, 4, v3
  v_add3_u32 v11, v11, v3, v4
  v_mov_b32 v3, 0x40000000
  v_cndmask_b32 v11, v3, v11, vcc
  v_add_u32 v3, 1, v2
  v_lshrrev_b32 v12, 5, v3
  v_mul_lo_u32 v12, v12, s23
  v_cmp_gt_u32 vcc, s26, v3
  v_and_b32 v3, 31, v3
  v_lshlrev_b32 v3, 4, v3
  v_add3_u32 v12, v12, v3, v4
  v_mov_b32 v3, 0x40000000
  v_cndmask_b32 v12, v3, v12, vcc
  v_add_u32 v3, -2, v2
  v_lshrrev_b32 v13, 5, v3
  v_mul_lo_u32 v13, v13, s23
  v_cmp_gt_u32 vcc, s26, v3
  v_and_b32 v3, 31, v3
  v_lshlrev_b32 v3, 4, v3
  v_add3_u32 v13, v13, v3, v4
  v_mov_b32 v3, 0x40000000
  v_cndmask_b32 v13, v3, v13, vcc
  v_add_u32 v3, 2, v2
  v_lshrrev_b32 v14, 5, v3
  v_mul_lo_u32 v14, v14, s23
  v_cmp_gt_u32 vcc, s26, v3
  v_and_b32 v3, 31, v3
  v_lshlrev_b32 v3, 4, v3
  v_add3_u32 v14, v14, v3, v4
  v_mov_b32 v3, 0x40000000
  v_cndmask_b32 v14, v3, v14, vcc
  s_mul_i32 s26, s22, 36864
  s_add_u32 s26, s26, s27
  s_waitcnt lgkmcnt(0)
  s_mov_b32 s8, s50
  s_mov_b32 s9, s51
  s_mov_b32 s10, 663552
  s_mov_b32 s11, 0x20000
  s_add_u32 s4, s52, 7077888
  s_addc_u32 s5, s53, 0
  s_mov_b32 s6, 2359296
  s_mov_b32 s7, 0x20000
  s_add_u32 s12, s52, 9437184
  s_addc_u32 s13, s53, 0
  s_mov_b32 s14, 2359296
  s_mov_b32 s15, 0x20000
  s_mov_b32 s16, s54
  s_mov_b32 s17, s55
  s_mov_b32 s18, 2359296
  s_mov_b32 s19, 0x20000
  s_add_u32 s56, s52, 14172160
  s_addc_u32 s57, s53, 0
  s_mov_b32 s58, 98304
  s_mov_b32 s59, 0x20000
  s_mul_i32 s49, s3, 6144
  s_add_u32 s49, s49, 110592
  s_add_u32 s27, s26, 18432
  s_mul_i32 s24, s3, 9216
  s_add_u32 s24, s24, 0
  s_add_u32 m0, s24, 0
  s_nop 0
  buffer_load_dwordx4 v8, s[8:11], s28 offen lds
  s_add_u32 m0, s24, 1024
  s_nop 0
  buffer_load_dwordx4 v8, s[8:11], s29 offen lds
  s_add_u32 m0, s24, 2048
  s_nop 0
  buffer_load_dwordx4 v8, s[8:11], s30 offen lds
  s_add_u32 m0, s24, 3072
  s_nop 0
  buffer_load_dwordx4 v8, s[8:11], s31 offen lds
  s_add_u32 m0, s24, 4096
  s_nop 0
  buffer_load_dwordx4 v8, s[8:11], s32 offen lds
  s_add_u32 m0, s24, 5120
  s_nop 0
  buffer_load_dwordx4 v8, s[8:11], s33 offen lds
  s_add_u32 m0, s24, 6144
  s_nop 0
  buffer_load_dwordx4 v8, s[8:11], s34 offen lds
  s_add_u32 m0, s24, 7168
  s_nop 0
  buffer_load_dwordx4 v8, s[8:11], s35 offen lds
  s_add_u32 m0, s24, 8192
  s_nop 0
  buffer_load_dwordx4 v8, s[8:11], s36 offen lds
  v_add_u32 v8, 64, v8
  s_mul_i32 s24, s3, 9216
  s_add_u32 s24, s24, 36864
  s_add_u32 m0, s24, 0
  s_nop 0
  buffer_load_dwordx4 v8, s[8:11], s28 offen lds
  s_add_u32 m0, s24, 1024
  s_nop 0
  buffer_load_dwordx4 v8, s[8:11], s29 offen lds
  s_add_u32 m0, s24, 2048
  s_nop 0
  buffer_load_dwordx4 v8, s[8:11], s30 offen lds
  s_add_u32 m0, s24, 3072
  s_nop 0
  buffer_load_dwordx4 v8, s[8:11], s31 offen lds
  s_add_u32 m0, s24, 4096
  s_nop 0
  buffer_load_dwordx4 v8, s[8:11], s32 offen lds
  s_add_u32 m0, s24, 5120
  s_nop 0
  buffer_load_dwordx4 v8, s[8:11], s33 offen lds
  s_add_u32 m0, s24, 6144
  s_nop 0
  buffer_load_dwordx4 v8, s[8:11], s34 offen lds
  s_add_u32 m0, s24, 7168
  s_nop 0
  buffer_load_dwordx4 v8, s[8:11], s35 offen lds
  s_add_u32 m0, s24, 8192
  s_nop 0
  buffer_load_dwordx4 v8, s[8:11], s36 offen lds
  v_add_u32 v8, 64, v8
  s_mul_i32 s24, s3, 9216
  s_add_u32 s24, s24, 73728
  s_add_u32 m0, s24, 0
  s_nop 0
  buffer_load_dwordx4 v8, s[8:11], s28 offen lds
  s_add_u32 m0, s24, 1024
  s_nop 0
  buffer_load_dwordx4 v8, s[8:11], s29 offen lds
  s_add_u32 m0, s24, 2048
  s_nop 0
  buffer_load_dwordx4 v8, s[8:11], s30 offen lds
  s_add_u32 m0, s24, 3072
  s_nop 0
  buffer_load_dwordx4 v8, s[8:11], s31 offen lds
  s_add_u32 m0, s24, 4096
  s_nop 0
  buffer_load_dwordx4 v8, s[8:11], s32 offen lds
  s_add_u32 m0, s24, 5120
  s_nop 0
  buffer_load_dwordx4 v8, s[8:11], s33 offen lds
  s_add_u32 m0, s24, 6144
  s_nop 0
  buffer_load_dwordx4 v8, s[8:11], s34 offen lds
  s_add_u32 m0, s24, 7168
  s_nop 0
  buffer_load_dwordx4 v8, s[8:11], s35 offen lds
  s_add_u32 m0, s24, 8192
  s_nop 0
  buffer_load_dwordx4 v8, s[8:11], s36 offen lds
  v_add_u32 v8, 64, v8
  buffer_load_dwordx4 v[16:19], v11, s[4:7], s40 offen offset:0
  buffer_load_dwordx4 v[20:23], v11, s[4:7], s40 offen offset:1024
  buffer_load_dwordx4 v[24:27], v11, s[4:7], s40 offen offset:2048
  buffer_load_dwordx4 v[28:31], v11, s[4:7], s40 offen offset:3072
  buffer_load_dwordx4 v[32:35], v11, s[4:7], s41 offen offset:0
  buffer_load_dwordx4 v[36:39], v11, s[4:7], s41 offen offset:1024
  buffer_load_dwordx4 v[40:43], v11, s[4:7], s41 offen offset:2048
  buffer_load_dwordx4 v[44:47], v11, s[4:7], s41 offen offset:3072
  buffer_load_dwordx4 v[48:51], v11, s[4:7], s42 offen offset:0
  buffer_load_dwordx4 v[52:55], v12, s[4:7], s42 offen offset:1024
  buffer_load_dwordx4 v[56:59], v12, s[4:7], s42 offen offset:2048
  buffer_load_dwordx4 v[60:63], v12, s[4:7], s42 offen offset:3072
  v_bfe_u32 v2, v1, 2, 2
  v_lshrrev_b32 v3, 5, v1
  v_lshlrev_b32 v3, 2, v3
  v_add_u32 v2, v2, v3
  v_lshlrev_b32 v5, 6, v2
  v_bfe_u32 v2, v1, 4, 1
  v_lshlrev_b32 v2, 5, v2
  v_add_u32 v5, v5, v2
  v_and_b32 v2, 3, v1
  v_lshlrev_b32 v2, 3, v2
  v_add_u32 v5, v5, v2
  v_add_u32 v6, 36864, v5
  v_add_u32 v7, 73728, v5
  v_and_b32 v2, 31, v1
  v_lshlrev_b32 v15, 6, v2
  v_lshrrev_b32 v2, 5, v1
  v_lshlrev_b32 v2, 3, v2
  v_add3_u32 v15, v15, v2, s49
  v_lshlrev_b32 v9, 4, v1
  s_mul_i32 s25, s22, 36864
  s_mul_i32 s23, s37, 6144
  s_add_u32 s25, s25, s23
  v_accvgpr_write_b32 a0, 0
  v_accvgpr_write_b32 a1, 0
  v_accvgpr_write_b32 a2, 0
  v_accvgpr_write_b32 a3, 0
  v_accvgpr_write_b32 a4, 0
  v_accvgpr_write_b32 a5, 0
  v_accvgpr_write_b32 a6, 0
  v_accvgpr_write_b32 a7, 0
  v_accvgpr_write_b32 a8, 0
  v_accvgpr_write_b32 a9, 0
  v_accvgpr_write_b32 a10, 0
  v_accvgpr_write_b32 a11, 0
  v_accvgpr_write_b32 a12, 0
  v_accvgpr_write_b32 a13, 0
  v_accvgpr_write_b32 a14, 0
  v_accvgpr_write_b32 a15, 0
  v_accvgpr_write_b32 a16, 0
  v_accvgpr_write_b32 a17, 0
  v_accvgpr_write_b32 a18, 0
  v_accvgpr_write_b32 a19, 0
  v_accvgpr_write_b32 a20, 0
  v_accvgpr_write_b32 a21, 0
  v_accvgpr_write_b32 a22, 0
  v_accvgpr_write_b32 a23, 0
  v_accvgpr_write_b32 a24, 0
  v_accvgpr_write_b32 a25, 0
  v_accvgpr_write_b32 a26, 0
  v_accvgpr_write_b32 a27, 0
  v_accvgpr_write_b32 a28, 0
  v_accvgpr_write_b32 a29, 0
  v_accvgpr_write_b32 a30, 0
  v_accvgpr_write_b32 a31, 0
  v_accvgpr_write_b32 a32, 0
  v_accvgpr_write_b32 a33, 0
  v_accvgpr_write_b32 a34, 0
  v_accvgpr_write_b32 a35, 0
  v_accvgpr_write_b32 a36, 0
  v_accvgpr_write_b32 a37, 0
  v_accvgpr_write_b32 a38, 0
  v_accvgpr_write_b32 a39, 0
  v_accvgpr_write_b32 a40, 0
  v_accvgpr_write_b32 a41, 0
  v_accvgpr_write_b32 a42, 0
  v_accvgpr_write_b32 a43, 0
  v_accvgpr_write_b32 a44, 0
  v_accvgpr_write_b32 a45, 0
  v_accvgpr_write_b32 a46, 0
  v_accvgpr_write_b32 a47, 0
  v_accvgpr_write_b32 a48, 0
  v_accvgpr_write_b32 a49, 0
  v_accvgpr_write_b32 a50, 0
  v_accvgpr_write_b32 a51, 0
  v_accvgpr_write_b32 a52, 0
  v_accvgpr_write_b32 a53, 0
  v_accvgpr_write_b32 a54, 0
  v_accvgpr_write_b32 a55, 0
  v_accvgpr_write_b32 a56, 0
  v_accvgpr_write_b32 a57, 0
  v_accvgpr_write_b32 a58, 0
  v_accvgpr_write_b32 a59, 0
  v_accvgpr_write_b32 a60, 0
  v_accvgpr_write_b32 a61, 0
  v_accvgpr_write_b32 a62, 0
  v_accvgpr_write_b32 a63, 0
  v_accvgpr_write_b32 a64, 0
  v_accvgpr_write_b32 a65, 0
  v_accvgpr_write_b32 a66, 0
  v_accvgpr_write_b32 a67, 0
  v_accvgpr_write_b32 a68, 0
  v_accvgpr_write_b32 a69, 0
  v_accvgpr_write_b32 a70, 0
  v_accvgpr_write_b32 a71, 0
  v_accvgpr_write_b32 a72, 0
  v_accvgpr_write_b32 a73, 0
  v_accvgpr_write_b32 a74, 0
  v_accvgpr_write_b32 a75, 0
  v_accvgpr_write_b32 a76, 0
  v_accvgpr_write_b32 a77, 0
  v_accvgpr_write_b32 a78, 0
  v_accvgpr_write_b32 a79, 0
  v_accvgpr_write_b32 a80, 0
  v_accvgpr_write_b32 a81, 0
  v_accvgpr_write_b32 a82, 0
  v_accvgpr_write_b32 a83, 0
  v_accvgpr_write_b32 a84, 0
  v_accvgpr_write_b32 a85, 0
  v_accvgpr_write_b32 a86, 0
  v_accvgpr_write_b32 a87, 0
  v_accvgpr_write_b32 a88, 0
  v_accvgpr_write_b32 a89, 0
  v_accvgpr_write_b32 a90, 0
  v_accvgpr_write_b32 a91, 0
  v_accvgpr_write_b32 a92, 0
  v_accvgpr_write_b32 a93, 0
  v_accvgpr_write_b32 a94, 0
  v_accvgpr_write_b32 a95, 0
  v_accvgpr_write_b32 a96, 0
  v_accvgpr_write_b32 a97, 0
  v_accvgpr_write_b32 a98, 0
  v_accvgpr_write_b32 a99, 0
  v_accvgpr_write_b32 a100, 0
  v_accvgpr_write_b32 a101, 0
  v_accvgpr_write_b32 a102, 0
  v_accvgpr_write_b32 a103, 0
  v_accvgpr_write_b32 a104, 0
  v_accvgpr_write_b32 a105, 0
  v_accvgpr_write_b32 a106, 0
  v_accvgpr_write_b32 a107, 0
  v_accvgpr_write_b32 a108, 0
  v_accvgpr_write_b32 a109, 0
  v_accvgpr_write_b32 a110, 0
  v_accvgpr_write_b32 a111, 0
  v_accvgpr_write_b32 a112, 0
  v_accvgpr_write_b32 a113, 0
  v_accvgpr_write_b32 a114, 0
  v_accvgpr_write_b32 a115, 0
  v_accvgpr_write_b32 a116, 0
  v_accvgpr_write_b32 a117, 0
  v_accvgpr_write_b32 a118, 0
  v_accvgpr_write_b32 a119, 0
  v_accvgpr_write_b32 a120, 0
  v_accvgpr_write_b32 a121, 0
  v_accvgpr_write_b32 a122, 0
  v_accvgpr_write_b32 a123, 0
  v_accvgpr_write_b32 a124, 0
  v_accvgpr_write_b32 a125, 0
  v_accvgpr_write_b32 a126, 0
  v_accvgpr_write_b32 a127, 0
  v_accvgpr_write_b32 a128, 0
  v_accvgpr_write_b32 a129, 0
  v_accvgpr_write_b32 a130, 0
  v_accvgpr_write_b32 a131, 0
  v_accvgpr_write_b32 a132, 0
  v_accvgpr_write_b32 a133, 0
  v_accvgpr_write_b32 a134, 0
  v_accvgpr_write_b32 a135, 0
  v_accvgpr_write_b32 a136, 0
  v_accvgpr_write_b32 a137, 0
  v_accvgpr_write_b32 a138, 0
  v_accvgpr_write_b32 a139, 0
  v_accvgpr_write_b32 a140, 0
  v_accvgpr_write_b32 a141, 0
  v_accvgpr_write_b32 a142, 0
  v_accvgpr_write_b32 a143, 0
  v_accvgpr_write_b32 a144, 0
  v_accvgpr_write_b32 a145, 0
  v_accvgpr_write_b32 a146, 0
  v_accvgpr_write_b32 a147, 0
  v_accvgpr_write_b32 a148, 0
  v_accvgpr_write_b32 a149, 0
  v_accvgpr_write_b32 a150, 0
  v_accvgpr_write_b32 a151, 0
  v_accvgpr_write_b32 a152, 0
  v_accvgpr_write_b32 a153, 0
  v_accvgpr_write_b32 a154, 0
  v_accvgpr_write_b32 a155, 0
  v_accvgpr_write_b32 a156, 0
  v_accvgpr_write_b32 a157, 0
  v_accvgpr_write_b32 a158, 0
  v_accvgpr_write_b32 a159, 0
  v_accvgpr_write_b32 a160, 0
  v_accvgpr_write_b32 a161, 0
  v_accvgpr_write_b32 a162, 0
  v_accvgpr_write_b32 a163, 0
  v_accvgpr_write_b32 a164, 0
  v_accvgpr_write_b32 a165, 0
  v_accvgpr_write_b32 a166, 0
  v_accvgpr_write_b32 a167, 0
  v_accvgpr_write_b32 a168, 0
  v_accvgpr_write_b32 a169, 0
  v_accvgpr_write_b32 a170, 0
  v_accvgpr_write_b32 a171, 0
  v_accvgpr_write_b32 a172, 0
  v_accvgpr_write_b32 a173, 0
  v_accvgpr_write_b32 a174, 0
  v_accvgpr_write_b32 a175, 0
  v_accvgpr_write_b32 a176, 0
  v_accvgpr_write_b32 a177, 0
  v_accvgpr_write_b32 a178, 0
  v_accvgpr_write_b32 a179, 0
  v_accvgpr_write_b32 a180, 0
  v_accvgpr_write_b32 a181, 0
  v_accvgpr_write_b32 a182, 0
  v_accvgpr_write_b32 a183, 0
  v_accvgpr_write_b32 a184, 0
  v_accvgpr_write_b32 a185, 0
  v_accvgpr_write_b32 a186, 0
  v_accvgpr_write_b32 a187, 0
  v_accvgpr_write_b32 a188, 0
  v_accvgpr_write_b32 a189, 0
  v_accvgpr_write_b32 a190, 0
  v_accvgpr_write_b32 a191, 0
  v_accvgpr_write_b32 a192, 0
  v_accvgpr_write_b32 a193, 0
  v_accvgpr_write_b32 a194, 0
  v_accvgpr_write_b32 a195, 0
  v_accvgpr_write_b32 a196, 0
  v_accvgpr_write_b32 a197, 0
  v_accvgpr_write_b32 a198, 0
  v_accvgpr_write_b32 a199, 0
  v_accvgpr_write_b32 a200, 0
  v_accvgpr_write_b32 a201, 0
  v_accvgpr_write_b32 a202, 0
  v_accvgpr_write_b32 a203, 0
  v_accvgpr_write_b32 a204, 0
  v_accvgpr_write_b32 a205, 0
  v_accvgpr_write_b32 a206, 0
  v_accvgpr_write_b32 a207, 0
  v_accvgpr_write_b32 a208, 0
  v_accvgpr_write_b32 a209, 0
  v_accvgpr_write_b32 a210, 0
  v_accvgpr_write_b32 a211, 0
  v_accvgpr_write_b32 a212, 0
  v_accvgpr_write_b32 a213, 0
  v_accvgpr_write_b32 a214, 0
  v_accvgpr_write_b32 a215, 0
  v_accvgpr_write_b32 a216, 0
  v_accvgpr_write_b32 a217, 0
  v_accvgpr_write_b32 a218, 0
  v_accvgpr_write_b32 a219, 0
  v_accvgpr_write_b32 a220, 0
  v_accvgpr_write_b32 a221, 0
  v_accvgpr_write_b32 a222, 0
  v_accvgpr_write_b32 a223, 0
  v_accvgpr_write_b32 a224, 0
  v_accvgpr_write_b32 a225, 0
  v_accvgpr_write_b32 a226, 0
  v_accvgpr_write_b32 a227, 0
  v_accvgpr_write_b32 a228, 0
  v_accvgpr_write_b32 a229, 0
  v_accvgpr_write_b32 a230, 0
  v_accvgpr_write_b32 a231, 0
  v_accvgpr_write_b32 a232, 0
  v_accvgpr_write_b32 a233, 0
  v_accvgpr_write_b32 a234, 0
  v_accvgpr_write_b32 a235, 0
  v_accvgpr_write_b32 a236, 0
  v_accvgpr_write_b32 a237, 0
  v_accvgpr_write_b32 a238, 0
  v_accvgpr_write_b32 a239, 0
  v_accvgpr_write_b32 a240, 0
  v_accvgpr_write_b32 a241, 0
  v_accvgpr_write_b32 a242, 0
  v_accvgpr_write_b32 a243, 0
  v_accvgpr_write_b32 a244, 0
  v_accvgpr_write_b32 a245, 0
  v_accvgpr_write_b32 a246, 0
  v_accvgpr_write_b32 a247, 0
  v_accvgpr_write_b32 a248, 0
  v_accvgpr_write_b32 a249, 0
  v_accvgpr_write_b32 a250, 0
  v_accvgpr_write_b32 a251, 0
  v_accvgpr_write_b32 a252, 0
  v_accvgpr_write_b32 a253, 0
  v_accvgpr_write_b32 a254, 0
  v_accvgpr_write_b32 a255, 0
  s_waitcnt vmcnt(12)
  s_barrier
  ds_read_b64_tr_b16 v[208:209], v5 offset:0
  ds_read_b64_tr_b16 v[210:211], v5 offset:512
  ds_read_b64_tr_b16 v[212:213], v6 offset:0
  ds_read_b64_tr_b16 v[214:215], v6 offset:512
  ds_read_b64_tr_b16 v[216:217], v7 offset:0
  ds_read_b64_tr_b16 v[218:219], v7 offset:512
  ds_read_b64_tr_b16 v[220:221], v5 offset:1024
  ds_read_b64_tr_b16 v[222:223], v5 offset:1536
  ds_read_b64_tr_b16 v[224:225], v6 offset:1024
  ds_read_b64_tr_b16 v[226:227], v6 offset:1536
  ds_read_b64_tr_b16 v[228:229], v7 offset:1024
  ds_read_b64_tr_b16 v[230:231], v7 offset:1536
  s_waitcnt vmcnt(11) lgkmcnt(10)
  v_mfma_f32_32x32x16_bf16 v[160:175], v[208:211], v[16:19], 0
  ds_read_b64_tr_b16 v[208:209], v5 offset:2048
  ds_read_b64_tr_b16 v[210:211], v5 offset:2560
  buffer_load_dwordx4 v[64:67], v12, s[4:7], s43 offen offset:0
  s_waitcnt lgkmcnt(10)
  v_mfma_f32_32x32x16_bf16 v[176:191], v[212:215], v[16:19], 0
  ds_read_b64_tr_b16 v[212:213], v6 offset:2048
  ds_read_b64_tr_b16 v[214:215], v6 offset:2560
  s_waitcnt lgkmcnt(10)
  v_mfma_f32_32x32x16_bf16 v[192:207], v[216:219], v[16:19], 0
  ds_read_b64_tr_b16 v[216:217], v7 offset:2048
  ds_read_b64_tr_b16 v[218:219], v7 offset:2560
  s_waitcnt vmcnt(11) lgkmcnt(10)
  v_mfma_f32_32x32x16_bf16 v[160:175], v[220:223], v[20:23], v[160:175]
  ds_read_b64_tr_b16 v[220:221], v5 offset:3072
  ds_read_b64_tr_b16 v[222:223], v5 offset:3584
  buffer_load_dwordx4 v[68:71], v12, s[4:7], s43 offen offset:1024
  s_waitcnt lgkmcnt(10)
  v_mfma_f32_32x32x16_bf16 v[176:191], v[224:227], v[20:23], v[176:191]
  ds_read_b64_tr_b16 v[224:225], v6 offset:3072
  ds_read_b64_tr_b16 v[226:227], v6 offset:3584
  s_waitcnt lgkmcnt(10)
  v_mfma_f32_32x32x16_bf16 v[192:207], v[228:231], v[20:23], v[192:207]
  ds_read_b64_tr_b16 v[228:229], v7 offset:3072
  ds_read_b64_tr_b16 v[230:231], v7 offset:3584
  s_waitcnt vmcnt(11) lgkmcnt(10)
  v_mfma_f32_32x32x16_bf16 v[160:175], v[208:211], v[24:27], v[160:175]
  ds_read_b64_tr_b16 v[208:209], v5 offset:4096
  ds_read_b64_tr_b16 v[210:211], v5 offset:4608
  buffer_load_dwordx4 v[72:75], v12, s[4:7], s43 offen offset:2048
  s_waitcnt lgkmcnt(10)
  v_mfma_f32_32x32x16_bf16 v[176:191], v[212:215], v[24:27], v[176:191]
  ds_read_b64_tr_b16 v[212:213], v6 offset:4096
  ds_read_b64_tr_b16 v[214:215], v6 offset:4608
  s_waitcnt lgkmcnt(10)
  v_mfma_f32_32x32x16_bf16 v[192:207], v[216:219], v[24:27], v[192:207]
  ds_read_b64_tr_b16 v[216:217], v7 offset:4096
  ds_read_b64_tr_b16 v[218:219], v7 offset:4608
  s_waitcnt vmcnt(11) lgkmcnt(10)
  v_mfma_f32_32x32x16_bf16 v[160:175], v[220:223], v[28:31], v[160:175]
  ds_read_b64_tr_b16 v[220:221], v5 offset:5120
  ds_read_b64_tr_b16 v[222:223], v5 offset:5632
  buffer_load_dwordx4 v[76:79], v12, s[4:7], s43 offen offset:3072
  s_waitcnt lgkmcnt(10)
  v_mfma_f32_32x32x16_bf16 v[176:191], v[224:227], v[28:31], v[176:191]
  ds_read_b64_tr_b16 v[224:225], v6 offset:5120
  ds_read_b64_tr_b16 v[226:227], v6 offset:5632
  s_waitcnt lgkmcnt(10)
  v_mfma_f32_32x32x16_bf16 v[192:207], v[228:231], v[28:31], v[192:207]
  ds_read_b64_tr_b16 v[228:229], v7 offset:5120
  ds_read_b64_tr_b16 v[230:231], v7 offset:5632
  s_waitcnt vmcnt(11) lgkmcnt(10)
  v_mfma_f32_32x32x16_bf16 v[160:175], v[208:211], v[32:35], v[160:175]
  ds_read_b64_tr_b16 v[208:209], v5 offset:6144
  ds_read_b64_tr_b16 v[210:211], v5 offset:6656
  buffer_load_dwordx4 v[80:83], v12, s[4:7], s44 offen offset:0
  s_waitcnt lgkmcnt(10)
  v_mfma_f32_32x32x16_bf16 v[176:191], v[212:215], v[32:35], v[176:191]
  ds_read_b64_tr_b16 v[212:213], v6 offset:6144
  ds_read_b64_tr_b16 v[214:215], v6 offset:6656
  s_waitcnt lgkmcnt(10)
  v_mfma_f32_32x32x16_bf16 v[192:207], v[216:219], v[32:35], v[192:207]
  ds_read_b64_tr_b16 v[216:217], v7 offset:6144
  ds_read_b64_tr_b16 v[218:219], v7 offset:6656
  s_waitcnt vmcnt(11) lgkmcnt(10)
  v_mfma_f32_32x32x16_bf16 v[160:175], v[220:223], v[36:39], v[160:175]
  ds_read_b64_tr_b16 v[220:221], v5 offset:7168
  ds_read_b64_tr_b16 v[222:223], v5 offset:7680
  buffer_load_dwordx4 v[84:87], v12, s[4:7], s44 offen offset:1024
  s_waitcnt lgkmcnt(10)
  v_mfma_f32_32x32x16_bf16 v[176:191], v[224:227], v[36:39], v[176:191]
  ds_read_b64_tr_b16 v[224:225], v6 offset:7168
  ds_read_b64_tr_b16 v[226:227], v6 offset:7680
  s_waitcnt lgkmcnt(10)
  v_mfma_f32_32x32x16_bf16 v[192:207], v[228:231], v[36:39], v[192:207]
  ds_read_b64_tr_b16 v[228:229], v7 offset:7168
  ds_read_b64_tr_b16 v[230:231], v7 offset:7680
  s_waitcnt vmcnt(11) lgkmcnt(10)
  v_mfma_f32_32x32x16_bf16 v[160:175], v[208:211], v[40:43], v[160:175]
  ds_read_b64_tr_b16 v[208:209], v5 offset:8192
  ds_read_b64_tr_b16 v[210:211], v5 offset:8704
  buffer_load_dwordx4 v[88:91], v13, s[4:7], s44 offen offset:2048
  s_waitcnt lgkmcnt(10)
  v_mfma_f32_32x32x16_bf16 v[176:191], v[212:215], v[40:43], v[176:191]
  ds_read_b64_tr_b16 v[212:213], v6 offset:8192
  ds_read_b64_tr_b16 v[214:215], v6 offset:8704
  s_waitcnt lgkmcnt(10)
  v_mfma_f32_32x32x16_bf16 v[192:207], v[216:219], v[40:43], v[192:207]
  ds_read_b64_tr_b16 v[216:217], v7 offset:8192
  ds_read_b64_tr_b16 v[218:219], v7 offset:8704
  s_waitcnt vmcnt(11) lgkmcnt(10)
  v_mfma_f32_32x32x16_bf16 v[160:175], v[220:223], v[44:47], v[160:175]
  ds_read_b64_tr_b16 v[220:221], v5 offset:9216
  ds_read_b64_tr_b16 v[222:223], v5 offset:9728
  buffer_load_dwordx4 v[92:95], v13, s[4:7], s44 offen offset:3072
  s_waitcnt lgkmcnt(10)
  v_mfma_f32_32x32x16_bf16 v[176:191], v[224:227], v[44:47], v[176:191]
  ds_read_b64_tr_b16 v[224:225], v6 offset:9216
  ds_read_b64_tr_b16 v[226:227], v6 offset:9728
  s_waitcnt lgkmcnt(10)
  v_mfma_f32_32x32x16_bf16 v[192:207], v[228:231], v[44:47], v[192:207]
  ds_read_b64_tr_b16 v[228:229], v7 offset:9216
  ds_read_b64_tr_b16 v[230:231], v7 offset:9728
  s_waitcnt vmcnt(11) lgkmcnt(10)
  v_mfma_f32_32x32x16_bf16 v[160:175], v[208:211], v[48:51], v[160:175]
  ds_read_b64_tr_b16 v[208:209], v5 offset:10240
  ds_read_b64_tr_b16 v[210:211], v5 offset:10752
  buffer_load_dwordx4 v[96:99], v13, s[4:7], s45 offen offset:0
  s_waitcnt lgkmcnt(10)
  v_mfma_f32_32x32x16_bf16 v[176:191], v[212:215], v[48:51], v[176:191]
  ds_read_b64_tr_b16 v[212:213], v6 offset:10240
  ds_read_b64_tr_b16 v[214:215], v6 offset:10752
  s_waitcnt lgkmcnt(10)
  v_mfma_f32_32x32x16_bf16 v[192:207], v[216:219], v[48:51], v[192:207]
  ds_read_b64_tr_b16 v[216:217], v7 offset:10240
  ds_read_b64_tr_b16 v[218:219], v7 offset:10752
  s_waitcnt vmcnt(11) lgkmcnt(10)
  v_mfma_f32_32x32x16_bf16 v[160:175], v[220:223], v[52:55], v[160:175]
  ds_read_b64_tr_b16 v[220:221], v5 offset:11264
  ds_read_b64_tr_b16 v[222:223], v5 offset:11776
  buffer_load_dwordx4 v[100:103], v13, s[4:7], s45 offen offset:1024
  s_waitcnt lgkmcnt(10)
  v_mfma_f32_32x32x16_bf16 v[176:191], v[224:227], v[52:55], v[176:191]
  ds_read_b64_tr_b16 v[224:225], v6 offset:11264
  ds_read_b64_tr_b16 v[226:227], v6 offset:11776
  s_waitcnt lgkmcnt(10)
  v_mfma_f32_32x32x16_bf16 v[192:207], v[228:231], v[52:55], v[192:207]
  ds_read_b64_tr_b16 v[228:229], v7 offset:11264
  ds_read_b64_tr_b16 v[230:231], v7 offset:11776
  s_waitcnt vmcnt(11) lgkmcnt(10)
  v_mfma_f32_32x32x16_bf16 v[160:175], v[208:211], v[56:59], v[160:175]
  ds_read_b64_tr_b16 v[208:209], v5 offset:12288
  ds_read_b64_tr_b16 v[210:211], v5 offset:12800
  buffer_load_dwordx4 v[104:107], v13, s[4:7], s45 offen offset:2048
  s_waitcnt lgkmcnt(10)
  v_mfma_f32_32x32x16_bf16 v[176:191], v[212:215], v[56:59], v[176:191]
  ds_read_b64_tr_b16 v[212:213], v6 offset:12288
  ds_read_b64_tr_b16 v[214:215], v6 offset:12800
  s_waitcnt lgkmcnt(10)
  v_mfma_f32_32x32x16_bf16 v[192:207], v[216:219], v[56:59], v[192:207]
  ds_read_b64_tr_b16 v[216:217], v7 offset:12288
  ds_read_b64_tr_b16 v[218:219], v7 offset:12800
  s_waitcnt vmcnt(11) lgkmcnt(10)
  v_mfma_f32_32x32x16_bf16 v[160:175], v[220:223], v[60:63], v[160:175]
  ds_read_b64_tr_b16 v[220:221], v5 offset:13312
  ds_read_b64_tr_b16 v[222:223], v5 offset:13824
  buffer_load_dwordx4 v[108:111], v13, s[4:7], s45 offen offset:3072
  s_waitcnt lgkmcnt(10)
  v_mfma_f32_32x32x16_bf16 v[176:191], v[224:227], v[60:63], v[176:191]
  ds_read_b64_tr_b16 v[224:225], v6 offset:13312
  ds_read_b64_tr_b16 v[226:227], v6 offset:13824
  s_waitcnt lgkmcnt(10)
  v_mfma_f32_32x32x16_bf16 v[192:207], v[228:231], v[60:63], v[192:207]
  ds_read_b64_tr_b16 v[228:229], v7 offset:13312
  ds_read_b64_tr_b16 v[230:231], v7 offset:13824
  s_waitcnt vmcnt(11) lgkmcnt(10)
  v_mfma_f32_32x32x16_bf16 v[160:175], v[208:211], v[64:67], v[160:175]
  ds_read_b64_tr_b16 v[208:209], v5 offset:14336
  ds_read_b64_tr_b16 v[210:211], v5 offset:14848
  buffer_load_dwordx4 v[112:115], v13, s[4:7], s46 offen offset:0
  s_waitcnt lgkmcnt(10)
  v_mfma_f32_32x32x16_bf16 v[176:191], v[212:215], v[64:67], v[176:191]
  ds_read_b64_tr_b16 v[212:213], v6 offset:14336
  ds_read_b64_tr_b16 v[214:215], v6 offset:14848
  s_waitcnt lgkmcnt(10)
  v_mfma_f32_32x32x16_bf16 v[192:207], v[216:219], v[64:67], v[192:207]
  ds_read_b64_tr_b16 v[216:217], v7 offset:14336
  ds_read_b64_tr_b16 v[218:219], v7 offset:14848
  s_waitcnt vmcnt(11) lgkmcnt(10)
  v_mfma_f32_32x32x16_bf16 v[160:175], v[220:223], v[68:71], v[160:175]
  ds_read_b64_tr_b16 v[220:221], v5 offset:15360
  ds_read_b64_tr_b16 v[222:223], v5 offset:15872
  buffer_load_dwordx4 v[116:119], v13, s[4:7], s46 offen offset:1024
  s_waitcnt lgkmcnt(10)
  v_mfma_f32_32x32x16_bf16 v[176:191], v[224:227], v[68:71], v[176:191]
  ds_read_b64_tr_b16 v[224:225], v6 offset:15360
  ds_read_b64_tr_b16 v[226:227], v6 offset:15872
  s_waitcnt lgkmcnt(10)
  v_mfma_f32_32x32x16_bf16 v[192:207], v[228:231], v[68:71], v[192:207]
  ds_read_b64_tr_b16 v[228:229], v7 offset:15360
  ds_read_b64_tr_b16 v[230:231], v7 offset:15872
  s_waitcnt vmcnt(11) lgkmcnt(10)
  v_mfma_f32_32x32x16_bf16 v[160:175], v[208:211], v[72:75], v[160:175]
  ds_read_b64_tr_b16 v[208:209], v5 offset:16384
  ds_read_b64_tr_b16 v[210:211], v5 offset:16896
  buffer_load_dwordx4 v[120:123], v13, s[4:7], s46 offen offset:2048
  s_waitcnt lgkmcnt(10)
  v_mfma_f32_32x32x16_bf16 v[176:191], v[212:215], v[72:75], v[176:191]
  ds_read_b64_tr_b16 v[212:213], v6 offset:16384
  ds_read_b64_tr_b16 v[214:215], v6 offset:16896
  s_waitcnt lgkmcnt(10)
  v_mfma_f32_32x32x16_bf16 v[192:207], v[216:219], v[72:75], v[192:207]
  ds_read_b64_tr_b16 v[216:217], v7 offset:16384
  ds_read_b64_tr_b16 v[218:219], v7 offset:16896
  s_waitcnt vmcnt(11) lgkmcnt(10)
  v_mfma_f32_32x32x16_bf16 v[160:175], v[220:223], v[76:79], v[160:175]
  ds_read_b64_tr_b16 v[220:221], v5 offset:17408
  ds_read_b64_tr_b16 v[222:223], v5 offset:17920
  buffer_load_dwordx4 v[124:127], v14, s[4:7], s46 offen offset:3072
  s_waitcnt lgkmcnt(10)
  v_mfma_f32_32x32x16_bf16 v[176:191], v[224:227], v[76:79], v[176:191]
  ds_read_b64_tr_b16 v[224:225], v6 offset:17408
  ds_read_b64_tr_b16 v[226:227], v6 offset:17920
  s_waitcnt lgkmcnt(10)
  v_mfma_f32_32x32x16_bf16 v[192:207], v[228:231], v[76:79], v[192:207]
  ds_read_b64_tr_b16 v[228:229], v7 offset:17408
  ds_read_b64_tr_b16 v[230:231], v7 offset:17920
  s_waitcnt vmcnt(11) lgkmcnt(10)
  v_mfma_f32_32x32x16_bf16 v[160:175], v[208:211], v[80:83], v[160:175]
  ds_read_b64_tr_b16 v[208:209], v5 offset:18432
  ds_read_b64_tr_b16 v[210:211], v5 offset:18944
  buffer_load_dwordx4 v[128:131], v14, s[4:7], s47 offen offset:0
  s_waitcnt lgkmcnt(10)
  v_mfma_f32_32x32x16_bf16 v[176:191], v[212:215], v[80:83], v[176:191]
  ds_read_b64_tr_b16 v[212:213], v6 offset:18432
  ds_read_b64_tr_b16 v[214:215], v6 offset:18944
  s_waitcnt lgkmcnt(10)
  v_mfma_f32_32x32x16_bf16 v[192:207], v[216:219], v[80:83], v[192:207]
  ds_read_b64_tr_b16 v[216:217], v7 offset:18432
  ds_read_b64_tr_b16 v[218:219], v7 offset:18944
  s_waitcnt vmcnt(11) lgkmcnt(10)
  v_mfma_f32_32x32x16_bf16 v[160:175], v[220:223], v[84:87], v[160:175]
  ds_read_b64_tr_b16 v[220:221], v5 offset:19456
  ds_read_b64_tr_b16 v[222:223], v5 offset:19968
  buffer_load_dwordx4 v[132:135], v14, s[4:7], s47 offen offset:1024
  s_waitcnt lgkmcnt(10)
  v_mfma_f32_32x32x16_bf16 v[176:191], v[224:227], v[84:87], v[176:191]
  ds_read_b64_tr_b16 v[224:225], v6 offset:19456
  ds_read_b64_tr_b16 v[226:227], v6 offset:19968
  s_waitcnt lgkmcnt(10)
  v_mfma_f32_32x32x16_bf16 v[192:207], v[228:231], v[84:87], v[192:207]
  ds_read_b64_tr_b16 v[228:229], v7 offset:19456
  ds_read_b64_tr_b16 v[230:231], v7 offset:19968
  s_waitcnt vmcnt(11) lgkmcnt(10)
  v_mfma_f32_32x32x16_bf16 v[160:175], v[208:211], v[88:91], v[160:175]
  ds_read_b64_tr_b16 v[208:209], v5 offset:20480
  ds_read_b64_tr_b16 v[210:211], v5 offset:20992
  buffer_load_dwordx4 v[136:139], v14, s[4:7], s47 offen offset:2048
  s_waitcnt lgkmcnt(10)
  v_mfma_f32_32x32x16_bf16 v[176:191], v[212:215], v[88:91], v[176:191]
  ds_read_b64_tr_b16 v[212:213], v6 offset:20480
  ds_read_b64_tr_b16 v[214:215], v6 offset:20992
  s_waitcnt lgkmcnt(10)
  v_mfma_f32_32x32x16_bf16 v[192:207], v[216:219], v[88:91], v[192:207]
  ds_read_b64_tr_b16 v[216:217], v7 offset:20480
  ds_read_b64_tr_b16 v[218:219], v7 offset:20992
  s_waitcnt vmcnt(11) lgkmcnt(10)
  v_mfma_f32_32x32x16_bf16 v[160:175], v[220:223], v[92:95], v[160:175]
  ds_read_b64_tr_b16 v[220:221], v5 offset:21504
  ds_read_b64_tr_b16 v[222:223], v5 offset:22016
  buffer_load_dwordx4 v[140:143], v14, s[4:7], s47 offen offset:3072
  s_waitcnt lgkmcnt(10)
  v_mfma_f32_32x32x16_bf16 v[176:191], v[224:227], v[92:95], v[176:191]
  ds_read_b64_tr_b16 v[224:225], v6 offset:21504
  ds_read_b64_tr_b16 v[226:227], v6 offset:22016
  s_waitcnt lgkmcnt(10)
  v_mfma_f32_32x32x16_bf16 v[192:207], v[228:231], v[92:95], v[192:207]
  ds_read_b64_tr_b16 v[228:229], v7 offset:21504
  ds_read_b64_tr_b16 v[230:231], v7 offset:22016
  s_waitcnt vmcnt(11) lgkmcnt(10)
  v_mfma_f32_32x32x16_bf16 v[160:175], v[208:211], v[96:99], v[160:175]
  ds_read_b64_tr_b16 v[208:209], v5 offset:22528
  ds_read_b64_tr_b16 v[210:211], v5 offset:23040
  buffer_load_dwordx4 v[144:147], v14, s[4:7], s48 offen offset:0
  s_waitcnt lgkmcnt(10)
  v_mfma_f32_32x32x16_bf16 v[176:191], v[212:215], v[96:99], v[176:191]
  ds_read_b64_tr_b16 v[212:213], v6 offset:22528
  ds_read_b64_tr_b16 v[214:215], v6 offset:23040
  s_waitcnt lgkmcnt(10)
  v_mfma_f32_32x32x16_bf16 v[192:207], v[216:219], v[96:99], v[192:207]
  ds_read_b64_tr_b16 v[216:217], v7 offset:22528
  ds_read_b64_tr_b16 v[218:219], v7 offset:23040
  s_waitcnt vmcnt(11) lgkmcnt(10)
  v_mfma_f32_32x32x16_bf16 v[160:175], v[220:223], v[100:103], v[160:175]
  ds_read_b64_tr_b16 v[220:221], v5 offset:23552
  ds_read_b64_tr_b16 v[222:223], v5 offset:24064
  buffer_load_dwordx4 v[148:151], v14, s[4:7], s48 offen offset:1024
  s_waitcnt lgkmcnt(10)
  v_mfma_f32_32x32x16_bf16 v[176:191], v[224:227], v[100:103], v[176:191]
  ds_read_b64_tr_b16 v[224:225], v6 offset:23552
  ds_read_b64_tr_b16 v[226:227], v6 offset:24064
  s_waitcnt lgkmcnt(10)
  v_mfma_f32_32x32x16_bf16 v[192:207], v[228:231], v[100:103], v[192:207]
  ds_read_b64_tr_b16 v[228:229], v7 offset:23552
  ds_read_b64_tr_b16 v[230:231], v7 offset:24064
  s_waitcnt vmcnt(11) lgkmcnt(10)
  v_mfma_f32_32x32x16_bf16 v[160:175], v[208:211], v[104:107], v[160:175]
  ds_read_b64_tr_b16 v[208:209], v5 offset:24576
  ds_read_b64_tr_b16 v[210:211], v5 offset:25088
  buffer_load_dwordx4 v[152:155], v14, s[4:7], s48 offen offset:2048
  s_waitcnt lgkmcnt(10)
  v_mfma_f32_32x32x16_bf16 v[176:191], v[212:215], v[104:107], v[176:191]
  ds_read_b64_tr_b16 v[212:213], v6 offset:24576
  ds_read_b64_tr_b16 v[214:215], v6 offset:25088
  s_waitcnt lgkmcnt(10)
  v_mfma_f32_32x32x16_bf16 v[192:207], v[216:219], v[104:107], v[192:207]
  ds_read_b64_tr_b16 v[216:217], v7 offset:24576
  ds_read_b64_tr_b16 v[218:219], v7 offset:25088
  s_waitcnt vmcnt(11) lgkmcnt(10)
  v_mfma_f32_32x32x16_bf16 v[160:175], v[220:223], v[108:111], v[160:175]
  ds_read_b64_tr_b16 v[220:221], v5 offset:25600
  ds_read_b64_tr_b16 v[222:223], v5 offset:26112
  buffer_load_dwordx4 v[156:159], v14, s[4:7], s48 offen offset:3072
  s_waitcnt lgkmcnt(10)
  v_mfma_f32_32x32x16_bf16 v[176:191], v[224:227], v[108:111], v[176:191]
  ds_read_b64_tr_b16 v[224:225], v6 offset:25600
  ds_read_b64_tr_b16 v[226:227], v6 offset:26112
  s_waitcnt lgkmcnt(10)
  v_mfma_f32_32x32x16_bf16 v[192:207], v[228:231], v[108:111], v[192:207]
  ds_read_b64_tr_b16 v[228:229], v7 offset:25600
  ds_read_b64_tr_b16 v[230:231], v7 offset:26112
  s_waitcnt vmcnt(11) lgkmcnt(10)
  v_mfma_f32_32x32x16_bf16 v[160:175], v[208:211], v[112:115], v[160:175]
  ds_read_b64_tr_b16 v[208:209], v5 offset:26624
  ds_read_b64_tr_b16 v[210:211], v5 offset:27136
  s_waitcnt lgkmcnt(10)
  v_mfma_f32_32x32x16_bf16 v[176:191], v[212:215], v[112:115], v[176:191]
  ds_read_b64_tr_b16 v[212:213], v6 offset:26624
  ds_read_b64_tr_b16 v[214:215], v6 offset:27136
  s_add_u32 m0, s49, 0
  s_nop 0
  buffer_load_dwordx4 v10, s[16:19], s26 offen offset:0 lds
  s_waitcnt lgkmcnt(10)
  v_mfma_f32_32x32x16_bf16 v[192:207], v[216:219], v[112:115], v[192:207]
  ds_read_b64_tr_b16 v[216:217], v7 offset:26624
  ds_read_b64_tr_b16 v[218:219], v7 offset:27136
  s_waitcnt vmcnt(11) lgkmcnt(10)
  v_mfma_f32_32x32x16_bf16 v[160:175], v[220:223], v[116:119], v[160:175]
  ds_read_b64_tr_b16 v[220:221], v5 offset:27648
  ds_read_b64_tr_b16 v[222:223], v5 offset:28160
  s_add_u32 m0, s49, 1024
  s_nop 0
  buffer_load_dwordx4 v10, s[16:19], s27 offen offset:0 lds
  s_waitcnt lgkmcnt(10)
  v_mfma_f32_32x32x16_bf16 v[176:191], v[224:227], v[116:119], v[176:191]
  ds_read_b64_tr_b16 v[224:225], v6 offset:27648
  ds_read_b64_tr_b16 v[226:227], v6 offset:28160
  s_waitcnt lgkmcnt(10)
  v_mfma_f32_32x32x16_bf16 v[192:207], v[228:231], v[116:119], v[192:207]
  ds_read_b64_tr_b16 v[228:229], v7 offset:27648
  ds_read_b64_tr_b16 v[230:231], v7 offset:28160
  s_add_u32 m0, s49, 1984
  s_nop 0
  buffer_load_dwordx4 v10, s[16:19], s26 offen offset:64 lds
  s_waitcnt vmcnt(12) lgkmcnt(10)
  v_mfma_f32_32x32x16_bf16 v[160:175], v[208:211], v[120:123], v[160:175]
  ds_read_b64_tr_b16 v[208:209], v5 offset:28672
  ds_read_b64_tr_b16 v[210:211], v5 offset:29184
  s_waitcnt lgkmcnt(10)
  v_mfma_f32_32x32x16_bf16 v[176:191], v[212:215], v[120:123], v[176:191]
  ds_read_b64_tr_b16 v[212:213], v6 offset:28672
  ds_read_b64_tr_b16 v[214:215], v6 offset:29184
  s_add_u32 m0, s49, 3008
  s_nop 0
  buffer_load_dwordx4 v10, s[16:19], s27 offen offset:64 lds
  s_waitcnt lgkmcnt(10)
  v_mfma_f32_32x32x16_bf16 v[192:207], v[216:219], v[120:123], v[192:207]
  ds_read_b64_tr_b16 v[216:217], v7 offset:28672
  ds_read_b64_tr_b16 v[218:219], v7 offset:29184
  s_waitcnt vmcnt(12) lgkmcnt(10)
  v_mfma_f32_32x32x16_bf16 v[160:175], v[220:223], v[124:127], v[160:175]
  ds_read_b64_tr_b16 v[220:221], v5 offset:29696
  ds_read_b64_tr_b16 v[222:223], v5 offset:30208
  s_add_u32 m0, s49, 3968
  s_nop 0
  buffer_load_dwordx4 v10, s[16:19], s26 offen offset:128 lds
  s_waitcnt lgkmcnt(10)
  v_mfma_f32_32x32x16_bf16 v[176:191], v[224:227], v[124:127], v[176:191]
  ds_read_b64_tr_b16 v[224:225], v6 offset:29696
  ds_read_b64_tr_b16 v[226:227], v6 offset:30208
  s_waitcnt lgkmcnt(10)
  v_mfma_f32_32x32x16_bf16 v[192:207], v[228:231], v[124:127], v[192:207]
  ds_read_b64_tr_b16 v[228:229], v7 offset:29696
  ds_read_b64_tr_b16 v[230:231], v7 offset:30208
  s_add_u32 m0, s49, 4992
  s_nop 0
  buffer_load_dwordx4 v10, s[16:19], s27 offen offset:128 lds
  s_waitcnt vmcnt(13) lgkmcnt(10)
  v_mfma_f32_32x32x16_bf16 v[160:175], v[208:211], v[128:131], v[160:175]
  ds_read_b64_tr_b16 v[208:209], v5 offset:30720
  ds_read_b64_tr_b16 v[210:211], v5 offset:31232
  s_waitcnt lgkmcnt(10)
  v_mfma_f32_32x32x16_bf16 v[176:191], v[212:215], v[128:131], v[176:191]
  ds_read_b64_tr_b16 v[212:213], v6 offset:30720
  ds_read_b64_tr_b16 v[214:215], v6 offset:31232
  s_waitcnt lgkmcnt(10)
  v_mfma_f32_32x32x16_bf16 v[192:207], v[216:219], v[128:131], v[192:207]
  ds_read_b64_tr_b16 v[216:217], v7 offset:30720
  ds_read_b64_tr_b16 v[218:219], v7 offset:31232
  s_waitcnt vmcnt(12) lgkmcnt(10)
  v_mfma_f32_32x32x16_bf16 v[160:175], v[220:223], v[132:135], v[160:175]
  ds_read_b64_tr_b16 v[220:221], v5 offset:31744
  ds_read_b64_tr_b16 v[222:223], v5 offset:32256
  s_waitcnt lgkmcnt(10)
  v_mfma_f32_32x32x16_bf16 v[176:191], v[224:227], v[132:135], v[176:191]
  ds_read_b64_tr_b16 v[224:225], v6 offset:31744
  ds_read_b64_tr_b16 v[226:227], v6 offset:32256
  s_waitcnt lgkmcnt(10)
  v_mfma_f32_32x32x16_bf16 v[192:207], v[228:231], v[132:135], v[192:207]
  ds_read_b64_tr_b16 v[228:229], v7 offset:31744
  ds_read_b64_tr_b16 v[230:231], v7 offset:32256
  s_waitcnt vmcnt(11) lgkmcnt(10)
  v_mfma_f32_32x32x16_bf16 v[160:175], v[208:211], v[136:139], v[160:175]
  ds_read_b64_tr_b16 v[208:209], v5 offset:32768
  ds_read_b64_tr_b16 v[210:211], v5 offset:33280
  s_waitcnt lgkmcnt(10)
  v_mfma_f32_32x32x16_bf16 v[176:191], v[212:215], v[136:139], v[176:191]
  ds_read_b64_tr_b16 v[212:213], v6 offset:32768
  ds_read_b64_tr_b16 v[214:215], v6 offset:33280
  s_waitcnt lgkmcnt(10)
  v_mfma_f32_32x32x16_bf16 v[192:207], v[216:219], v[136:139], v[192:207]
  ds_read_b64_tr_b16 v[216:217], v7 offset:32768
  ds_read_b64_tr_b16 v[218:219], v7 offset:33280
  s_waitcnt vmcnt(10) lgkmcnt(10)
  v_mfma_f32_32x32x16_bf16 v[160:175], v[220:223], v[140:143], v[160:175]
  ds_read_b64_tr_b16 v[220:221], v5 offset:33792
  ds_read_b64_tr_b16 v[222:223], v5 offset:34304
  s_waitcnt lgkmcnt(10)
  v_mfma_f32_32x32x16_bf16 v[176:191], v[224:227], v[140:143], v[176:191]
  ds_read_b64_tr_b16 v[224:225], v6 offset:33792
  ds_read_b64_tr_b16 v[226:227], v6 offset:34304
  s_waitcnt lgkmcnt(10)
  v_mfma_f32_32x32x16_bf16 v[192:207], v[228:231], v[140:143], v[192:207]
  ds_read_b64_tr_b16 v[228:229], v7 offset:33792
  ds_read_b64_tr_b16 v[230:231], v7 offset:34304
  s_waitcnt vmcnt(9) lgkmcnt(10)
  v_mfma_f32_32x32x16_bf16 v[160:175], v[208:211], v[144:147], v[160:175]
  ds_read_b64_tr_b16 v[208:209], v5 offset:34816
  ds_read_b64_tr_b16 v[210:211], v5 offset:35328
  s_waitcnt lgkmcnt(10)
  v_mfma_f32_32x32x16_bf16 v[176:191], v[212:215], v[144:147], v[176:191]
  ds_read_b64_tr_b16 v[212:213], v6 offset:34816
  ds_read_b64_tr_b16 v[214:215], v6 offset:35328
  s_waitcnt lgkmcnt(10)
  v_mfma_f32_32x32x16_bf16 v[192:207], v[216:219], v[144:147], v[192:207]
  ds_read_b64_tr_b16 v[216:217], v7 offset:34816
  ds_read_b64_tr_b16 v[218:219], v7 offset:35328
  s_waitcnt vmcnt(8) lgkmcnt(10)
  v_mfma_f32_32x32x16_bf16 v[160:175], v[220:223], v[148:151], v[160:175]
  ds_read_b64_tr_b16 v[220:221], v5 offset:35840
  ds_read_b64_tr_b16 v[222:223], v5 offset:36352
  s_waitcnt lgkmcnt(10)
  v_mfma_f32_32x32x16_bf16 v[176:191], v[224:227], v[148:151], v[176:191]
  ds_read_b64_tr_b16 v[224:225], v6 offset:35840
  ds_read_b64_tr_b16 v[226:227], v6 offset:36352
  s_waitcnt lgkmcnt(10)
  v_mfma_f32_32x32x16_bf16 v[192:207], v[228:231], v[148:151], v[192:207]
  ds_read_b64_tr_b16 v[228:229], v7 offset:35840
  ds_read_b64_tr_b16 v[230:231], v7 offset:36352
  s_waitcnt vmcnt(7) lgkmcnt(10)
  v_mfma_f32_32x32x16_bf16 v[160:175], v[208:211], v[152:155], v[160:175]
  s_waitcnt lgkmcnt(8)
  v_mfma_f32_32x32x16_bf16 v[176:191], v[212:215], v[152:155], v[176:191]
  s_waitcnt lgkmcnt(6)
  v_mfma_f32_32x32x16_bf16 v[192:207], v[216:219], v[152:155], v[192:207]
  s_waitcnt vmcnt(6) lgkmcnt(4)
  v_mfma_f32_32x32x16_bf16 v[160:175], v[220:223], v[156:159], v[160:175]
  s_waitcnt lgkmcnt(2)
  v_mfma_f32_32x32x16_bf16 v[176:191], v[224:227], v[156:159], v[176:191]
  s_waitcnt lgkmcnt(0)
  v_mfma_f32_32x32x16_bf16 v[192:207], v[228:231], v[156:159], v[192:207]
  s_waitcnt vmcnt(0)
  ds_read_b64 v[224:225], v15 offset:0
  ds_read_b64 v[226:227], v15 offset:16
  ds_read_b64 v[228:229], v15 offset:32
  ds_read_b64 v[230:231], v15 offset:48
  s_waitcnt lgkmcnt(3)
  v_lshlrev_b32 v2, 16, v224
  v_and_b32 v3, 0xffff0000, v224
  v_add_f32 v160, v160, v2
  v_add_f32 v161, v161, v3
  v_lshlrev_b32 v2, 16, v225
  v_and_b32 v3, 0xffff0000, v225
  v_add_f32 v162, v162, v2
  v_add_f32 v163, v163, v3
  s_waitcnt lgkmcnt(2)
  v_lshlrev_b32 v2, 16, v226
  v_and_b32 v3, 0xffff0000, v226
  v_add_f32 v164, v164, v2
  v_add_f32 v165, v165, v3
  v_lshlrev_b32 v2, 16, v227
  v_and_b32 v3, 0xffff0000, v227
  v_add_f32 v166, v166, v2
  v_add_f32 v167, v167, v3
  s_waitcnt lgkmcnt(1)
  v_lshlrev_b32 v2, 16, v228
  v_and_b32 v3, 0xffff0000, v228
  v_add_f32 v168, v168, v2
  v_add_f32 v169, v169, v3
  v_lshlrev_b32 v2, 16, v229
  v_and_b32 v3, 0xffff0000, v229
  v_add_f32 v170, v170, v2
  v_add_f32 v171, v171, v3
  s_waitcnt lgkmcnt(0)
  v_lshlrev_b32 v2, 16, v230
  v_and_b32 v3, 0xffff0000, v230
  v_add_f32 v172, v172, v2
  v_add_f32 v173, v173, v3
  v_lshlrev_b32 v2, 16, v231
  v_and_b32 v3, 0xffff0000, v231
  v_add_f32 v174, v174, v2
  v_add_f32 v175, v175, v3
  v_mov_b32 v240, v160
  v_mul_f32 v242, v160, v160
  v_mov_b32 v241, v161
  v_mul_f32 v243, v161, v161
  v_add_f32 v240, v240, v162
  v_fma_f32 v242, v162, v162, v242
  v_add_f32 v241, v241, v163
  v_fma_f32 v243, v163, v163, v243
  v_add_f32 v240, v240, v164
  v_fma_f32 v242, v164, v164, v242
  v_add_f32 v241, v241, v165
  v_fma_f32 v243, v165, v165, v243
  v_add_f32 v240, v240, v166
  v_fma_f32 v242, v166, v166, v242
  v_add_f32 v241, v241, v167
  v_fma_f32 v243, v167, v167, v243
  v_add_f32 v240, v240, v168
  v_fma_f32 v242, v168, v168, v242
  v_add_f32 v241, v241, v169
  v_fma_f32 v243, v169, v169, v243
  v_add_f32 v240, v240, v170
  v_fma_f32 v242, v170, v170, v242
  v_add_f32 v241, v241, v171
  v_fma_f32 v243, v171, v171, v243
  v_add_f32 v240, v240, v172
  v_fma_f32 v242, v172, v172, v242
  v_add_f32 v241, v241, v173
  v_fma_f32 v243, v173, v173, v243
  v_add_f32 v240, v240, v174
  v_fma_f32 v242, v174, v174, v242
  v_add_f32 v241, v241, v175
  v_fma_f32 v243, v175, v175, v243
  v_cvt_pk_bf16_f32 v232, v160, v161
  v_cvt_pk_bf16_f32 v233, v162, v163
  v_cvt_pk_bf16_f32 v234, v164, v165
  v_cvt_pk_bf16_f32 v235, v166, v167
  v_cvt_pk_bf16_f32 v236, v168, v169
  v_cvt_pk_bf16_f32 v237, v170, v171
  v_cvt_pk_bf16_f32 v238, v172, v173
  v_cvt_pk_bf16_f32 v239, v174, v175
  buffer_store_dwordx4 v[232:235], v9, s[12:15], s25 offen offset:0 sc1
  buffer_store_dwordx4 v[236:239], v9, s[12:15], s25 offen offset:1024 sc1
  ds_read_b64 v[224:225], v15 offset:2048
  ds_read_b64 v[226:227], v15 offset:2064
  ds_read_b64 v[228:229], v15 offset:2080
  ds_read_b64 v[230:231], v15 offset:2096
  s_waitcnt lgkmcnt(3)
  v_lshlrev_b32 v2, 16, v224
  v_and_b32 v3, 0xffff0000, v224
  v_add_f32 v176, v176, v2
  v_add_f32 v177, v177, v3
  v_lshlrev_b32 v2, 16, v225
  v_and_b32 v3, 0xffff0000, v225
  v_add_f32 v178, v178, v2
  v_add_f32 v179, v179, v3
  s_waitcnt lgkmcnt(2)
  v_lshlrev_b32 v2, 16, v226
  v_and_b32 v3, 0xffff0000, v226
  v_add_f32 v180, v180, v2
  v_add_f32 v181, v181, v3
  v_lshlrev_b32 v2, 16, v227
  v_and_b32 v3, 0xffff0000, v227
  v_add_f32 v182, v182, v2
  v_add_f32 v183, v183, v3
  s_waitcnt lgkmcnt(1)
  v_lshlrev_b32 v2, 16, v228
  v_and_b32 v3, 0xffff0000, v228
  v_add_f32 v184, v184, v2
  v_add_f32 v185, v185, v3
  v_lshlrev_b32 v2, 16, v229
  v_and_b32 v3, 0xffff0000, v229
  v_add_f32 v186, v186, v2
  v_add_f32 v187, v187, v3
  s_waitcnt lgkmcnt(0)
  v_lshlrev_b32 v2, 16, v230
  v_and_b32 v3, 0xffff0000, v230
  v_add_f32 v188, v188, v2
  v_add_f32 v189, v189, v3
  v_lshlrev_b32 v2, 16, v231
  v_and_b32 v3, 0xffff0000, v231
  v_add_f32 v190, v190, v2
  v_add_f32 v191, v191, v3
  v_add_f32 v240, v240, v176
  v_fma_f32 v242, v176, v176, v242
  v_add_f32 v241, v241, v177
  v_fma_f32 v243, v177, v177, v243
  v_add_f32 v240, v240, v178
  v_fma_f32 v242, v178, v178, v242
  v_add_f32 v241, v241, v179
  v_fma_f32 v243, v179, v179, v243
  v_add_f32 v240, v240, v180
  v_fma_f32 v242, v180, v180, v242
  v_add_f32 v241, v241, v181
  v_fma_f32 v243, v181, v181, v243
  v_add_f32 v240, v240, v182
  v_fma_f32 v242, v182, v182, v242
  v_add_f32 v241, v241, v183
  v_fma_f32 v243, v183, v183, v243
  v_add_f32 v240, v240, v184
  v_fma_f32 v242, v184, v184, v242
  v_add_f32 v241, v241, v185
  v_fma_f32 v243, v185, v185, v243
  v_add_f32 v240, v240, v186
  v_fma_f32 v242, v186, v186, v242
  v_add_f32 v241, v241, v187
  v_fma_f32 v243, v187, v187, v243
  v_add_f32 v240, v240, v188
  v_fma_f32 v242, v188, v188, v242
  v_add_f32 v241, v241, v189
  v_fma_f32 v243, v189, v189, v243
  v_add_f32 v240, v240, v190
  v_fma_f32 v242, v190, v190, v242
  v_add_f32 v241, v241, v191
  v_fma_f32 v243, v191, v191, v243
  v_cvt_pk_bf16_f32 v232, v176, v177
  v_cvt_pk_bf16_f32 v233, v178, v179
  v_cvt_pk_bf16_f32 v234, v180, v181
  v_cvt_pk_bf16_f32 v235, v182, v183
  v_cvt_pk_bf16_f32 v236, v184, v185
  v_cvt_pk_bf16_f32 v237, v186, v187
  v_cvt_pk_bf16_f32 v238, v188, v189
  v_cvt_pk_bf16_f32 v239, v190, v191
  buffer_store_dwordx4 v[232:235], v9, s[12:15], s25 offen offset:2048 sc1
  buffer_store_dwordx4 v[236:239], v9, s[12:15], s25 offen offset:3072 sc1
  ds_read_b64 v[224:225], v15 offset:4096
  ds_read_b64 v[226:227], v15 offset:4112
  ds_read_b64 v[228:229], v15 offset:4128
  ds_read_b64 v[230:231], v15 offset:4144
  s_waitcnt lgkmcnt(3)
  v_lshlrev_b32 v2, 16, v224
  v_and_b32 v3, 0xffff0000, v224
  v_add_f32 v192, v192, v2
  v_add_f32 v193, v193, v3
  v_lshlrev_b32 v2, 16, v225
  v_and_b32 v3, 0xffff0000, v225
  v_add_f32 v194, v194, v2
  v_add_f32 v195, v195, v3
  s_waitcnt lgkmcnt(2)
  v_lshlrev_b32 v2, 16, v226
  v_and_b32 v3, 0xffff0000, v226
  v_add_f32 v196, v196, v2
  v_add_f32 v197, v197, v3
  v_lshlrev_b32 v2, 16, v227
  v_and_b32 v3, 0xffff0000, v227
  v_add_f32 v198, v198, v2
  v_add_f32 v199, v199, v3
  s_waitcnt lgkmcnt(1)
  v_lshlrev_b32 v2, 16, v228
  v_and_b32 v3, 0xffff0000, v228
  v_add_f32 v200, v200, v2
  v_add_f32 v201, v201, v3
  v_lshlrev_b32 v2, 16, v229
  v_and_b32 v3, 0xffff0000, v229
  v_add_f32 v202, v202, v2
  v_add_f32 v203, v203, v3
  s_waitcnt lgkmcnt(0)
  v_lshlrev_b32 v2, 16, v230
  v_and_b32 v3, 0xffff0000, v230
  v_add_f32 v204, v204, v2
  v_add_f32 v205, v205, v3
  v_lshlrev_b32 v2, 16, v231
  v_and_b32 v3, 0xffff0000, v231
  v_add_f32 v206, v206, v2
  v_add_f32 v207, v207, v3
  v_add_f32 v240, v240, v192
  v_fma_f32 v242, v192, v192, v242
  v_add_f32 v241, v241, v193
  v_fma_f32 v243, v193, v193, v243
  v_add_f32 v240, v240, v194
  v_fma_f32 v242, v194, v194, v242
  v_add_f32 v241, v241, v195
  v_fma_f32 v243, v195, v195, v243
  v_add_f32 v240, v240, v196
  v_fma_f32 v242, v196, v196, v242
  v_add_f32 v241, v241, v197
  v_fma_f32 v243, v197, v197, v243
  v_add_f32 v240, v240, v198
  v_fma_f32 v242, v198, v198, v242
  v_add_f32 v241, v241, v199
  v_fma_f32 v243, v199, v199, v243
  v_add_f32 v240, v240, v200
  v_fma_f32 v242, v200, v200, v242
  v_add_f32 v241, v241, v201
  v_fma_f32 v243, v201, v201, v243
  v_add_f32 v240, v240, v202
  v_fma_f32 v242, v202, v202, v242
  v_add_f32 v241, v241, v203
  v_fma_f32 v243, v203, v203, v243
  v_add_f32 v240, v240, v204
  v_fma_f32 v242, v204, v204, v242
  v_add_f32 v241, v241, v205
  v_fma_f32 v243, v205, v205, v243
  v_add_f32 v240, v240, v206
  v_fma_f32 v242, v206, v206, v242
  v_add_f32 v241, v241, v207
  v_fma_f32 v243, v207, v207, v243
  v_cvt_pk_bf16_f32 v232, v192, v193
  v_cvt_pk_bf16_f32 v233, v194, v195
  v_cvt_pk_bf16_f32 v234, v196, v197
  v_cvt_pk_bf16_f32 v235, v198, v199
  v_cvt_pk_bf16_f32 v236, v200, v201
  v_cvt_pk_bf16_f32 v237, v202, v203
  v_cvt_pk_bf16_f32 v238, v204, v205
  v_cvt_pk_bf16_f32 v239, v206, v207
  s_add_u32 s23, s25, 4096
  buffer_store_dwordx4 v[232:235], v9, s[12:15], s23 offen offset:0 sc1
  buffer_store_dwordx4 v[236:239], v9, s[12:15], s23 offen offset:1024 sc1
  v_add_f32 v240, v240, v241
  v_add_f32 v241, v242, v243
  v_mov_b32 v242, v240
  v_mov_b32 v243, v241
  s_nop 0
  v_permlane32_swap_b32 v240, v242
  v_permlane32_swap_b32 v241, v243
  v_add_f32 v240, v240, v242
  v_add_f32 v241, v241, v243
  v_and_b32 v2, 31, v1
  s_lshl_b32 s23, s22, 5
  v_add_u32 v2, s23, v2
  v_lshlrev_b32 v2, 3, v2
  s_lshl_b32 s23, s37, 14
  buffer_store_dwordx2 v[240:241], v2, s[56:59], s23 offen sc1
  s_add_u32 s27, s22, 64
  s_lshl_b32 s27, s27, 7
  v_mov_b32 v2, s27
  v_mov_b32 v3, 0x40000000
  v_cmp_eq_u32 vcc, 0, v1
  s_nop 1
  v_cndmask_b32 v2, v3, v2, vcc
  v_mov_b32 v3, 1
  s_waitcnt vmcnt(0)
  buffer_atomic_add v3, v2, s[72:75], 0 offen offset:0 sc1
  s_barrier
  s_branch L_k3_mlp
L_k3_pf:
  v_accvgpr_write_b32 a0, 0
  v_accvgpr_write_b32 a1, 0
  v_accvgpr_write_b32 a2, 0
  v_accvgpr_write_b32 a3, 0
  v_accvgpr_write_b32 a4, 0
  v_accvgpr_write_b32 a5, 0
  v_accvgpr_write_b32 a6, 0
  v_accvgpr_write_b32 a7, 0
  v_accvgpr_write_b32 a8, 0
  v_accvgpr_write_b32 a9, 0
  v_accvgpr_write_b32 a10, 0
  v_accvgpr_write_b32 a11, 0
  v_accvgpr_write_b32 a12, 0
  v_accvgpr_write_b32 a13, 0
  v_accvgpr_write_b32 a14, 0
  v_accvgpr_write_b32 a15, 0
  v_accvgpr_write_b32 a16, 0
  v_accvgpr_write_b32 a17, 0
  v_accvgpr_write_b32 a18, 0
  v_accvgpr_write_b32 a19, 0
  v_accvgpr_write_b32 a20, 0
  v_accvgpr_write_b32 a21, 0
  v_accvgpr_write_b32 a22, 0
  v_accvgpr_write_b32 a23, 0
  v_accvgpr_write_b32 a24, 0
  v_accvgpr_write_b32 a25, 0
  v_accvgpr_write_b32 a26, 0
  v_accvgpr_write_b32 a27, 0
  v_accvgpr_write_b32 a28, 0
  v_accvgpr_write_b32 a29, 0
  v_accvgpr_write_b32 a30, 0
  v_accvgpr_write_b32 a31, 0
  v_accvgpr_write_b32 a32, 0
  v_accvgpr_write_b32 a33, 0
  v_accvgpr_write_b32 a34, 0
  v_accvgpr_write_b32 a35, 0
  v_accvgpr_write_b32 a36, 0
  v_accvgpr_write_b32 a37, 0
  v_accvgpr_write_b32 a38, 0
  v_accvgpr_write_b32 a39, 0
  v_accvgpr_write_b32 a40, 0
  v_accvgpr_write_b32 a41, 0
  v_accvgpr_write_b32 a42, 0
  v_accvgpr_write_b32 a43, 0
  v_accvgpr_write_b32 a44, 0
  v_accvgpr_write_b32 a45, 0
  v_accvgpr_write_b32 a46, 0
  v_accvgpr_write_b32 a47, 0
  v_accvgpr_write_b32 a48, 0
  v_accvgpr_write_b32 a49, 0
  v_accvgpr_write_b32 a50, 0
  v_accvgpr_write_b32 a51, 0
  v_accvgpr_write_b32 a52, 0
  v_accvgpr_write_b32 a53, 0
  v_accvgpr_write_b32 a54, 0
  v_accvgpr_write_b32 a55, 0
  v_accvgpr_write_b32 a56, 0
  v_accvgpr_write_b32 a57, 0
  v_accvgpr_write_b32 a58, 0
  v_accvgpr_write_b32 a59, 0
  v_accvgpr_write_b32 a60, 0
  v_accvgpr_write_b32 a61, 0
  v_accvgpr_write_b32 a62, 0
  v_accvgpr_write_b32 a63, 0
  v_accvgpr_write_b32 a64, 0
  v_accvgpr_write_b32 a65, 0
  v_accvgpr_write_b32 a66, 0
  v_accvgpr_write_b32 a67, 0
  v_accvgpr_write_b32 a68, 0
  v_accvgpr_write_b32 a69, 0
  v_accvgpr_write_b32 a70, 0
  v_accvgpr_write_b32 a71, 0
  v_accvgpr_write_b32 a72, 0
  v_accvgpr_write_b32 a73, 0
  v_accvgpr_write_b32 a74, 0
  v_accvgpr_write_b32 a75, 0
  v_accvgpr_write_b32 a76, 0
  v_accvgpr_write_b32 a77, 0
  v_accvgpr_write_b32 a78, 0
  v_accvgpr_write_b32 a79, 0
  v_accvgpr_write_b32 a80, 0
  v_accvgpr_write_b32 a81, 0
  v_accvgpr_write_b32 a82, 0
  v_accvgpr_write_b32 a83, 0
  v_accvgpr_write_b32 a84, 0
  v_accvgpr_write_b32 a85, 0
  v_accvgpr_write_b32 a86, 0
  v_accvgpr_write_b32 a87, 0
  v_accvgpr_write_b32 a88, 0
  v_accvgpr_write_b32 a89, 0
  v_accvgpr_write_b32 a90, 0
  v_accvgpr_write_b32 a91, 0
  v_accvgpr_write_b32 a92, 0
  v_accvgpr_write_b32 a93, 0
  v_accvgpr_write_b32 a94, 0
  v_accvgpr_write_b32 a95, 0
  v_accvgpr_write_b32 a96, 0
  v_accvgpr_write_b32 a97, 0
  v_accvgpr_write_b32 a98, 0
  v_accvgpr_write_b32 a99, 0
  v_accvgpr_write_b32 a100, 0
  v_accvgpr_write_b32 a101, 0
  v_accvgpr_write_b32 a102, 0
  v_accvgpr_write_b32 a103, 0
  v_accvgpr_write_b32 a104, 0
  v_accvgpr_write_b32 a105, 0
  v_accvgpr_write_b32 a106, 0
  v_accvgpr_write_b32 a107, 0
  v_accvgpr_write_b32 a108, 0
  v_accvgpr_write_b32 a109, 0
  v_accvgpr_write_b32 a110, 0
  v_accvgpr_write_b32 a111, 0
  v_accvgpr_write_b32 a112, 0
  v_accvgpr_write_b32 a113, 0
  v_accvgpr_write_b32 a114, 0
  v_accvgpr_write_b32 a115, 0
  v_accvgpr_write_b32 a116, 0
  v_accvgpr_write_b32 a117, 0
  v_accvgpr_write_b32 a118, 0
  v_accvgpr_write_b32 a119, 0
  v_accvgpr_write_b32 a120, 0
  v_accvgpr_write_b32 a121, 0
  v_accvgpr_write_b32 a122, 0
  v_accvgpr_write_b32 a123, 0
  v_accvgpr_write_b32 a124, 0
  v_accvgpr_write_b32 a125, 0
  v_accvgpr_write_b32 a126, 0
  v_accvgpr_write_b32 a127, 0
  v_accvgpr_write_b32 a128, 0
  v_accvgpr_write_b32 a129, 0
  v_accvgpr_write_b32 a130, 0
  v_accvgpr_write_b32 a131, 0
  v_accvgpr_write_b32 a132, 0
  v_accvgpr_write_b32 a133, 0
  v_accvgpr_write_b32 a134, 0
  v_accvgpr_write_b32 a135, 0
  v_accvgpr_write_b32 a136, 0
  v_accvgpr_write_b32 a137, 0
  v_accvgpr_write_b32 a138, 0
  v_accvgpr_write_b32 a139, 0
  v_accvgpr_write_b32 a140, 0
  v_accvgpr_write_b32 a141, 0
  v_accvgpr_write_b32 a142, 0
  v_accvgpr_write_b32 a143, 0
  v_accvgpr_write_b32 a144, 0
  v_accvgpr_write_b32 a145, 0
  v_accvgpr_write_b32 a146, 0
  v_accvgpr_write_b32 a147, 0
  v_accvgpr_write_b32 a148, 0
  v_accvgpr_write_b32 a149, 0
  v_accvgpr_write_b32 a150, 0
  v_accvgpr_write_b32 a151, 0
  v_accvgpr_write_b32 a152, 0
  v_accvgpr_write_b32 a153, 0
  v_accvgpr_write_b32 a154, 0
  v_accvgpr_write_b32 a155, 0
  v_accvgpr_write_b32 a156, 0
  v_accvgpr_write_b32 a157, 0
  v_accvgpr_write_b32 a158, 0
  v_accvgpr_write_b32 a159, 0
  v_accvgpr_write_b32 a160, 0
  v_accvgpr_write_b32 a161, 0
  v_accvgpr_write_b32 a162, 0
  v_accvgpr_write_b32 a163, 0
  v_accvgpr_write_b32 a164, 0
  v_accvgpr_write_b32 a165, 0
  v_accvgpr_write_b32 a166, 0
  v_accvgpr_write_b32 a167, 0
  v_accvgpr_write_b32 a168, 0
  v_accvgpr_write_b32 a169, 0
  v_accvgpr_write_b32 a170, 0
  v_accvgpr_write_b32 a171, 0
  v_accvgpr_write_b32 a172, 0
  v_accvgpr_write_b32 a173, 0
  v_accvgpr_write_b32 a174, 0
  v_accvgpr_write_b32 a175, 0
  v_accvgpr_write_b32 a176, 0
  v_accvgpr_write_b32 a177, 0
  v_accvgpr_write_b32 a178, 0
  v_accvgpr_write_b32 a179, 0
  v_accvgpr_write_b32 a180, 0
  v_accvgpr_write_b32 a181, 0
  v_accvgpr_write_b32 a182, 0
  v_accvgpr_write_b32 a183, 0
  v_accvgpr_write_b32 a184, 0
  v_accvgpr_write_b32 a185, 0
  v_accvgpr_write_b32 a186, 0
  v_accvgpr_write_b32 a187, 0
  v_accvgpr_write_b32 a188, 0
  v_accvgpr_write_b32 a189, 0
  v_accvgpr_write_b32 a190, 0
  v_accvgpr_write_b32 a191, 0
  v_accvgpr_write_b32 a192, 0
  v_accvgpr_write_b32 a193, 0
  v_accvgpr_write_b32 a194, 0
  v_accvgpr_write_b32 a195, 0
  v_accvgpr_write_b32 a196, 0
  v_accvgpr_write_b32 a197, 0
  v_accvgpr_write_b32 a198, 0
  v_accvgpr_write_b32 a199, 0
  v_accvgpr_write_b32 a200, 0
  v_accvgpr_write_b32 a201, 0
  v_accvgpr_write_b32 a202, 0
  v_accvgpr_write_b32 a203, 0
  v_accvgpr_write_b32 a204, 0
  v_accvgpr_write_b32 a205, 0
  v_accvgpr_write_b32 a206, 0
  v_accvgpr_write_b32 a207, 0
  v_accvgpr_write_b32 a208, 0
  v_accvgpr_write_b32 a209, 0
  v_accvgpr_write_b32 a210, 0
  v_accvgpr_write_b32 a211, 0
  v_accvgpr_write_b32 a212, 0
  v_accvgpr_write_b32 a213, 0
  v_accvgpr_write_b32 a214, 0
  v_accvgpr_write_b32 a215, 0
  v_accvgpr_write_b32 a216, 0
  v_accvgpr_write_b32 a217, 0
  v_accvgpr_write_b32 a218, 0
  v_accvgpr_write_b32 a219, 0
  v_accvgpr_write_b32 a220, 0
  v_accvgpr_write_b32 a221, 0
  v_accvgpr_write_b32 a222, 0
  v_accvgpr_write_b32 a223, 0
  v_accvgpr_write_b32 a224, 0
  v_accvgpr_write_b32 a225, 0
  v_accvgpr_write_b32 a226, 0
  v_accvgpr_write_b32 a227, 0
  v_accvgpr_write_b32 a228, 0
  v_accvgpr_write_b32 a229, 0
  v_accvgpr_write_b32 a230, 0
  v_accvgpr_write_b32 a231, 0
  v_accvgpr_write_b32 a232, 0
  v_accvgpr_write_b32 a233, 0
  v_accvgpr_write_b32 a234, 0
  v_accvgpr_write_b32 a235, 0
  v_accvgpr_write_b32 a236, 0
  v_accvgpr_write_b32 a237, 0
  v_accvgpr_write_b32 a238, 0
  v_accvgpr_write_b32 a239, 0
  v_accvgpr_write_b32 a240, 0
  v_accvgpr_write_b32 a241, 0
  v_accvgpr_write_b32 a242, 0
  v_accvgpr_write_b32 a243, 0
  v_accvgpr_write_b32 a244, 0
  v_accvgpr_write_b32 a245, 0
  v_accvgpr_write_b32 a246, 0
  v_accvgpr_write_b32 a247, 0
  v_accvgpr_write_b32 a248, 0
  v_accvgpr_write_b32 a249, 0
  v_accvgpr_write_b32 a250, 0
  v_accvgpr_write_b32 a251, 0
  v_accvgpr_write_b32 a252, 0
  v_accvgpr_write_b32 a253, 0
  v_accvgpr_write_b32 a254, 0
  v_accvgpr_write_b32 a255, 0
L_k3_mlp:
  s_mov_b64 s[60:61], s[100:101]
  s_mov_b64 s[62:63], s[92:93]
  s_mov_b64 s[64:65], s[94:95]
  s_and_b32 s21, s38, 1
  s_lshl_b32 s21, s21, 2
  s_lshr_b32 s23, s39, 2
  s_add_u32 s21, s21, s23
  s_lshr_b32 s20, s38, 1
  s_lshl_b32 s20, s20, 2
  s_and_b32 s23, s39, 3
  s_add_u32 s20, s20, s23
  s_lshl_b32 s22, s20, 2
  s_add_u32 s22, s22, s3
  v_lshrrev_b32 v10, 2, v1
  s_mov_b32 s23, 9216
  v_mul_lo_u32 v5, v10, s23
  v_and_b32 v10, 3, v1
  v_lshlrev_b32 v10, 4, v10
  v_add_u32 v5, v5, v10
  s_mul_i32 s23, s21, 1152
  v_add_u32 v5, s23, v5
  s_mul_i32 s23, s3, 1327104
  s_add_u32 s40, s23, 0
  s_add_u32 s41, s23, 147456
  s_add_u32 s42, s23, 294912
  s_add_u32 s43, s23, 442368
  s_add_u32 s44, s23, 589824
  s_add_u32 s45, s23, 737280
  s_add_u32 s46, s23, 884736
  s_add_u32 s47, s23, 1032192
  s_add_u32 s48, s23, 1179648
  v_lshrrev_b32 v10, 2, v1
  s_mov_b32 s23, 1152
  v_mul_lo_u32 v6, v10, s23
  v_and_b32 v10, 3, v1
  v_lshlrev_b32 v10, 4, v10
  v_add_u32 v6, v6, v10
  s_mul_i32 s23, s21, 663552
  v_add_u32 v6, s23, v6
  s_lshr_b32 s23, s3, 1
  s_mul_i32 s28, s23, 18432
  s_and_b32 s23, s3, 1
  s_mul_i32 s23, s23, 576
  s_add_u32 s28, s28, s23
  s_mov_b32 s50, 0
  s_mov_b32 s51, 4096
  s_mov_b32 s52, 8192
  s_mov_b32 s53, 12288
  s_mov_b32 s54, 16384
  s_mov_b32 s55, 20480
  s_mov_b32 s56, 24576
  s_mov_b32 s57, 28672
  s_mov_b32 s58, 32768
  v_lshlrev_b32 v9, 4, v1
  s_waitcnt lgkmcnt(0)
  s_add_u32 s4, s60, 9437184
  s_addc_u32 s5, s61, 0
  s_mov_b32 s6, 2359296
  s_mov_b32 s7, 0x20000
  s_mov_b32 s8, s62
  s_mov_b32 s9, s63
  s_mov_b32 s10, 5308416
  s_mov_b32 s11, 0x20000
  s_mov_b32 s12, s64
  s_mov_b32 s13, s65
  s_mov_b32 s14, 5308416
  s_mov_b32 s15, 0x20000
  s_add_u32 s16, s60, 14680064
  s_addc_u32 s17, s61, 0
  s_mov_b32 s18, 18874368
  s_mov_b32 s19, 0x20000
  s_mov_b32 s29, 5308416
  s_add_u32 s68, s60, 14172160
  s_addc_u32 s69, s61, 0
  s_mov_b32 s70, 98304
  s_mov_b32 s71, 0x20000
  s_add_u32 s27, s22, 64
  s_lshl_b32 s27, s27, 7
  v_mov_b32 v192, s27
  buffer_load_dword v192, v192, s[72:75], 0 offen sc1
  s_mul_i32 s23, s3, 9216
  s_add_u32 s26, s23, 0
  s_add_u32 m0, s26, 0
  s_nop 0
  buffer_load_dwordx4 v5, s[8:11], s40 offen lds
  s_add_u32 m0, s26, 1024
  s_nop 0
  buffer_load_dwordx4 v5, s[8:11], s41 offen lds
  s_add_u32 m0, s26, 2048
  s_nop 0
  buffer_load_dwordx4 v5, s[8:11], s42 offen lds
  s_add_u32 m0, s26, 3072
  s_nop 0
  buffer_load_dwordx4 v5, s[8:11], s43 offen lds
  s_add_u32 m0, s26, 4096
  s_nop 0
  buffer_load_dwordx4 v5, s[8:11], s44 offen lds
  s_add_u32 m0, s26, 5120
  s_nop 0
  buffer_load_dwordx4 v5, s[8:11], s45 offen lds
  s_add_u32 m0, s26, 6144
  s_nop 0
  buffer_load_dwordx4 v5, s[8:11], s46 offen lds
  s_add_u32 m0, s26, 7168
  s_nop 0
  buffer_load_dwordx4 v5, s[8:11], s47 offen lds
  s_add_u32 m0, s26, 8192
  s_nop 0
  buffer_load_dwordx4 v5, s[8:11], s48 offen lds
  v_add_u32 v5, 64, v5
  v_bfe_u32 v10, v1, 2, 2
  v_lshrrev_b32 v11, 5, v1
  v_lshlrev_b32 v11, 2, v11
  v_add_u32 v10, v10, v11
  v_lshlrev_b32 v12, 6, v10
  v_bfe_u32 v10, v1, 4, 1
  v_lshlrev_b32 v10, 5, v10
  v_add_u32 v12, v12, v10
  v_and_b32 v10, 3, v1
  v_lshlrev_b32 v10, 3, v10
  v_add_u32 v12, v12, v10
  v_mov_b32 v216, 0
  v_mov_b32 v217, 0
  v_mov_b32 v218, 0
  v_mov_b32 v219, 0
  v_mov_b32 v220, 0
  v_mov_b32 v221, 0
  v_mov_b32 v222, 0
  v_mov_b32 v223, 0
  v_mov_b32 v224, 0
  v_mov_b32 v225, 0
  v_mov_b32 v226, 0
  v_mov_b32 v227, 0
  v_mov_b32 v228, 0
  v_mov_b32 v229, 0
  v_mov_b32 v230, 0
  v_mov_b32 v231, 0
  v_mov_b32 v232, 0
  v_mov_b32 v233, 0
  v_mov_b32 v234, 0
  v_mov_b32 v235, 0
  v_mov_b32 v236, 0
  v_mov_b32 v237, 0
  v_mov_b32 v238, 0
  v_mov_b32 v239, 0
  v_mov_b32 v240, 0
  v_mov_b32 v241, 0
  v_mov_b32 v242, 0
  v_mov_b32 v243, 0
  v_mov_b32 v244, 0
  v_mov_b32 v245, 0
  v_mov_b32 v246, 0
  v_mov_b32 v247, 0
  s_waitcnt vmcnt(9)
  v_readfirstlane_b32 s76, v192
  s_nop 0
  s_cmp_ge_u32 s76, 6
  s_cbranch_scc1 L_x1_ready
  s_add_u32 s27, s22, 64
  s_lshl_b32 s27, s27, 7
  v_mov_b32 v10, s27
  s_mov_b32 s77, 131072
L_wpoll_8:
  buffer_load_dword v11, v10, s[72:75], 0 offen sc1
  s_waitcnt vmcnt(0)
  v_readfirstlane_b32 s76, v11
  s_nop 0
  s_cmp_ge_u32 s76, 6
  s_cbranch_scc1 L_wgot_9
  s_sub_u32 s77, s77, 1
  s_cbranch_scc1 L_wgot_9
  s_sleep 4
  s_branch L_wpoll_8
L_wgot_9:
L_x1_ready:
  v_and_b32 v10, 31, v1
  s_lshl_b32 s23, s22, 5
  v_add_u32 v10, s23, v10
  v_lshlrev_b32 v10, 3, v10
  s_mov_b32 s23, 0
  buffer_load_dwordx2 v[160:161], v10, s[68:71], s23 offen sc1
  s_mov_b32 s23, 16384
  buffer_load_dwordx2 v[162:163], v10, s[68:71], s23 offen sc1
  s_mov_b32 s23, 32768
  buffer_load_dwordx2 v[164:165], v10, s[68:71], s23 offen sc1
  s_mov_b32 s23, 49152
  buffer_load_dwordx2 v[166:167], v10, s[68:71], s23 offen sc1
  s_mov_b32 s23, 65536
  buffer_load_dwordx2 v[168:169], v10, s[68:71], s23 offen sc1
  s_mov_b32 s23, 81920
  buffer_load_dwordx2 v[170:171], v10, s[68:71], s23 offen sc1
  s_mul_i32 s30, s22, 36864
  s_add_u32 s23, s30, s50
  buffer_load_dwordx4 v[16:19], v9, s[4:7], s23 offen offset:0 sc1
  buffer_load_dwordx4 v[20:23], v9, s[4:7], s23 offen offset:1024 sc1
  buffer_load_dwordx4 v[24:27], v9, s[4:7], s23 offen offset:2048 sc1
  buffer_load_dwordx4 v[28:31], v9, s[4:7], s23 offen offset:3072 sc1
  s_add_u32 s23, s30, s51
  buffer_load_dwordx4 v[32:35], v9, s[4:7], s23 offen offset:0 sc1
  buffer_load_dwordx4 v[36:39], v9, s[4:7], s23 offen offset:1024 sc1
  buffer_load_dwordx4 v[40:43], v9, s[4:7], s23 offen offset:2048 sc1
  buffer_load_dwordx4 v[44:47], v9, s[4:7], s23 offen offset:3072 sc1
  s_add_u32 s23, s30, s52
  buffer_load_dwordx4 v[48:51], v9, s[4:7], s23 offen offset:0 sc1
  buffer_load_dwordx4 v[52:55], v9, s[4:7], s23 offen offset:1024 sc1
  buffer_load_dwordx4 v[56:59], v9, s[4:7], s23 offen offset:2048 sc1
  buffer_load_dwordx4 v[60:63], v9, s[4:7], s23 offen offset:3072 sc1
  s_add_u32 s23, s30, s53
  buffer_load_dwordx4 v[64:67], v9, s[4:7], s23 offen offset:0 sc1
  buffer_load_dwordx4 v[68:71], v9, s[4:7], s23 offen offset:1024 sc1
  buffer_load_dwordx4 v[72:75], v9, s[4:7], s23 offen offset:2048 sc1
  buffer_load_dwordx4 v[76:79], v9, s[4:7], s23 offen offset:3072 sc1
  s_add_u32 s23, s30, s54
  buffer_load_dwordx4 v[80:83], v9, s[4:7], s23 offen offset:0 sc1
  buffer_load_dwordx4 v[84:87], v9, s[4:7], s23 offen offset:1024 sc1
  buffer_load_dwordx4 v[88:91], v9, s[4:7], s23 offen offset:2048 sc1
  buffer_load_dwordx4 v[92:95], v9, s[4:7], s23 offen offset:3072 sc1
  s_add_u32 s23, s30, s55
  buffer_load_dwordx4 v[96:99], v9, s[4:7], s23 offen offset:0 sc1
  buffer_load_dwordx4 v[100:103], v9, s[4:7], s23 offen offset:1024 sc1
  buffer_load_dwordx4 v[104:107], v9, s[4:7], s23 offen offset:2048 sc1
  buffer_load_dwordx4 v[108:111], v9, s[4:7], s23 offen offset:3072 sc1
  s_waitcnt vmcnt(28)
  v_add_f32 v160, v160, v162
  v_add_f32 v161, v161, v163
  s_waitcnt vmcnt(27)
  v_add_f32 v160, v160, v164
  v_add_f32 v161, v161, v165
  s_waitcnt vmcnt(26)
  v_add_f32 v160, v160, v166
  v_add_f32 v161, v161, v167
  s_waitcnt vmcnt(25)
  v_add_f32 v160, v160, v168
  v_add_f32 v161, v161, v169
  s_waitcnt vmcnt(24)
  v_add_f32 v160, v160, v170
  v_add_f32 v161, v161, v171
  v_mul_f32 v160, 0x3ae38e39, v160
  v_mul_f32 v161, 0x3ae38e39, v161
  v_fma_f32 v161, -v160, v160, v161
  v_max_f32 v161, 0, v161
  v_add_f32 v161, 0x3727c5ac, v161
  v_rsq_f32 v248, v161
  s_nop 0
  v_mul_f32 v250, v160, v248
  v_sub_f32 v250, 0, v250
  s_waitcnt vmcnt(23)
  v_lshlrev_b32 v192, 16, v16
  v_and_b32 v193, 0xffff0000, v16
  v_lshlrev_b32 v194, 16, v17
  v_and_b32 v195, 0xffff0000, v17
  v_lshlrev_b32 v196, 16, v18
  v_and_b32 v197, 0xffff0000, v18
  v_lshlrev_b32 v198, 16, v19
  v_and_b32 v199, 0xffff0000, v19
  v_pk_fma_f32 v[192:193], v[192:193], v[248:249], v[250:251] op_sel_hi:[1,0,0]
  v_pk_fma_f32 v[194:195], v[194:195], v[248:249], v[250:251] op_sel_hi:[1,0,0]
  v_pk_fma_f32 v[196:197], v[196:197], v[248:249], v[250:251] op_sel_hi:[1,0,0]
  v_pk_fma_f32 v[198:199], v[198:199], v[248:249], v[250:251] op_sel_hi:[1,0,0]
  v_cvt_pk_bf16_f32 v16, v192, v193
  v_cvt_pk_bf16_f32 v17, v194, v195
  v_cvt_pk_bf16_f32 v18, v196, v197
  v_cvt_pk_bf16_f32 v19, v198, v199
  s_waitcnt vmcnt(22)
  v_lshlrev_b32 v192, 16, v20
  v_and_b32 v193, 0xffff0000, v20
  v_lshlrev_b32 v194, 16, v21
  v_and_b32 v195, 0xffff0000, v21
  v_lshlrev_b32 v196, 16, v22
  v_and_b32 v197, 0xffff0000, v22
  v_lshlrev_b32 v198, 16, v23
  v_and_b32 v199, 0xffff0000, v23
  v_pk_fma_f32 v[192:193], v[192:193], v[248:249], v[250:251] op_sel_hi:[1,0,0]
  v_pk_fma_f32 v[194:195], v[194:195], v[248:249], v[250:251] op_sel_hi:[1,0,0]
  v_pk_fma_f32 v[196:197], v[196:197], v[248:249], v[250:251] op_sel_hi:[1,0,0]
  v_pk_fma_f32 v[198:199], v[198:199], v[248:249], v[250:251] op_sel_hi:[1,0,0]
  v_cvt_pk_bf16_f32 v20, v192, v193
  v_cvt_pk_bf16_f32 v21, v194, v195
  v_cvt_pk_bf16_f32 v22, v196, v197
  v_cvt_pk_bf16_f32 v23, v198, v199
  s_waitcnt vmcnt(21)
  v_lshlrev_b32 v192, 16, v24
  v_and_b32 v193, 0xffff0000, v24
  v_lshlrev_b32 v194, 16, v25
  v_and_b32 v195, 0xffff0000, v25
  v_lshlrev_b32 v196, 16, v26
  v_and_b32 v197, 0xffff0000, v26
  v_lshlrev_b32 v198, 16, v27
  v_and_b32 v199, 0xffff0000, v27
  v_pk_fma_f32 v[192:193], v[192:193], v[248:249], v[250:251] op_sel_hi:[1,0,0]
  v_pk_fma_f32 v[194:195], v[194:195], v[248:249], v[250:251] op_sel_hi:[1,0,0]
  v_pk_fma_f32 v[196:197], v[196:197], v[248:249], v[250:251] op_sel_hi:[1,0,0]
  v_pk_fma_f32 v[198:199], v[198:199], v[248:249], v[250:251] op_sel_hi:[1,0,0]
  v_cvt_pk_bf16_f32 v24, v192, v193
  v_cvt_pk_bf16_f32 v25, v194, v195
  v_cvt_pk_bf16_f32 v26, v196, v197
  v_cvt_pk_bf16_f32 v27, v198, v199
  s_waitcnt vmcnt(20)
  v_lshlrev_b32 v192, 16, v28
  v_and_b32 v193, 0xffff0000, v28
  v_lshlrev_b32 v194, 16, v29
  v_and_b32 v195, 0xffff0000, v29
  v_lshlrev_b32 v196, 16, v30
  v_and_b32 v197, 0xffff0000, v30
  v_lshlrev_b32 v198, 16, v31
  v_and_b32 v199, 0xffff0000, v31
  v_pk_fma_f32 v[192:193], v[192:193], v[248:249], v[250:251] op_sel_hi:[1,0,0]
  v_pk_fma_f32 v[194:195], v[194:195], v[248:249], v[250:251] op_sel_hi:[1,0,0]
  v_pk_fma_f32 v[196:197], v[196:197], v[248:249], v[250:251] op_sel_hi:[1,0,0]
  v_pk_fma_f32 v[198:199], v[198:199], v[248:249], v[250:251] op_sel_hi:[1,0,0]
  v_cvt_pk_bf16_f32 v28, v192, v193
  v_cvt_pk_bf16_f32 v29, v194, v195
  v_cvt_pk_bf16_f32 v30, v196, v197
  v_cvt_pk_bf16_f32 v31, v198, v199
  s_waitcnt vmcnt(19)
  v_lshlrev_b32 v192, 16, v32
  v_and_b32 v193, 0xffff0000, v32
  v_lshlrev_b32 v194, 16, v33
  v_and_b32 v195, 0xffff0000, v33
  v_lshlrev_b32 v196, 16, v34
  v_and_b32 v197, 0xffff0000, v34
  v_lshlrev_b32 v198, 16, v35
  v_and_b32 v199, 0xffff0000, v35
  v_pk_fma_f32 v[192:193], v[192:193], v[248:249], v[250:251] op_sel_hi:[1,0,0]
  v_pk_fma_f32 v[194:195], v[194:195], v[248:249], v[250:251] op_sel_hi:[1,0,0]
  v_pk_fma_f32 v[196:197], v[196:197], v[248:249], v[250:251] op_sel_hi:[1,0,0]
  v_pk_fma_f32 v[198:199], v[198:199], v[248:249], v[250:251] op_sel_hi:[1,0,0]
  v_cvt_pk_bf16_f32 v32, v192, v193
  v_cvt_pk_bf16_f32 v33, v194, v195
  v_cvt_pk_bf16_f32 v34, v196, v197
  v_cvt_pk_bf16_f32 v35, v198, v199
  s_waitcnt vmcnt(18)
  v_lshlrev_b32 v192, 16, v36
  v_and_b32 v193, 0xffff0000, v36
  v_lshlrev_b32 v194, 16, v37
  v_and_b32 v195, 0xffff0000, v37
  v_lshlrev_b32 v196, 16, v38
  v_and_b32 v197, 0xffff0000, v38
  v_lshlrev_b32 v198, 16, v39
  v_and_b32 v199, 0xffff0000, v39
  v_pk_fma_f32 v[192:193], v[192:193], v[248:249], v[250:251] op_sel_hi:[1,0,0]
  v_pk_fma_f32 v[194:195], v[194:195], v[248:249], v[250:251] op_sel_hi:[1,0,0]
  v_pk_fma_f32 v[196:197], v[196:197], v[248:249], v[250:251] op_sel_hi:[1,0,0]
  v_pk_fma_f32 v[198:199], v[198:199], v[248:249], v[250:251] op_sel_hi:[1,0,0]
  v_cvt_pk_bf16_f32 v36, v192, v193
  v_cvt_pk_bf16_f32 v37, v194, v195
  v_cvt_pk_bf16_f32 v38, v196, v197
  v_cvt_pk_bf16_f32 v39, v198, v199
  s_waitcnt vmcnt(17)
  v_lshlrev_b32 v192, 16, v40
  v_and_b32 v193, 0xffff0000, v40
  v_lshlrev_b32 v194, 16, v41
  v_and_b32 v195, 0xffff0000, v41
  v_lshlrev_b32 v196, 16, v42
  v_and_b32 v197, 0xffff0000, v42
  v_lshlrev_b32 v198, 16, v43
  v_and_b32 v199, 0xffff0000, v43
  v_pk_fma_f32 v[192:193], v[192:193], v[248:249], v[250:251] op_sel_hi:[1,0,0]
  v_pk_fma_f32 v[194:195], v[194:195], v[248:249], v[250:251] op_sel_hi:[1,0,0]
  v_pk_fma_f32 v[196:197], v[196:197], v[248:249], v[250:251] op_sel_hi:[1,0,0]
  v_pk_fma_f32 v[198:199], v[198:199], v[248:249], v[250:251] op_sel_hi:[1,0,0]
  v_cvt_pk_bf16_f32 v40, v192, v193
  v_cvt_pk_bf16_f32 v41, v194, v195
  v_cvt_pk_bf16_f32 v42, v196, v197
  v_cvt_pk_bf16_f32 v43, v198, v199
  s_waitcnt vmcnt(16)
  v_lshlrev_b32 v192, 16, v44
  v_and_b32 v193, 0xffff0000, v44
  v_lshlrev_b32 v194, 16, v45
  v_and_b32 v195, 0xffff0000, v45
  v_lshlrev_b32 v196, 16, v46
  v_and_b32 v197, 0xffff0000, v46
  v_lshlrev_b32 v198, 16, v47
  v_and_b32 v199, 0xffff0000, v47
  v_pk_fma_f32 v[192:193], v[192:193], v[248:249], v[250:251] op_sel_hi:[1,0,0]
  v_pk_fma_f32 v[194:195], v[194:195], v[248:249], v[250:251] op_sel_hi:[1,0,0]
  v_pk_fma_f32 v[196:197], v[196:197], v[248:249], v[250:251] op_sel_hi:[1,0,0]
  v_pk_fma_f32 v[198:199], v[198:199], v[248:249], v[250:251] op_sel_hi:[1,0,0]
  v_cvt_pk_bf16_f32 v44, v192, v193
  v_cvt_pk_bf16_f32 v45, v194, v195
  v_cvt_pk_bf16_f32 v46, v196, v197
  v_cvt_pk_bf16_f32 v47, v198, v199
  s_waitcnt vmcnt(15)
  v_lshlrev_b32 v192, 16, v48
  v_and_b32 v193, 0xffff0000, v48
  v_lshlrev_b32 v194, 16, v49
  v_and_b32 v195, 0xffff0000, v49
  v_lshlrev_b32 v196, 16, v50
  v_and_b32 v197, 0xffff0000, v50
  v_lshlrev_b32 v198, 16, v51
  v_and_b32 v199, 0xffff0000, v51
  v_pk_fma_f32 v[192:193], v[192:193], v[248:249], v[250:251] op_sel_hi:[1,0,0]
  v_pk_fma_f32 v[194:195], v[194:195], v[248:249], v[250:251] op_sel_hi:[1,0,0]
  v_pk_fma_f32 v[196:197], v[196:197], v[248:249], v[250:251] op_sel_hi:[1,0,0]
  v_pk_fma_f32 v[198:199], v[198:199], v[248:249], v[250:251] op_sel_hi:[1,0,0]
  v_cvt_pk_bf16_f32 v48, v192, v193
  v_cvt_pk_bf16_f32 v49, v194, v195
  v_cvt_pk_bf16_f32 v50, v196, v197
  v_cvt_pk_bf16_f32 v51, v198, v199
  s_waitcnt vmcnt(14)
  v_lshlrev_b32 v192, 16, v52
  v_and_b32 v193, 0xffff0000, v52
  v_lshlrev_b32 v194, 16, v53
  v_and_b32 v195, 0xffff0000, v53
  v_lshlrev_b32 v196, 16, v54
  v_and_b32 v197, 0xffff0000, v54
  v_lshlrev_b32 v198, 16, v55
  v_and_b32 v199, 0xffff0000, v55
  v_pk_fma_f32 v[192:193], v[192:193], v[248:249], v[250:251] op_sel_hi:[1,0,0]
  v_pk_fma_f32 v[194:195], v[194:195], v[248:249], v[250:251] op_sel_hi:[1,0,0]
  v_pk_fma_f32 v[196:197], v[196:197], v[248:249], v[250:251] op_sel_hi:[1,0,0]
  v_pk_fma_f32 v[198:199], v[198:199], v[248:249], v[250:251] op_sel_hi:[1,0,0]
  v_cvt_pk_bf16_f32 v52, v192, v193
  v_cvt_pk_bf16_f32 v53, v194, v195
  v_cvt_pk_bf16_f32 v54, v196, v197
  v_cvt_pk_bf16_f32 v55, v198, v199
  s_waitcnt vmcnt(13)
  v_lshlrev_b32 v192, 16, v56
  v_and_b32 v193, 0xffff0000, v56
  v_lshlrev_b32 v194, 16, v57
  v_and_b32 v195, 0xffff0000, v57
  v_lshlrev_b32 v196, 16, v58
  v_and_b32 v197, 0xffff0000, v58
  v_lshlrev_b32 v198, 16, v59
  v_and_b32 v199, 0xffff0000, v59
  v_pk_fma_f32 v[192:193], v[192:193], v[248:249], v[250:251] op_sel_hi:[1,0,0]
  v_pk_fma_f32 v[194:195], v[194:195], v[248:249], v[250:251] op_sel_hi:[1,0,0]
  v_pk_fma_f32 v[196:197], v[196:197], v[248:249], v[250:251] op_sel_hi:[1,0,0]
  v_pk_fma_f32 v[198:199], v[198:199], v[248:249], v[250:251] op_sel_hi:[1,0,0]
  v_cvt_pk_bf16_f32 v56, v192, v193
  v_cvt_pk_bf16_f32 v57, v194, v195
  v_cvt_pk_bf16_f32 v58, v196, v197
  v_cvt_pk_bf16_f32 v59, v198, v199
  s_waitcnt vmcnt(12)
  v_lshlrev_b32 v192, 16, v60
  v_and_b32 v193, 0xffff0000, v60
  v_lshlrev_b32 v194, 16, v61
  v_and_b32 v195, 0xffff0000, v61
  v_lshlrev_b32 v196, 16, v62
  v_and_b32 v197, 0xffff0000, v62
  v_lshlrev_b32 v198, 16, v63
  v_and_b32 v199, 0xffff0000, v63
  v_pk_fma_f32 v[192:193], v[192:193], v[248:249], v[250:251] op_sel_hi:[1,0,0]
  v_pk_fma_f32 v[194:195], v[194:195], v[248:249], v[250:251] op_sel_hi:[1,0,0]
  v_pk_fma_f32 v[196:197], v[196:197], v[248:249], v[250:251] op_sel_hi:[1,0,0]
  v_pk_fma_f32 v[198:199], v[198:199], v[248:249], v[250:251] op_sel_hi:[1,0,0]
  v_cvt_pk_bf16_f32 v60, v192, v193
  v_cvt_pk_bf16_f32 v61, v194, v195
  v_cvt_pk_bf16_f32 v62, v196, v197
  v_cvt_pk_bf16_f32 v63, v198, v199
  s_add_u32 s23, s30, s56
  buffer_load_dwordx4 v[112:115], v9, s[4:7], s23 offen offset:0 sc1
  buffer_load_dwordx4 v[116:119], v9, s[4:7], s23 offen offset:1024 sc1
  buffer_load_dwordx4 v[120:123], v9, s[4:7], s23 offen offset:2048 sc1
  buffer_load_dwordx4 v[124:127], v9, s[4:7], s23 offen offset:3072 sc1
  s_add_u32 s23, s30, s57
  buffer_load_dwordx4 v[128:131], v9, s[4:7], s23 offen offset:0 sc1
  buffer_load_dwordx4 v[132:135], v9, s[4:7], s23 offen offset:1024 sc1
  buffer_load_dwordx4 v[136:139], v9, s[4:7], s23 offen offset:2048 sc1
  buffer_load_dwordx4 v[140:143], v9, s[4:7], s23 offen offset:3072 sc1
  s_add_u32 s23, s30, s58
  buffer_load_dwordx4 v[144:147], v9, s[4:7], s23 offen offset:0 sc1
  buffer_load_dwordx4 v[148:151], v9, s[4:7], s23 offen offset:1024 sc1
  buffer_load_dwordx4 v[152:155], v9, s[4:7], s23 offen offset:2048 sc1
  buffer_load_dwordx4 v[156:159], v9, s[4:7], s23 offen offset:3072 sc1
  s_waitcnt vmcnt(23)
  v_lshlrev_b32 v192, 16, v64
  v_and_b32 v193, 0xffff0000, v64
  v_lshlrev_b32 v194, 16, v65
  v_and_b32 v195, 0xffff0000, v65
  v_lshlrev_b32 v196, 16, v66
  v_and_b32 v197, 0xffff0000, v66
  v_lshlrev_b32 v198, 16, v67
  v_and_b32 v199, 0xffff0000, v67
  v_pk_fma_f32 v[192:193], v[192:193], v[248:249], v[250:251] op_sel_hi:[1,0,0]
  v_pk_fma_f32 v[194:195], v[194:195], v[248:249], v[250:251] op_sel_hi:[1,0,0]
  v_pk_fma_f32 v[196:197], v[196:197], v[248:249], v[250:251] op_sel_hi:[1,0,0]
  v_pk_fma_f32 v[198:199], v[198:199], v[248:249], v[250:251] op_sel_hi:[1,0,0]
  v_cvt_pk_bf16_f32 v64, v192, v193
  v_cvt_pk_bf16_f32 v65, v194, v195
  v_cvt_pk_bf16_f32 v66, v196, v197
  v_cvt_pk_bf16_f32 v67, v198, v199
  s_waitcnt vmcnt(22)
  v_lshlrev_b32 v192, 16, v68
  v_and_b32 v193, 0xffff0000, v68
  v_lshlrev_b32 v194, 16, v69
  v_and_b32 v195, 0xffff0000, v69
  v_lshlrev_b32 v196, 16, v70
  v_and_b32 v197, 0xffff0000, v70
  v_lshlrev_b32 v198, 16, v71
  v_and_b32 v199, 0xffff0000, v71
  v_pk_fma_f32 v[192:193], v[192:193], v[248:249], v[250:251] op_sel_hi:[1,0,0]
  v_pk_fma_f32 v[194:195], v[194:195], v[248:249], v[250:251] op_sel_hi:[1,0,0]
  v_pk_fma_f32 v[196:197], v[196:197], v[248:249], v[250:251] op_sel_hi:[1,0,0]
  v_pk_fma_f32 v[198:199], v[198:199], v[248:249], v[250:251] op_sel_hi:[1,0,0]
  v_cvt_pk_bf16_f32 v68, v192, v193
  v_cvt_pk_bf16_f32 v69, v194, v195
  v_cvt_pk_bf16_f32 v70, v196, v197
  v_cvt_pk_bf16_f32 v71, v198, v199
  s_waitcnt vmcnt(21)
  v_lshlrev_b32 v192, 16, v72
  v_and_b32 v193, 0xffff0000, v72
  v_lshlrev_b32 v194, 16, v73
  v_and_b32 v195, 0xffff0000, v73
  v_lshlrev_b32 v196, 16, v74
  v_and_b32 v197, 0xffff0000, v74
  v_lshlrev_b32 v198, 16, v75
  v_and_b32 v199, 0xffff0000, v75
  v_pk_fma_f32 v[192:193], v[192:193], v[248:249], v[250:251] op_sel_hi:[1,0,0]
  v_pk_fma_f32 v[194:195], v[194:195], v[248:249], v[250:251] op_sel_hi:[1,0,0]
  v_pk_fma_f32 v[196:197], v[196:197], v[248:249], v[250:251] op_sel_hi:[1,0,0]
  v_pk_fma_f32 v[198:199], v[198:199], v[248:249], v[250:251] op_sel_hi:[1,0,0]
  v_cvt_pk_bf16_f32 v72, v192, v193
  v_cvt_pk_bf16_f32 v73, v194, v195
  v_cvt_pk_bf16_f32 v74, v196, v197
  v_cvt_pk_bf16_f32 v75, v198, v199
  s_waitcnt vmcnt(20)
  v_lshlrev_b32 v192, 16, v76
  v_and_b32 v193, 0xffff0000, v76
  v_lshlrev_b32 v194, 16, v77
  v_and_b32 v195, 0xffff0000, v77
  v_lshlrev_b32 v196, 16, v78
  v_and_b32 v197, 0xffff0000, v78
  v_lshlrev_b32 v198, 16, v79
  v_and_b32 v199, 0xffff0000, v79
  v_pk_fma_f32 v[192:193], v[192:193], v[248:249], v[250:251] op_sel_hi:[1,0,0]
  v_pk_fma_f32 v[194:195], v[194:195], v[248:249], v[250:251] op_sel_hi:[1,0,0]
  v_pk_fma_f32 v[196:197], v[196:197], v[248:249], v[250:251] op_sel_hi:[1,0,0]
  v_pk_fma_f32 v[198:199], v[198:199], v[248:249], v[250:251] op_sel_hi:[1,0,0]
  v_cvt_pk_bf16_f32 v76, v192, v193
  v_cvt_pk_bf16_f32 v77, v194, v195
  v_cvt_pk_bf16_f32 v78, v196, v197
  v_cvt_pk_bf16_f32 v79, v198, v199
  s_waitcnt vmcnt(19)
  v_lshlrev_b32 v192, 16, v80
  v_and_b32 v193, 0xffff0000, v80
  v_lshlrev_b32 v194, 16, v81
  v_and_b32 v195, 0xffff0000, v81
  v_lshlrev_b32 v196, 16, v82
  v_and_b32 v197, 0xffff0000, v82
  v_lshlrev_b32 v198, 16, v83
  v_and_b32 v199, 0xffff0000, v83
  v_pk_fma_f32 v[192:193], v[192:193], v[248:249], v[250:251] op_sel_hi:[1,0,0]
  v_pk_fma_f32 v[194:195], v[194:195], v[248:249], v[250:251] op_sel_hi:[1,0,0]
  v_pk_fma_f32 v[196:197], v[196:197], v[248:249], v[250:251] op_sel_hi:[1,0,0]
  v_pk_fma_f32 v[198:199], v[198:199], v[248:249], v[250:251] op_sel_hi:[1,0,0]
  v_cvt_pk_bf16_f32 v80, v192, v193
  v_cvt_pk_bf16_f32 v81, v194, v195
  v_cvt_pk_bf16_f32 v82, v196, v197
  v_cvt_pk_bf16_f32 v83, v198, v199
  s_waitcnt vmcnt(18)
  v_lshlrev_b32 v192, 16, v84
  v_and_b32 v193, 0xffff0000, v84
  v_lshlrev_b32 v194, 16, v85
  v_and_b32 v195, 0xffff0000, v85
  v_lshlrev_b32 v196, 16, v86
  v_and_b32 v197, 0xffff0000, v86
  v_lshlrev_b32 v198, 16, v87
  v_and_b32 v199, 0xffff0000, v87
  v_pk_fma_f32 v[192:193], v[192:193], v[248:249], v[250:251] op_sel_hi:[1,0,0]
  v_pk_fma_f32 v[194:195], v[194:195], v[248:249], v[250:251] op_sel_hi:[1,0,0]
  v_pk_fma_f32 v[196:197], v[196:197], v[248:249], v[250:251] op_sel_hi:[1,0,0]
  v_pk_fma_f32 v[198:199], v[198:199], v[248:249], v[250:251] op_sel_hi:[1,0,0]
  v_cvt_pk_bf16_f32 v84, v192, v193
  v_cvt_pk_bf16_f32 v85, v194, v195
  v_cvt_pk_bf16_f32 v86, v196, v197
  v_cvt_pk_bf16_f32 v87, v198, v199
  s_waitcnt vmcnt(17)
  v_lshlrev_b32 v192, 16, v88
  v_and_b32 v193, 0xffff0000, v88
  v_lshlrev_b32 v194, 16, v89
  v_and_b32 v195, 0xffff0000, v89
  v_lshlrev_b32 v196, 16, v90
  v_and_b32 v197, 0xffff0000, v90
  v_lshlrev_b32 v198, 16, v91
  v_and_b32 v199, 0xffff0000, v91
  v_pk_fma_f32 v[192:193], v[192:193], v[248:249], v[250:251] op_sel_hi:[1,0,0]
  v_pk_fma_f32 v[194:195], v[194:195], v[248:249], v[250:251] op_sel_hi:[1,0,0]
  v_pk_fma_f32 v[196:197], v[196:197], v[248:249], v[250:251] op_sel_hi:[1,0,0]
  v_pk_fma_f32 v[198:199], v[198:199], v[248:249], v[250:251] op_sel_hi:[1,0,0]
  v_cvt_pk_bf16_f32 v88, v192, v193
  v_cvt_pk_bf16_f32 v89, v194, v195
  v_cvt_pk_bf16_f32 v90, v196, v197
  v_cvt_pk_bf16_f32 v91, v198, v199
  s_waitcnt vmcnt(16)
  v_lshlrev_b32 v192, 16, v92
  v_and_b32 v193, 0xffff0000, v92
  v_lshlrev_b32 v194, 16, v93
  v_and_b32 v195, 0xffff0000, v93
  v_lshlrev_b32 v196, 16, v94
  v_and_b32 v197, 0xffff0000, v94
  v_lshlrev_b32 v198, 16, v95
  v_and_b32 v199, 0xffff0000, v95
  v_pk_fma_f32 v[192:193], v[192:193], v[248:249], v[250:251] op_sel_hi:[1,0,0]
  v_pk_fma_f32 v[194:195], v[194:195], v[248:249], v[250:251] op_sel_hi:[1,0,0]
  v_pk_fma_f32 v[196:197], v[196:197], v[248:249], v[250:251] op_sel_hi:[1,0,0]
  v_pk_fma_f32 v[198:199], v[198:199], v[248:249], v[250:251] op_sel_hi:[1,0,0]
  v_cvt_pk_bf16_f32 v92, v192, v193
  v_cvt_pk_bf16_f32 v93, v194, v195
  v_cvt_pk_bf16_f32 v94, v196, v197
  v_cvt_pk_bf16_f32 v95, v198, v199
  s_waitcnt vmcnt(15)
  v_lshlrev_b32 v192, 16, v96
  v_and_b32 v193, 0xffff0000, v96
  v_lshlrev_b32 v194, 16, v97
  v_and_b32 v195, 0xffff0000, v97
  v_lshlrev_b32 v196, 16, v98
  v_and_b32 v197, 0xffff0000, v98
  v_lshlrev_b32 v198, 16, v99
  v_and_b32 v199, 0xffff0000, v99
  v_pk_fma_f32 v[192:193], v[192:193], v[248:249], v[250:251] op_sel_hi:[1,0,0]
  v_pk_fma_f32 v[194:195], v[194:195], v[248:249], v[250:251] op_sel_hi:[1,0,0]
  v_pk_fma_f32 v[196:197], v[196:197], v[248:249], v[250:251] op_sel_hi:[1,0,0]
  v_pk_fma_f32 v[198:199], v[198:199], v[248:249], v[250:251] op_sel_hi:[1,0,0]
  v_cvt_pk_bf16_f32 v96, v192, v193
  v_cvt_pk_bf16_f32 v97, v194, v195
  v_cvt_pk_bf16_f32 v98, v196, v197
  v_cvt_pk_bf16_f32 v99, v198, v199
  s_waitcnt vmcnt(14)
  v_lshlrev_b32 v192, 16, v100
  v_and_b32 v193, 0xffff0000, v100
  v_lshlrev_b32 v194, 16, v101
  v_and_b32 v195, 0xffff0000, v101
  v_lshlrev_b32 v196, 16, v102
  v_and_b32 v197, 0xffff0000, v102
  v_lshlrev_b32 v198, 16, v103
  v_and_b32 v199, 0xffff0000, v103
  v_pk_fma_f32 v[192:193], v[192:193], v[248:249], v[250:251] op_sel_hi:[1,0,0]
  v_pk_fma_f32 v[194:195], v[194:195], v[248:249], v[250:251] op_sel_hi:[1,0,0]
  v_pk_fma_f32 v[196:197], v[196:197], v[248:249], v[250:251] op_sel_hi:[1,0,0]
  v_pk_fma_f32 v[198:199], v[198:199], v[248:249], v[250:251] op_sel_hi:[1,0,0]
  v_cvt_pk_bf16_f32 v100, v192, v193
  v_cvt_pk_bf16_f32 v101, v194, v195
  v_cvt_pk_bf16_f32 v102, v196, v197
  v_cvt_pk_bf16_f32 v103, v198, v199
  s_waitcnt vmcnt(13)
  v_lshlrev_b32 v192, 16, v104
  v_and_b32 v193, 0xffff0000, v104
  v_lshlrev_b32 v194, 16, v105
  v_and_b32 v195, 0xffff0000, v105
  v_lshlrev_b32 v196, 16, v106
  v_and_b32 v197, 0xffff0000, v106
  v_lshlrev_b32 v198, 16, v107
  v_and_b32 v199, 0xffff0000, v107
  v_pk_fma_f32 v[192:193], v[192:193], v[248:249], v[250:251] op_sel_hi:[1,0,0]
  v_pk_fma_f32 v[194:195], v[194:195], v[248:249], v[250:251] op_sel_hi:[1,0,0]
  v_pk_fma_f32 v[196:197], v[196:197], v[248:249], v[250:251] op_sel_hi:[1,0,0]
  v_pk_fma_f32 v[198:199], v[198:199], v[248:249], v[250:251] op_sel_hi:[1,0,0]
  v_cvt_pk_bf16_f32 v104, v192, v193
  v_cvt_pk_bf16_f32 v105, v194, v195
  v_cvt_pk_bf16_f32 v106, v196, v197
  v_cvt_pk_bf16_f32 v107, v198, v199
  s_waitcnt vmcnt(12)
  v_lshlrev_b32 v192, 16, v108
  v_and_b32 v193, 0xffff0000, v108
  v_lshlrev_b32 v194, 16, v109
  v_and_b32 v195, 0xffff0000, v109
  v_lshlrev_b32 v196, 16, v110
  v_and_b32 v197, 0xffff0000, v110
  v_lshlrev_b32 v198, 16, v111
  v_and_b32 v199, 0xffff0000, v111
  v_pk_fma_f32 v[192:193], v[192:193], v[248:249], v[250:251] op_sel_hi:[1,0,0]
  v_pk_fma_f32 v[194:195], v[194:195], v[248:249], v[250:251] op_sel_hi:[1,0,0]
  v_pk_fma_f32 v[196:197], v[196:197], v[248:249], v[250:251] op_sel_hi:[1,0,0]
  v_pk_fma_f32 v[198:199], v[198:199], v[248:249], v[250:251] op_sel_hi:[1,0,0]
  v_cvt_pk_bf16_f32 v108, v192, v193
  v_cvt_pk_bf16_f32 v109, v194, v195
  v_cvt_pk_bf16_f32 v110, v196, v197
  v_cvt_pk_bf16_f32 v111, v198, v199
  s_mul_i32 s23, s3, 9216
  s_add_u32 s26, s23, 36864
  s_add_u32 s27, s23, 73728
  s_add_u32 m0, s26, 0
  s_nop 0
  buffer_load_dwordx4 v5, s[8:11], s40 offen lds
  s_add_u32 m0, s26, 1024
  s_nop 0
  buffer_load_dwordx4 v5, s[8:11], s41 offen lds
  s_add_u32 m0, s26, 2048
  s_nop 0
  buffer_load_dwordx4 v5, s[8:11], s42 offen lds
  s_add_u32 m0, s26, 3072
  s_nop 0
  buffer_load_dwordx4 v5, s[8:11], s43 offen lds
  s_add_u32 m0, s26, 4096
  s_nop 0
  buffer_load_dwordx4 v5, s[8:11], s44 offen lds
  s_add_u32 m0, s26, 5120
  s_nop 0
  buffer_load_dwordx4 v5, s[8:11], s45 offen lds
  s_add_u32 m0, s26, 6144
  s_nop 0
  buffer_load_dwordx4 v5, s[8:11], s46 offen lds
  s_add_u32 m0, s26, 7168
  s_nop 0
  buffer_load_dwordx4 v5, s[8:11], s47 offen lds
  s_add_u32 m0, s26, 8192
  s_nop 0
  buffer_load_dwordx4 v5, s[8:11], s48 offen lds
  v_add_u32 v5, 64, v5
  s_waitcnt vmcnt(20)
  v_lshlrev_b32 v192, 16, v112
  v_and_b32 v193, 0xffff0000, v112
  v_lshlrev_b32 v194, 16, v113
  v_and_b32 v195, 0xffff0000, v113
  v_lshlrev_b32 v196, 16, v114
  v_and_b32 v197, 0xffff0000, v114
  v_lshlrev_b32 v198, 16, v115
  v_and_b32 v199, 0xffff0000, v115
  v_pk_fma_f32 v[192:193], v[192:193], v[248:249], v[250:251] op_sel_hi:[1,0,0]
  v_pk_fma_f32 v[194:195], v[194:195], v[248:249], v[250:251] op_sel_hi:[1,0,0]
  v_pk_fma_f32 v[196:197], v[196:197], v[248:249], v[250:251] op_sel_hi:[1,0,0]
  v_pk_fma_f32 v[198:199], v[198:199], v[248:249], v[250:251] op_sel_hi:[1,0,0]
  v_cvt_pk_bf16_f32 v112, v192, v193
  v_cvt_pk_bf16_f32 v113, v194, v195
  v_cvt_pk_bf16_f32 v114, v196, v197
  v_cvt_pk_bf16_f32 v115, v198, v199
  s_waitcnt vmcnt(19)
  v_lshlrev_b32 v192, 16, v116
  v_and_b32 v193, 0xffff0000, v116
  v_lshlrev_b32 v194, 16, v117
  v_and_b32 v195, 0xffff0000, v117
  v_lshlrev_b32 v196, 16, v118
  v_and_b32 v197, 0xffff0000, v118
  v_lshlrev_b32 v198, 16, v119
  v_and_b32 v199, 0xffff0000, v119
  v_pk_fma_f32 v[192:193], v[192:193], v[248:249], v[250:251] op_sel_hi:[1,0,0]
  v_pk_fma_f32 v[194:195], v[194:195], v[248:249], v[250:251] op_sel_hi:[1,0,0]
  v_pk_fma_f32 v[196:197], v[196:197], v[248:249], v[250:251] op_sel_hi:[1,0,0]
  v_pk_fma_f32 v[198:199], v[198:199], v[248:249], v[250:251] op_sel_hi:[1,0,0]
  v_cvt_pk_bf16_f32 v116, v192, v193
  v_cvt_pk_bf16_f32 v117, v194, v195
  v_cvt_pk_bf16_f32 v118, v196, v197
  v_cvt_pk_bf16_f32 v119, v198, v199
  s_waitcnt vmcnt(18)
  v_lshlrev_b32 v192, 16, v120
  v_and_b32 v193, 0xffff0000, v120
  v_lshlrev_b32 v194, 16, v121
  v_and_b32 v195, 0xffff0000, v121
  v_lshlrev_b32 v196, 16, v122
  v_and_b32 v197, 0xffff0000, v122
  v_lshlrev_b32 v198, 16, v123
  v_and_b32 v199, 0xffff0000, v123
  v_pk_fma_f32 v[192:193], v[192:193], v[248:249], v[250:251] op_sel_hi:[1,0,0]
  v_pk_fma_f32 v[194:195], v[194:195], v[248:249], v[250:251] op_sel_hi:[1,0,0]
  v_pk_fma_f32 v[196:197], v[196:197], v[248:249], v[250:251] op_sel_hi:[1,0,0]
  v_pk_fma_f32 v[198:199], v[198:199], v[248:249], v[250:251] op_sel_hi:[1,0,0]
  v_cvt_pk_bf16_f32 v120, v192, v193
  v_cvt_pk_bf16_f32 v121, v194, v195
  v_cvt_pk_bf16_f32 v122, v196, v197
  v_cvt_pk_bf16_f32 v123, v198, v199
  s_waitcnt vmcnt(17)
  v_lshlrev_b32 v192, 16, v124
  v_and_b32 v193, 0xffff0000, v124
  v_lshlrev_b32 v194, 16, v125
  v_and_b32 v195, 0xffff0000, v125
  v_lshlrev_b32 v196, 16, v126
  v_and_b32 v197, 0xffff0000, v126
  v_lshlrev_b32 v198, 16, v127
  v_and_b32 v199, 0xffff0000, v127
  v_pk_fma_f32 v[192:193], v[192:193], v[248:249], v[250:251] op_sel_hi:[1,0,0]
  v_pk_fma_f32 v[194:195], v[194:195], v[248:249], v[250:251] op_sel_hi:[1,0,0]
  v_pk_fma_f32 v[196:197], v[196:197], v[248:249], v[250:251] op_sel_hi:[1,0,0]
  v_pk_fma_f32 v[198:199], v[198:199], v[248:249], v[250:251] op_sel_hi:[1,0,0]
  v_cvt_pk_bf16_f32 v124, v192, v193
  v_cvt_pk_bf16_f32 v125, v194, v195
  v_cvt_pk_bf16_f32 v126, v196, v197
  v_cvt_pk_bf16_f32 v127, v198, v199
  s_waitcnt vmcnt(16)
  v_lshlrev_b32 v192, 16, v128
  v_and_b32 v193, 0xffff0000, v128
  v_lshlrev_b32 v194, 16, v129
  v_and_b32 v195, 0xffff0000, v129
  v_lshlrev_b32 v196, 16, v130
  v_and_b32 v197, 0xffff0000, v130
  v_lshlrev_b32 v198, 16, v131
  v_and_b32 v199, 0xffff0000, v131
  v_pk_fma_f32 v[192:193], v[192:193], v[248:249], v[250:251] op_sel_hi:[1,0,0]
  v_pk_fma_f32 v[194:195], v[194:195], v[248:249], v[250:251] op_sel_hi:[1,0,0]
  v_pk_fma_f32 v[196:197], v[196:197], v[248:249], v[250:251] op_sel_hi:[1,0,0]
  v_pk_fma_f32 v[198:199], v[198:199], v[248:249], v[250:251] op_sel_hi:[1,0,0]
  v_cvt_pk_bf16_f32 v128, v192, v193
  v_cvt_pk_bf16_f32 v129, v194, v195
  v_cvt_pk_bf16_f32 v130, v196, v197
  v_cvt_pk_bf16_f32 v131, v198, v199
  s_waitcnt vmcnt(15)
  v_lshlrev_b32 v192, 16, v132
  v_and_b32 v193, 0xffff0000, v132
  v_lshlrev_b32 v194, 16, v133
  v_and_b32 v195, 0xffff0000, v133
  v_lshlrev_b32 v196, 16, v134
  v_and_b32 v197, 0xffff0000, v134
  v_lshlrev_b32 v198, 16, v135
  v_and_b32 v199, 0xffff0000, v135
  v_pk_fma_f32 v[192:193], v[192:193], v[248:249], v[250:251] op_sel_hi:[1,0,0]
  v_pk_fma_f32 v[194:195], v[194:195], v[248:249], v[250:251] op_sel_hi:[1,0,0]
  v_pk_fma_f32 v[196:197], v[196:197], v[248:249], v[250:251] op_sel_hi:[1,0,0]
  v_pk_fma_f32 v[198:199], v[198:199], v[248:249], v[250:251] op_sel_hi:[1,0,0]
  v_cvt_pk_bf16_f32 v132, v192, v193
  v_cvt_pk_bf16_f32 v133, v194, v195
  v_cvt_pk_bf16_f32 v134, v196, v197
  v_cvt_pk_bf16_f32 v135, v198, v199
  s_waitcnt vmcnt(14)
  v_lshlrev_b32 v192, 16, v136
  v_and_b32 v193, 0xffff0000, v136
  v_lshlrev_b32 v194, 16, v137
  v_and_b32 v195, 0xffff0000, v137
  v_lshlrev_b32 v196, 16, v138
  v_and_b32 v197, 0xffff0000, v138
  v_lshlrev_b32 v198, 16, v139
  v_and_b32 v199, 0xffff0000, v139
  v_pk_fma_f32 v[192:193], v[192:193], v[248:249], v[250:251] op_sel_hi:[1,0,0]
  v_pk_fma_f32 v[194:195], v[194:195], v[248:249], v[250:251] op_sel_hi:[1,0,0]
  v_pk_fma_f32 v[196:197], v[196:197], v[248:249], v[250:251] op_sel_hi:[1,0,0]
  v_pk_fma_f32 v[198:199], v[198:199], v[248:249], v[250:251] op_sel_hi:[1,0,0]
  v_cvt_pk_bf16_f32 v136, v192, v193
  v_cvt_pk_bf16_f32 v137, v194, v195
  v_cvt_pk_bf16_f32 v138, v196, v197
  v_cvt_pk_bf16_f32 v139, v198, v199
  s_waitcnt vmcnt(13)
  v_lshlrev_b32 v192, 16, v140
  v_and_b32 v193, 0xffff0000, v140
  v_lshlrev_b32 v194, 16, v141
  v_and_b32 v195, 0xffff0000, v141
  v_lshlrev_b32 v196, 16, v142
  v_and_b32 v197, 0xffff0000, v142
  v_lshlrev_b32 v198, 16, v143
  v_and_b32 v199, 0xffff0000, v143
  v_pk_fma_f32 v[192:193], v[192:193], v[248:249], v[250:251] op_sel_hi:[1,0,0]
  v_pk_fma_f32 v[194:195], v[194:195], v[248:249], v[250:251] op_sel_hi:[1,0,0]
  v_pk_fma_f32 v[196:197], v[196:197], v[248:249], v[250:251] op_sel_hi:[1,0,0]
  v_pk_fma_f32 v[198:199], v[198:199], v[248:249], v[250:251] op_sel_hi:[1,0,0]
  v_cvt_pk_bf16_f32 v140, v192, v193
  v_cvt_pk_bf16_f32 v141, v194, v195
  v_cvt_pk_bf16_f32 v142, v196, v197
  v_cvt_pk_bf16_f32 v143, v198, v199
  s_waitcnt vmcnt(12)
  v_lshlrev_b32 v192, 16, v144
  v_and_b32 v193, 0xffff0000, v144
  v_lshlrev_b32 v194, 16, v145
  v_and_b32 v195, 0xffff0000, v145
  v_lshlrev_b32 v196, 16, v146
  v_and_b32 v197, 0xffff0000, v146
  v_lshlrev_b32 v198, 16, v147
  v_and_b32 v199, 0xffff0000, v147
  v_pk_fma_f32 v[192:193], v[192:193], v[248:249], v[250:251] op_sel_hi:[1,0,0]
  v_pk_fma_f32 v[194:195], v[194:195], v[248:249], v[250:251] op_sel_hi:[1,0,0]
  v_pk_fma_f32 v[196:197], v[196:197], v[248:249], v[250:251] op_sel_hi:[1,0,0]
  v_pk_fma_f32 v[198:199], v[198:199], v[248:249], v[250:251] op_sel_hi:[1,0,0]
  v_cvt_pk_bf16_f32 v144, v192, v193
  v_cvt_pk_bf16_f32 v145, v194, v195
  v_cvt_pk_bf16_f32 v146, v196, v197
  v_cvt_pk_bf16_f32 v147, v198, v199
  s_waitcnt vmcnt(11)
  v_lshlrev_b32 v192, 16, v148
  v_and_b32 v193, 0xffff0000, v148
  v_lshlrev_b32 v194, 16, v149
  v_and_b32 v195, 0xffff0000, v149
  v_lshlrev_b32 v196, 16, v150
  v_and_b32 v197, 0xffff0000, v150
  v_lshlrev_b32 v198, 16, v151
  v_and_b32 v199, 0xffff0000, v151
  v_pk_fma_f32 v[192:193], v[192:193], v[248:249], v[250:251] op_sel_hi:[1,0,0]
  v_pk_fma_f32 v[194:195], v[194:195], v[248:249], v[250:251] op_sel_hi:[1,0,0]
  v_pk_fma_f32 v[196:197], v[196:197], v[248:249], v[250:251] op_sel_hi:[1,0,0]
  v_pk_fma_f32 v[198:199], v[198:199], v[248:249], v[250:251] op_sel_hi:[1,0,0]
  v_cvt_pk_bf16_f32 v148, v192, v193
  v_cvt_pk_bf16_f32 v149, v194, v195
  v_cvt_pk_bf16_f32 v150, v196, v197
  v_cvt_pk_bf16_f32 v151, v198, v199
  s_waitcnt vmcnt(10)
  v_lshlrev_b32 v192, 16, v152
  v_and_b32 v193, 0xffff0000, v152
  v_lshlrev_b32 v194, 16, v153
  v_and_b32 v195, 0xffff0000, v153
  v_lshlrev_b32 v196, 16, v154
  v_and_b32 v197, 0xffff0000, v154
  v_lshlrev_b32 v198, 16, v155
  v_and_b32 v199, 0xffff0000, v155
  v_pk_fma_f32 v[192:193], v[192:193], v[248:249], v[250:251] op_sel_hi:[1,0,0]
  v_pk_fma_f32 v[194:195], v[194:195], v[248:249], v[250:251] op_sel_hi:[1,0,0]
  v_pk_fma_f32 v[196:197], v[196:197], v[248:249], v[250:251] op_sel_hi:[1,0,0]
  v_pk_fma_f32 v[198:199], v[198:199], v[248:249], v[250:251] op_sel_hi:[1,0,0]
  v_cvt_pk_bf16_f32 v152, v192, v193
  v_cvt_pk_bf16_f32 v153, v194, v195
  v_cvt_pk_bf16_f32 v154, v196, v197
  v_cvt_pk_bf16_f32 v155, v198, v199
  s_waitcnt vmcnt(9)
  v_lshlrev_b32 v192, 16, v156
  v_and_b32 v193, 0xffff0000, v156
  v_lshlrev_b32 v194, 16, v157
  v_and_b32 v195, 0xffff0000, v157
  v_lshlrev_b32 v196, 16, v158
  v_and_b32 v197, 0xffff0000, v158
  v_lshlrev_b32 v198, 16, v159
  v_and_b32 v199, 0xffff0000, v159
  v_pk_fma_f32 v[192:193], v[192:193], v[248:249], v[250:251] op_sel_hi:[1,0,0]
  v_pk_fma_f32 v[194:195], v[194:195], v[248:249], v[250:251] op_sel_hi:[1,0,0]
  v_pk_fma_f32 v[196:197], v[196:197], v[248:249], v[250:251] op_sel_hi:[1,0,0]
  v_pk_fma_f32 v[198:199], v[198:199], v[248:249], v[250:251] op_sel_hi:[1,0,0]
  v_cvt_pk_bf16_f32 v156, v192, v193
  v_cvt_pk_bf16_f32 v157, v194, v195
  v_cvt_pk_bf16_f32 v158, v196, v197
  v_cvt_pk_bf16_f32 v159, v198, v199
  v_mov_b32 v7, 0xc0135761
  v_mov_b32 v8, 0xbdd2d3e8
  s_waitcnt vmcnt(9)
  s_barrier
  v_mov_b32 v2, v12
  v_add_u32 v3, 36864, v12
  v_add_u32 v4, 73728, v12
  ds_read_b64_tr_b16 v[200:201], v2 offset:0
  ds_read_b64_tr_b16 v[202:203], v2 offset:512
  ds_read_b64_tr_b16 v[204:205], v2 offset:1024
  ds_read_b64_tr_b16 v[206:207], v2 offset:1536
  ds_read_b64_tr_b16 v[208:209], v2 offset:2048
  ds_read_b64_tr_b16 v[210:211], v2 offset:2560
  ds_read_b64_tr_b16 v[212:213], v2 offset:3072
  ds_read_b64_tr_b16 v[214:215], v2 offset:3584
  s_waitcnt lgkmcnt(4)
  v_mfma_f32_32x32x16_bf16 v[160:175], v[200:203], v[16:19], 0
  ds_read_b64_tr_b16 v[200:201], v2 offset:4096
  ds_read_b64_tr_b16 v[202:203], v2 offset:4608
  s_add_u32 m0, s27, 0
  s_nop 0
  buffer_load_dwordx4 v6, s[12:15], s28 offen offset:0 lds
  v_mfma_f32_32x32x16_bf16 v[160:175], v[204:207], v[20:23], v[160:175]
  ds_read_b64_tr_b16 v[204:205], v2 offset:5120
  ds_read_b64_tr_b16 v[206:207], v2 offset:5632
  s_waitcnt lgkmcnt(4)
  v_mfma_f32_32x32x16_bf16 v[160:175], v[208:211], v[24:27], v[160:175]
  ds_read_b64_tr_b16 v[208:209], v2 offset:6144
  ds_read_b64_tr_b16 v[210:211], v2 offset:6656
  s_add_u32 m0, s27, 960
  s_nop 0
  buffer_load_dwordx4 v6, s[12:15], s28 offen offset:64 lds
  v_mfma_f32_32x32x16_bf16 v[160:175], v[212:215], v[28:31], v[160:175]
  ds_read_b64_tr_b16 v[212:213], v2 offset:7168
  ds_read_b64_tr_b16 v[214:215], v2 offset:7680
  s_waitcnt lgkmcnt(4)
  v_mfma_f32_32x32x16_bf16 v[160:175], v[200:203], v[32:35], v[160:175]
  ds_read_b64_tr_b16 v[200:201], v2 offset:8192
  ds_read_b64_tr_b16 v[202:203], v2 offset:8704
  s_add_u32 m0, s27, 1920
  s_nop 0
  buffer_load_dwordx4 v6, s[12:15], s28 offen offset:128 lds
  v_mfma_f32_32x32x16_bf16 v[160:175], v[204:207], v[36:39], v[160:175]
  ds_read_b64_tr_b16 v[204:205], v2 offset:9216
  ds_read_b64_tr_b16 v[206:207], v2 offset:9728
  s_waitcnt lgkmcnt(4)
  v_mfma_f32_32x32x16_bf16 v[160:175], v[208:211], v[40:43], v[160:175]
  ds_read_b64_tr_b16 v[208:209], v2 offset:10240
  ds_read_b64_tr_b16 v[210:211], v2 offset:10752
  s_add_u32 m0, s27, 2880
  s_nop 0
  buffer_load_dwordx4 v6, s[12:15], s28 offen offset:192 lds
  v_mfma_f32_32x32x16_bf16 v[160:175], v[212:215], v[44:47], v[160:175]
  ds_read_b64_tr_b16 v[212:213], v2 offset:11264
  ds_read_b64_tr_b16 v[214:215], v2 offset:11776
  s_waitcnt lgkmcnt(4)
  v_mfma_f32_32x32x16_bf16 v[160:175], v[200:203], v[48:51], v[160:175]
  ds_read_b64_tr_b16 v[200:201], v2 offset:12288
  ds_read_b64_tr_b16 v[202:203], v2 offset:12800
  s_add_u32 m0, s27, 3840
  s_nop 0
  buffer_load_dwordx4 v6, s[12:15], s28 offen offset:256 lds
  v_mfma_f32_32x32x16_bf16 v[160:175], v[204:207], v[52:55], v[160:175]
  ds_read_b64_tr_b16 v[204:205], v2 offset:13312
  ds_read_b64_tr_b16 v[206:207], v2 offset:13824
  s_waitcnt lgkmcnt(4)
  v_mfma_f32_32x32x16_bf16 v[160:175], v[208:211], v[56:59], v[160:175]
  ds_read_b64_tr_b16 v[208:209], v2 offset:14336
  ds_read_b64_tr_b16 v[210:211], v2 offset:14848
  s_add_u32 m0, s27, 4800
  s_nop 0
  buffer_load_dwordx4 v6, s[12:15], s28 offen offset:320 lds
  v_mfma_f32_32x32x16_bf16 v[160:175], v[212:215], v[60:63], v[160:175]
  ds_read_b64_tr_b16 v[212:213], v2 offset:15360
  ds_read_b64_tr_b16 v[214:215], v2 offset:15872
  s_waitcnt lgkmcnt(4)
  v_mfma_f32_32x32x16_bf16 v[160:175], v[200:203], v[64:67], v[160:175]
  ds_read_b64_tr_b16 v[200:201], v2 offset:16384
  ds_read_b64_tr_b16 v[202:203], v2 offset:16896
  s_add_u32 m0, s27, 5760
  s_nop 0
  buffer_load_dwordx4 v6, s[12:15], s28 offen offset:384 lds
  v_mfma_f32_32x32x16_bf16 v[160:175], v[204:207], v[68:71], v[160:175]
  ds_read_b64_tr_b16 v[204:205], v2 offset:17408
  ds_read_b64_tr_b16 v[206:207], v2 offset:17920
  s_waitcnt lgkmcnt(4)
  v_mfma_f32_32x32x16_bf16 v[160:175], v[208:211], v[72:75], v[160:175]
  ds_read_b64_tr_b16 v[208:209], v2 offset:18432
  ds_read_b64_tr_b16 v[210:211], v2 offset:18944
  s_add_u32 m0, s27, 6720
  s_nop 0
  buffer_load_dwordx4 v6, s[12:15], s28 offen offset:448 lds
  v_mfma_f32_32x32x16_bf16 v[160:175], v[212:215], v[76:79], v[160:175]
  ds_read_b64_tr_b16 v[212:213], v2 offset:19456
  ds_read_b64_tr_b16 v[214:215], v2 offset:19968
  s_waitcnt lgkmcnt(4)
  v_mfma_f32_32x32x16_bf16 v[160:175], v[200:203], v[80:83], v[160:175]
  ds_read_b64_tr_b16 v[200:201], v2 offset:20480
  ds_read_b64_tr_b16 v[202:203], v2 offset:20992
  s_add_u32 m0, s27, 7680
  s_nop 0
  buffer_load_dwordx4 v6, s[12:15], s28 offen offset:512 lds
  v_mfma_f32_32x32x16_bf16 v[160:175], v[204:207], v[84:87], v[160:175]
  ds_read_b64_tr_b16 v[204:205], v2 offset:21504
  ds_read_b64_tr_b16 v[206:207], v2 offset:22016
  v_add_u32 v6, 36864, v6
  s_mul_i32 s23, s3, 9216
  s_add_u32 s26, s23, 110592
  s_mov_b32 s27, s23
  s_waitcnt vmcnt(9)
  s_barrier
  s_waitcnt lgkmcnt(4)
  v_mfma_f32_32x32x16_bf16 v[160:175], v[208:211], v[88:91], v[160:175]
  s_add_u32 m0, s26, 0
  ds_read_b64_tr_b16 v[208:209], v2 offset:22528
  buffer_load_dwordx4 v5, s[8:11], s40 offen lds
  ds_read_b64_tr_b16 v[210:211], v2 offset:23040
  v_mfma_f32_32x32x16_bf16 v[160:175], v[212:215], v[92:95], v[160:175]
  ds_read_b64_tr_b16 v[212:213], v2 offset:23552
  ds_read_b64_tr_b16 v[214:215], v2 offset:24064
  s_waitcnt lgkmcnt(4)
  v_mfma_f32_32x32x16_bf16 v[160:175], v[200:203], v[96:99], v[160:175]
  s_add_u32 m0, s26, 1024
  ds_read_b64_tr_b16 v[200:201], v2 offset:24576
  buffer_load_dwordx4 v5, s[8:11], s41 offen lds
  ds_read_b64_tr_b16 v[202:203], v2 offset:25088
  v_mfma_f32_32x32x16_bf16 v[160:175], v[204:207], v[100:103], v[160:175]
  ds_read_b64_tr_b16 v[204:205], v2 offset:25600
  ds_read_b64_tr_b16 v[206:207], v2 offset:26112
  s_waitcnt lgkmcnt(4)
  v_mfma_f32_32x32x16_bf16 v[160:175], v[208:211], v[104:107], v[160:175]
  s_add_u32 m0, s26, 2048
  ds_read_b64_tr_b16 v[208:209], v2 offset:26624
  buffer_load_dwordx4 v5, s[8:11], s42 offen lds
  ds_read_b64_tr_b16 v[210:211], v2 offset:27136
  v_mfma_f32_32x32x16_bf16 v[160:175], v[212:215], v[108:111], v[160:175]
  ds_read_b64_tr_b16 v[212:213], v2 offset:27648
  ds_read_b64_tr_b16 v[214:215], v2 offset:28160
  s_waitcnt lgkmcnt(4)
  v_mfma_f32_32x32x16_bf16 v[160:175], v[200:203], v[112:115], v[160:175]
  s_add_u32 m0, s26, 3072
  ds_read_b64_tr_b16 v[200:201], v2 offset:28672
  buffer_load_dwordx4 v5, s[8:11], s43 offen lds
  ds_read_b64_tr_b16 v[202:203], v2 offset:29184
  v_mfma_f32_32x32x16_bf16 v[160:175], v[204:207], v[116:119], v[160:175]
  ds_read_b64_tr_b16 v[204:205], v2 offset:29696
  ds_read_b64_tr_b16 v[206:207], v2 offset:30208
  s_waitcnt lgkmcnt(4)
  v_mfma_f32_32x32x16_bf16 v[160:175], v[208:211], v[120:123], v[160:175]
  s_add_u32 m0, s26, 4096
  ds_read_b64_tr_b16 v[208:209], v2 offset:30720
  buffer_load_dwordx4 v5, s[8:11], s44 offen lds
  ds_read_b64_tr_b16 v[210:211], v2 offset:31232
  v_mfma_f32_32x32x16_bf16 v[160:175], v[212:215], v[124:127], v[160:175]
  ds_read_b64_tr_b16 v[212:213], v2 offset:31744
  ds_read_b64_tr_b16 v[214:215], v2 offset:32256
  s_waitcnt lgkmcnt(4)
  v_mfma_f32_32x32x16_bf16 v[160:175], v[200:203], v[128:131], v[160:175]
  s_add_u32 m0, s26, 5120
  ds_read_b64_tr_b16 v[200:201], v2 offset:32768
  buffer_load_dwordx4 v5, s[8:11], s45 offen lds
  ds_read_b64_tr_b16 v[202:203], v2 offset:33280
  v_mfma_f32_32x32x16_bf16 v[160:175], v[204:207], v[132:135], v[160:175]
  ds_read_b64_tr_b16 v[204:205], v2 offset:33792
  ds_read_b64_tr_b16 v[206:207], v2 offset:34304
  s_waitcnt lgkmcnt(4)
  v_mfma_f32_32x32x16_bf16 v[160:175], v[208:211], v[136:139], v[160:175]
  s_add_u32 m0, s26, 6144
  ds_read_b64_tr_b16 v[208:209], v2 offset:34816
  buffer_load_dwordx4 v5, s[8:11], s46 offen lds
  ds_read_b64_tr_b16 v[210:211], v2 offset:35328
  v_mfma_f32_32x32x16_bf16 v[160:175], v[212:215], v[140:143], v[160:175]
  ds_read_b64_tr_b16 v[212:213], v2 offset:35840
  ds_read_b64_tr_b16 v[214:215], v2 offset:36352
  s_waitcnt lgkmcnt(4)
  v_mfma_f32_32x32x16_bf16 v[160:175], v[200:203], v[144:147], v[160:175]
  s_add_u32 m0, s26, 7168
  ds_read_b64_tr_b16 v[200:201], v3 offset:0
  buffer_load_dwordx4 v5, s[8:11], s47 offen lds
  ds_read_b64_tr_b16 v[202:203], v3 offset:512
  v_mfma_f32_32x32x16_bf16 v[160:175], v[204:207], v[148:151], v[160:175]
  ds_read_b64_tr_b16 v[204:205], v3 offset:1024
  ds_read_b64_tr_b16 v[206:207], v3 offset:1536
  s_waitcnt lgkmcnt(4)
  v_mfma_f32_32x32x16_bf16 v[160:175], v[208:211], v[152:155], v[160:175]
  s_add_u32 m0, s26, 8192
  ds_read_b64_tr_b16 v[208:209], v3 offset:2048
  buffer_load_dwordx4 v5, s[8:11], s48 offen lds
  ds_read_b64_tr_b16 v[210:211], v3 offset:2560
  v_mfma_f32_32x32x16_bf16 v[176:191], v[212:215], v[156:159], v[160:175]
  ds_read_b64_tr_b16 v[212:213], v3 offset:3072
  ds_read_b64_tr_b16 v[214:215], v3 offset:3584
  v_add_u32 v5, 64, v5
  s_waitcnt lgkmcnt(4)
  v_mfma_f32_32x32x16_bf16 v[160:175], v[200:203], v[16:19], 0
  ds_read_b64_tr_b16 v[200:201], v3 offset:4096
  ds_read_b64_tr_b16 v[202:203], v3 offset:4608
  v_mfma_f32_32x32x16_bf16 v[160:175], v[204:207], v[20:23], v[160:175]
  ds_read_b64_tr_b16 v[204:205], v3 offset:5120
  ds_read_b64_tr_b16 v[206:207], v3 offset:5632
  s_waitcnt lgkmcnt(4)
  v_mfma_f32_32x32x16_bf16 v[160:175], v[208:211], v[24:27], v[160:175]
  ds_read_b64_tr_b16 v[208:209], v3 offset:6144
  ds_read_b64_tr_b16 v[210:211], v3 offset:6656
  v_mul_f32 v248, v176, v176
  v_mul_f32 v249, v177, v177
  v_mul_f32 v250, v178, v178
  v_mul_f32 v251, v179, v179
  v_mfma_f32_32x32x16_bf16 v[160:175], v[212:215], v[28:31], v[160:175]
  ds_read_b64_tr_b16 v[212:213], v3 offset:7168
  ds_read_b64_tr_b16 v[214:215], v3 offset:7680
  v_fma_f32 v248, v248, v8, v7
  v_fma_f32 v249, v249, v8, v7
  v_fma_f32 v250, v250, v8, v7
  v_fma_f32 v251, v251, v8, v7
  s_waitcnt lgkmcnt(4)
  v_mfma_f32_32x32x16_bf16 v[160:175], v[200:203], v[32:35], v[160:175]
  ds_read_b64_tr_b16 v[200:201], v3 offset:8192
  ds_read_b64_tr_b16 v[202:203], v3 offset:8704
  v_mul_f32 v248, v176, v248
  v_mul_f32 v249, v177, v249
  v_mul_f32 v250, v178, v250
  v_mul_f32 v251, v179, v251
  v_mfma_f32_32x32x16_bf16 v[160:175], v[204:207], v[36:39], v[160:175]
  ds_read_b64_tr_b16 v[204:205], v3 offset:9216
  ds_read_b64_tr_b16 v[206:207], v3 offset:9728
  v_exp_f32 v248, v248
  v_exp_f32 v249, v249
  v_exp_f32 v250, v250
  s_waitcnt lgkmcnt(4)
  v_mfma_f32_32x32x16_bf16 v[160:175], v[208:211], v[40:43], v[160:175]
  ds_read_b64_tr_b16 v[208:209], v3 offset:10240
  ds_read_b64_tr_b16 v[210:211], v3 offset:10752
  v_exp_f32 v251, v251
  v_add_f32 v248, 1.0, v248
  v_add_f32 v249, 1.0, v249
  v_add_f32 v250, 1.0, v250
  v_mfma_f32_32x32x16_bf16 v[160:175], v[212:215], v[44:47], v[160:175]
  ds_read_b64_tr_b16 v[212:213], v3 offset:11264
  ds_read_b64_tr_b16 v[214:215], v3 offset:11776
  v_add_f32 v251, 1.0, v251
  v_rcp_f32 v248, v248
  v_rcp_f32 v249, v249
  v_rcp_f32 v250, v250
  s_waitcnt lgkmcnt(4)
  v_mfma_f32_32x32x16_bf16 v[160:175], v[200:203], v[48:51], v[160:175]
  ds_read_b64_tr_b16 v[200:201], v3 offset:12288
  ds_read_b64_tr_b16 v[202:203], v3 offset:12800
  v_rcp_f32 v251, v251
  v_mul_f32 v176, v176, v248
  v_mul_f32 v177, v177, v249
  v_mul_f32 v178, v178, v250
  v_mfma_f32_32x32x16_bf16 v[160:175], v[204:207], v[52:55], v[160:175]
  ds_read_b64_tr_b16 v[204:205], v3 offset:13312
  ds_read_b64_tr_b16 v[206:207], v3 offset:13824
  v_mul_f32 v179, v179, v251
  v_cvt_pk_bf16_f32 v192, v176, v177
  v_cvt_pk_bf16_f32 v193, v178, v179
  s_waitcnt lgkmcnt(4)
  v_mfma_f32_32x32x16_bf16 v[160:175], v[208:211], v[56:59], v[160:175]
  ds_read_b64_tr_b16 v[208:209], v3 offset:14336
  ds_read_b64_tr_b16 v[210:211], v3 offset:14848
  v_mul_f32 v248, v180, v180
  v_mul_f32 v249, v181, v181
  v_mul_f32 v250, v182, v182
  v_mul_f32 v251, v183, v183
  v_mfma_f32_32x32x16_bf16 v[160:175], v[212:215], v[60:63], v[160:175]
  ds_read_b64_tr_b16 v[212:213], v3 offset:15360
  ds_read_b64_tr_b16 v[214:215], v3 offset:15872
  v_fma_f32 v248, v248, v8, v7
  v_fma_f32 v249, v249, v8, v7
  v_fma_f32 v250, v250, v8, v7
  v_fma_f32 v251, v251, v8, v7
  s_waitcnt lgkmcnt(4)
  v_mfma_f32_32x32x16_bf16 v[160:175], v[200:203], v[64:67], v[160:175]
  ds_read_b64_tr_b16 v[200:201], v3 offset:16384
  ds_read_b64_tr_b16 v[202:203], v3 offset:16896
  v_mul_f32 v248, v180, v248
  v_mul_f32 v249, v181, v249
  v_mul_f32 v250, v182, v250
  v_mul_f32 v251, v183, v251
  v_mfma_f32_32x32x16_bf16 v[160:175], v[204:207], v[68:71], v[160:175]
  ds_read_b64_tr_b16 v[204:205], v3 offset:17408
  ds_read_b64_tr_b16 v[206:207], v3 offset:17920
  v_exp_f32 v248, v248
  v_exp_f32 v249, v249
  v_exp_f32 v250, v250
  s_waitcnt lgkmcnt(4)
  v_mfma_f32_32x32x16_bf16 v[160:175], v[208:211], v[72:75], v[160:175]
  ds_read_b64_tr_b16 v[208:209], v3 offset:18432
  ds_read_b64_tr_b16 v[210:211], v3 offset:18944
  v_exp_f32 v251, v251
  v_add_f32 v248, 1.0, v248
  v_add_f32 v249, 1.0, v249
  v_add_f32 v250, 1.0, v250
  v_mfma_f32_32x32x16_bf16 v[160:175], v[212:215], v[76:79], v[160:175]
  ds_read_b64_tr_b16 v[212:213], v3 offset:19456
  ds_read_b64_tr_b16 v[214:215], v3 offset:19968
  v_add_f32 v251, 1.0, v251
  v_rcp_f32 v248, v248
  v_rcp_f32 v249, v249
  v_rcp_f32 v250, v250
  s_waitcnt lgkmcnt(4)
  v_mfma_f32_32x32x16_bf16 v[160:175], v[200:203], v[80:83], v[160:175]
  ds_read_b64_tr_b16 v[200:201], v3 offset:20480
  ds_read_b64_tr_b16 v[202:203], v3 offset:20992
  v_rcp_f32 v251, v251
  v_mul_f32 v180, v180, v248
  v_mul_f32 v181, v181, v249
  v_mul_f32 v182, v182, v250
  v_mfma_f32_32x32x16_bf16 v[160:175], v[204:207], v[84:87], v[160:175]
  ds_read_b64_tr_b16 v[204:205], v3 offset:21504
  ds_read_b64_tr_b16 v[206:207], v3 offset:22016
  v_mul_f32 v183, v183, v251
  v_cvt_pk_bf16_f32 v194, v180, v181
  v_cvt_pk_bf16_f32 v195, v182, v183
  s_waitcnt vmcnt(9)
  s_barrier
  s_waitcnt lgkmcnt(4)
  v_mfma_f32_32x32x16_bf16 v[160:175], v[208:211], v[88:91], v[160:175]
  s_add_u32 m0, s27, 0
  ds_read_b64_tr_b16 v[208:209], v3 offset:22528
  buffer_load_dwordx4 v6, s[12:15], s28 offen offset:0 lds
  ds_read_b64_tr_b16 v[210:211], v3 offset:23040
  v_mul_f32 v248, v184, v184
  v_mul_f32 v249, v185, v185
  v_mul_f32 v250, v186, v186
  v_mul_f32 v251, v187, v187
  v_mfma_f32_32x32x16_bf16 v[160:175], v[212:215], v[92:95], v[160:175]
  ds_read_b64_tr_b16 v[212:213], v3 offset:23552
  ds_read_b64_tr_b16 v[214:215], v3 offset:24064
  v_fma_f32 v248, v248, v8, v7
  v_fma_f32 v249, v249, v8, v7
  v_fma_f32 v250, v250, v8, v7
  v_fma_f32 v251, v251, v8, v7
  s_waitcnt lgkmcnt(4)
  v_mfma_f32_32x32x16_bf16 v[160:175], v[200:203], v[96:99], v[160:175]
  s_add_u32 m0, s27, 960
  ds_read_b64_tr_b16 v[200:201], v3 offset:24576
  buffer_load_dwordx4 v6, s[12:15], s28 offen offset:64 lds
  ds_read_b64_tr_b16 v[202:203], v3 offset:25088
  v_mul_f32 v248, v184, v248
  v_mul_f32 v249, v185, v249
  v_mul_f32 v250, v186, v250
  v_mul_f32 v251, v187, v251
  v_mfma_f32_32x32x16_bf16 v[160:175], v[204:207], v[100:103], v[160:175]
  ds_read_b64_tr_b16 v[204:205], v3 offset:25600
  ds_read_b64_tr_b16 v[206:207], v3 offset:26112
  v_exp_f32 v248, v248
  v_exp_f32 v249, v249
  v_exp_f32 v250, v250
  s_waitcnt lgkmcnt(4)
  v_mfma_f32_32x32x16_bf16 v[160:175], v[208:211], v[104:107], v[160:175]
  s_add_u32 m0, s27, 1920
  ds_read_b64_tr_b16 v[208:209], v3 offset:26624
  buffer_load_dwordx4 v6, s[12:15], s28 offen offset:128 lds
  ds_read_b64_tr_b16 v[210:211], v3 offset:27136
  v_exp_f32 v251, v251
  v_add_f32 v248, 1.0, v248
  v_add_f32 v249, 1.0, v249
  v_add_f32 v250, 1.0, v250
  v_mfma_f32_32x32x16_bf16 v[160:175], v[212:215], v[108:111], v[160:175]
  ds_read_b64_tr_b16 v[212:213], v3 offset:27648
  ds_read_b64_tr_b16 v[214:215], v3 offset:28160
  v_add_f32 v251, 1.0, v251
  v_rcp_f32 v248, v248
  v_rcp_f32 v249, v249
  v_rcp_f32 v250, v250
  s_waitcnt lgkmcnt(4)
  v_mfma_f32_32x32x16_bf16 v[160:175], v[200:203], v[112:115], v[160:175]
  s_add_u32 m0, s27, 2880
  ds_read_b64_tr_b16 v[200:201], v3 offset:28672
  buffer_load_dwordx4 v6, s[12:15], s28 offen offset:192 lds
  ds_read_b64_tr_b16 v[202:203], v3 offset:29184
  v_rcp_f32 v251, v251
  v_mul_f32 v184, v184, v248
  v_mul_f32 v185, v185, v249
  v_mul_f32 v186, v186, v250
  v_mfma_f32_32x32x16_bf16 v[160:175], v[204:207], v[116:119], v[160:175]
  ds_read_b64_tr_b16 v[204:205], v3 offset:29696
  ds_read_b64_tr_b16 v[206:207], v3 offset:30208
  v_mul_f32 v187, v187, v251
  v_cvt_pk_bf16_f32 v196, v184, v185
  v_cvt_pk_bf16_f32 v197, v186, v187
  s_waitcnt lgkmcnt(4)
  v_mfma_f32_32x32x16_bf16 v[160:175], v[208:211], v[120:123], v[160:175]
  s_add_u32 m0, s27, 3840
  ds_read_b64_tr_b16 v[208:209], v3 offset:30720
  buffer_load_dwordx4 v6, s[12:15], s28 offen offset:256 lds
  ds_read_b64_tr_b16 v[210:211], v3 offset:31232
  v_mul_f32 v248, v188, v188
  v_mul_f32 v249, v189, v189
  v_mul_f32 v250, v190, v190
  v_mul_f32 v251, v191, v191
  v_mfma_f32_32x32x16_bf16 v[160:175], v[212:215], v[124:127], v[160:175]
  ds_read_b64_tr_b16 v[212:213], v3 offset:31744
  ds_read_b64_tr_b16 v[214:215], v3 offset:32256
  v_fma_f32 v248, v248, v8, v7
  v_fma_f32 v249, v249, v8, v7
  v_fma_f32 v250, v250, v8, v7
  v_fma_f32 v251, v251, v8, v7
  s_waitcnt lgkmcnt(4)
  v_mfma_f32_32x32x16_bf16 v[160:175], v[200:203], v[128:131], v[160:175]
  s_add_u32 m0, s27, 4800
  ds_read_b64_tr_b16 v[200:201], v3 offset:32768
  buffer_load_dwordx4 v6, s[12:15], s28 offen offset:320 lds
  ds_read_b64_tr_b16 v[202:203], v3 offset:33280
  v_mul_f32 v248, v188, v248
  v_mul_f32 v249, v189, v249
  v_mul_f32 v250, v190, v250
  v_mul_f32 v251, v191, v251
  v_mfma_f32_32x32x16_bf16 v[160:175], v[204:207], v[132:135], v[160:175]
  ds_read_b64_tr_b16 v[204:205], v3 offset:33792
  ds_read_b64_tr_b16 v[206:207], v3 offset:34304
  v_exp_f32 v248, v248
  v_exp_f32 v249, v249
  v_exp_f32 v250, v250
  s_waitcnt lgkmcnt(4)
  v_mfma_f32_32x32x16_bf16 v[160:175], v[208:211], v[136:139], v[160:175]
  s_add_u32 m0, s27, 5760
  ds_read_b64_tr_b16 v[208:209], v3 offset:34816
  buffer_load_dwordx4 v6, s[12:15], s28 offen offset:384 lds
  ds_read_b64_tr_b16 v[210:211], v3 offset:35328
  v_exp_f32 v251, v251
  v_add_f32 v248, 1.0, v248
  v_add_f32 v249, 1.0, v249
  v_add_f32 v250, 1.0, v250
  v_mfma_f32_32x32x16_bf16 v[160:175], v[212:215], v[140:143], v[160:175]
  ds_read_b64_tr_b16 v[212:213], v3 offset:35840
  ds_read_b64_tr_b16 v[214:215], v3 offset:36352
  v_add_f32 v251, 1.0, v251
  v_rcp_f32 v248, v248
  v_rcp_f32 v249, v249
  v_rcp_f32 v250, v250
  s_waitcnt lgkmcnt(4)
  v_mfma_f32_32x32x16_bf16 v[160:175], v[200:203], v[144:147], v[160:175]
  s_add_u32 m0, s27, 6720
  ds_read_b64_tr_b16 v[200:201], v4 offset:0
  buffer_load_dwordx4 v6, s[12:15], s28 offen offset:448 lds
  ds_read_b64_tr_b16 v[202:203], v4 offset:512
  v_rcp_f32 v251, v251
  v_mul_f32 v188, v188, v248
  v_mul_f32 v189, v189, v249
  v_mul_f32 v190, v190, v250
  v_mfma_f32_32x32x16_bf16 v[160:175], v[204:207], v[148:151], v[160:175]
  ds_read_b64_tr_b16 v[204:205], v4 offset:1024
  ds_read_b64_tr_b16 v[206:207], v4 offset:1536
  v_mul_f32 v191, v191, v251
  v_cvt_pk_bf16_f32 v198, v188, v189
  v_cvt_pk_bf16_f32 v199, v190, v191
  s_waitcnt lgkmcnt(4)
  v_mfma_f32_32x32x16_bf16 v[160:175], v[208:211], v[152:155], v[160:175]
  s_add_u32 m0, s27, 7680
  ds_read_b64_tr_b16 v[208:209], v4 offset:2048
  buffer_load_dwordx4 v6, s[12:15], s28 offen offset:512 lds
  ds_read_b64_tr_b16 v[210:211], v4 offset:2560
  v_mfma_f32_32x32x16_bf16 v[176:191], v[212:215], v[156:159], v[160:175]
  ds_read_b64_tr_b16 v[212:213], v4 offset:3072
  ds_read_b64_tr_b16 v[214:215], v4 offset:3584
  v_add_u32 v6, 36864, v6
  s_mov_b32 s25, 73728
  v_mov_b32 v2, v4
  v_add_u32 v3, 36864, v2
  v_mov_b32 v4, v12
  s_mov_b32 s24, 0
  v_mov_b32 v10, v4
  s_mul_i32 s33, s3, 9216
L_mlp_loop:
  s_waitcnt lgkmcnt(4)
  v_mfma_f32_32x32x16_bf16 a[0:15], v[200:203], v[192:195], a[0:15]
  ds_read_b64_tr_b16 v[200:201], v2 offset:4096
  ds_read_b64_tr_b16 v[202:203], v2 offset:4608
  v_mov_b32 v4, v10
  s_cmp_lt_u32 s24, 15
  s_cselect_b32 s10, s29, 0
  v_mfma_f32_32x32x16_bf16 a[16:31], v[204:207], v[192:195], a[16:31]
  ds_read_b64_tr_b16 v[204:205], v2 offset:5120
  ds_read_b64_tr_b16 v[206:207], v2 offset:5632
  s_xor_b32 s31, s25, 73728
  s_waitcnt lgkmcnt(4)
  v_mfma_f32_32x32x16_bf16 a[32:47], v[208:211], v[192:195], a[32:47]
  ds_read_b64_tr_b16 v[208:209], v2 offset:6144
  ds_read_b64_tr_b16 v[210:211], v2 offset:6656
  v_mul_f32 v248, v176, v176
  v_mul_f32 v249, v177, v177
  v_mfma_f32_32x32x16_bf16 a[48:63], v[212:215], v[192:195], a[48:63]
  ds_read_b64_tr_b16 v[212:213], v2 offset:7168
  ds_read_b64_tr_b16 v[214:215], v2 offset:7680
  v_mul_f32 v250, v178, v178
  v_mul_f32 v251, v179, v179
  s_waitcnt lgkmcnt(4)
  v_mfma_f32_32x32x16_bf16 a[64:79], v[200:203], v[192:195], a[64:79]
  ds_read_b64_tr_b16 v[200:201], v2 offset:8192
  ds_read_b64_tr_b16 v[202:203], v2 offset:8704
  v_fma_f32 v248, v248, v8, v7
  v_fma_f32 v249, v249, v8, v7
  s_add_u32 s32, s31, 36864
  v_mfma_f32_32x32x16_bf16 a[80:95], v[204:207], v[192:195], a[80:95]
  ds_read_b64_tr_b16 v[204:205], v2 offset:9216
  ds_read_b64_tr_b16 v[206:207], v2 offset:9728
  v_fma_f32 v250, v250, v8, v7
  v_fma_f32 v251, v251, v8, v7
  s_waitcnt lgkmcnt(4)
  v_mfma_f32_32x32x16_bf16 a[96:111], v[208:211], v[192:195], a[96:111]
  ds_read_b64_tr_b16 v[208:209], v2 offset:10240
  ds_read_b64_tr_b16 v[210:211], v2 offset:10752
  v_mul_f32 v248, v176, v248
  v_mul_f32 v249, v177, v249
  s_add_u32 s26, s33, s32
  v_mfma_f32_32x32x16_bf16 a[112:127], v[212:215], v[192:195], a[112:127]
  ds_read_b64_tr_b16 v[212:213], v2 offset:11264
  ds_read_b64_tr_b16 v[214:215], v2 offset:11776
  v_mul_f32 v250, v178, v250
  v_mul_f32 v251, v179, v251
  s_waitcnt lgkmcnt(4)
  v_mfma_f32_32x32x16_bf16 a[128:143], v[200:203], v[192:195], a[128:143]
  ds_read_b64_tr_b16 v[200:201], v2 offset:12288
  ds_read_b64_tr_b16 v[202:203], v2 offset:12800
  v_exp_f32 v248, v248
  v_exp_f32 v249, v249
  s_add_u32 s27, s33, s25
  v_mfma_f32_32x32x16_bf16 a[144:159], v[204:207], v[192:195], a[144:159]
  ds_read_b64_tr_b16 v[204:205], v2 offset:13312
  ds_read_b64_tr_b16 v[206:207], v2 offset:13824
  v_exp_f32 v250, v250
  v_exp_f32 v251, v251
  s_waitcnt lgkmcnt(4)
  v_mfma_f32_32x32x16_bf16 a[160:175], v[208:211], v[192:195], a[160:175]
  ds_read_b64_tr_b16 v[208:209], v2 offset:14336
  ds_read_b64_tr_b16 v[210:211], v2 offset:14848
  v_add_f32 v248, 1.0, v248
  v_add_f32 v249, 1.0, v249
  s_mov_b32 s25, s31
  v_mfma_f32_32x32x16_bf16 a[176:191], v[212:215], v[192:195], a[176:191]
  ds_read_b64_tr_b16 v[212:213], v2 offset:15360
  ds_read_b64_tr_b16 v[214:215], v2 offset:15872
  v_add_f32 v250, 1.0, v250
  v_add_f32 v251, 1.0, v251
  s_waitcnt lgkmcnt(4)
  v_mfma_f32_32x32x16_bf16 a[192:207], v[200:203], v[192:195], a[192:207]
  ds_read_b64_tr_b16 v[200:201], v2 offset:16384
  ds_read_b64_tr_b16 v[202:203], v2 offset:16896
  v_rcp_f32 v248, v248
  v_rcp_f32 v249, v249
  v_mfma_f32_32x32x16_bf16 a[208:223], v[204:207], v[192:195], a[208:223]
  ds_read_b64_tr_b16 v[204:205], v2 offset:17408
  ds_read_b64_tr_b16 v[206:207], v2 offset:17920
  v_rcp_f32 v250, v250
  v_rcp_f32 v251, v251
  s_waitcnt lgkmcnt(4)
  v_mfma_f32_32x32x16_bf16 a[224:239], v[208:211], v[192:195], a[224:239]
  ds_read_b64_tr_b16 v[208:209], v2 offset:18432
  ds_read_b64_tr_b16 v[210:211], v2 offset:18944
  v_mul_f32 v176, v176, v248
  v_mul_f32 v177, v177, v249
  v_mfma_f32_32x32x16_bf16 a[240:255], v[212:215], v[192:195], a[240:255]
  ds_read_b64_tr_b16 v[212:213], v2 offset:19456
  ds_read_b64_tr_b16 v[214:215], v2 offset:19968
  v_mul_f32 v178, v178, v250
  v_mul_f32 v179, v179, v251
  s_waitcnt lgkmcnt(4)
  v_mfma_f32_32x32x16_bf16 v[216:231], v[200:203], v[192:195], v[216:231]
  ds_read_b64_tr_b16 v[200:201], v2 offset:20480
  ds_read_b64_tr_b16 v[202:203], v2 offset:20992
  v_mul_f32 v248, v180, v180
  v_mul_f32 v249, v181, v181
  v_mfma_f32_32x32x16_bf16 v[232:247], v[204:207], v[192:195], v[232:247]
  ds_read_b64_tr_b16 v[204:205], v2 offset:21504
  ds_read_b64_tr_b16 v[206:207], v2 offset:22016
  v_mul_f32 v250, v182, v182
  v_mul_f32 v251, v183, v183
  s_waitcnt vmcnt(9)
  s_barrier
  s_waitcnt lgkmcnt(4)
  v_mfma_f32_32x32x16_bf16 a[0:15], v[208:211], v[196:199], a[0:15]
  s_add_u32 m0, s26, 0
  ds_read_b64_tr_b16 v[208:209], v2 offset:22528
  buffer_load_dwordx4 v5, s[8:11], s40 offen lds
  ds_read_b64_tr_b16 v[210:211], v2 offset:23040
  v_fma_f32 v248, v248, v8, v7
  v_fma_f32 v249, v249, v8, v7
  v_mfma_f32_32x32x16_bf16 a[16:31], v[212:215], v[196:199], a[16:31]
  ds_read_b64_tr_b16 v[212:213], v2 offset:23552
  ds_read_b64_tr_b16 v[214:215], v2 offset:24064
  v_fma_f32 v250, v250, v8, v7
  v_fma_f32 v251, v251, v8, v7
  s_waitcnt lgkmcnt(4)
  v_mfma_f32_32x32x16_bf16 a[32:47], v[200:203], v[196:199], a[32:47]
  s_add_u32 m0, s26, 1024
  ds_read_b64_tr_b16 v[200:201], v2 offset:24576
  buffer_load_dwordx4 v5, s[8:11], s41 offen lds
  ds_read_b64_tr_b16 v[202:203], v2 offset:25088
  v_mul_f32 v248, v180, v248
  v_mul_f32 v249, v181, v249
  v_mfma_f32_32x32x16_bf16 a[48:63], v[204:207], v[196:199], a[48:63]
  ds_read_b64_tr_b16 v[204:205], v2 offset:25600
  ds_read_b64_tr_b16 v[206:207], v2 offset:26112
  v_mul_f32 v250, v182, v250
  v_mul_f32 v251, v183, v251
  s_waitcnt lgkmcnt(4)
  v_mfma_f32_32x32x16_bf16 a[64:79], v[208:211], v[196:199], a[64:79]
  s_add_u32 m0, s26, 2048
  ds_read_b64_tr_b16 v[208:209], v2 offset:26624
  buffer_load_dwordx4 v5, s[8:11], s42 offen lds
  ds_read_b64_tr_b16 v[210:211], v2 offset:27136
  v_exp_f32 v248, v248
  v_exp_f32 v249, v249
  v_mfma_f32_32x32x16_bf16 a[80:95], v[212:215], v[196:199], a[80:95]
  ds_read_b64_tr_b16 v[212:213], v2 offset:27648
  ds_read_b64_tr_b16 v[214:215], v2 offset:28160
  v_exp_f32 v250, v250
  v_exp_f32 v251, v251
  s_waitcnt lgkmcnt(4)
  v_mfma_f32_32x32x16_bf16 a[96:111], v[200:203], v[196:199], a[96:111]
  s_add_u32 m0, s26, 3072
  ds_read_b64_tr_b16 v[200:201], v2 offset:28672
  buffer_load_dwordx4 v5, s[8:11], s43 offen lds
  ds_read_b64_tr_b16 v[202:203], v2 offset:29184
  v_add_f32 v248, 1.0, v248
  v_add_f32 v249, 1.0, v249
  v_mfma_f32_32x32x16_bf16 a[112:127], v[204:207], v[196:199], a[112:127]
  ds_read_b64_tr_b16 v[204:205], v2 offset:29696
  ds_read_b64_tr_b16 v[206:207], v2 offset:30208
  v_add_f32 v250, 1.0, v250
  v_add_f32 v251, 1.0, v251
  s_waitcnt lgkmcnt(4)
  v_mfma_f32_32x32x16_bf16 a[128:143], v[208:211], v[196:199], a[128:143]
  s_add_u32 m0, s26, 4096
  ds_read_b64_tr_b16 v[208:209], v2 offset:30720
  buffer_load_dwordx4 v5, s[8:11], s44 offen lds
  ds_read_b64_tr_b16 v[210:211], v2 offset:31232
  v_rcp_f32 v248, v248
  v_rcp_f32 v249, v249
  v_mfma_f32_32x32x16_bf16 a[144:159], v[212:215], v[196:199], a[144:159]
  ds_read_b64_tr_b16 v[212:213], v2 offset:31744
  ds_read_b64_tr_b16 v[214:215], v2 offset:32256
  v_rcp_f32 v250, v250
  v_rcp_f32 v251, v251
  s_waitcnt lgkmcnt(4)
  v_mfma_f32_32x32x16_bf16 a[160:175], v[200:203], v[196:199], a[160:175]
  s_add_u32 m0, s26, 5120
  ds_read_b64_tr_b16 v[200:201], v2 offset:32768
  buffer_load_dwordx4 v5, s[8:11], s45 offen lds
  ds_read_b64_tr_b16 v[202:203], v2 offset:33280
  v_mul_f32 v180, v180, v248
  v_mul_f32 v181, v181, v249
  v_mfma_f32_32x32x16_bf16 a[176:191], v[204:207], v[196:199], a[176:191]
  ds_read_b64_tr_b16 v[204:205], v2 offset:33792
  ds_read_b64_tr_b16 v[206:207], v2 offset:34304
  v_mul_f32 v182, v182, v250
  v_mul_f32 v183, v183, v251
  s_waitcnt lgkmcnt(4)
  v_mfma_f32_32x32x16_bf16 a[192:207], v[208:211], v[196:199], a[192:207]
  s_add_u32 m0, s26, 6144
  ds_read_b64_tr_b16 v[208:209], v2 offset:34816
  buffer_load_dwordx4 v5, s[8:11], s46 offen lds
  ds_read_b64_tr_b16 v[210:211], v2 offset:35328
  v_mfma_f32_32x32x16_bf16 a[208:223], v[212:215], v[196:199], a[208:223]
  ds_read_b64_tr_b16 v[212:213], v2 offset:35840
  ds_read_b64_tr_b16 v[214:215], v2 offset:36352
  v_cvt_pk_bf16_f32 v192, v176, v177
  s_waitcnt lgkmcnt(4)
  v_mfma_f32_32x32x16_bf16 a[224:239], v[200:203], v[196:199], a[224:239]
  s_add_u32 m0, s26, 7168
  ds_read_b64_tr_b16 v[200:201], v3 offset:0
  buffer_load_dwordx4 v5, s[8:11], s47 offen lds
  ds_read_b64_tr_b16 v[202:203], v3 offset:512
  v_cvt_pk_bf16_f32 v193, v178, v179
  v_mfma_f32_32x32x16_bf16 a[240:255], v[204:207], v[196:199], a[240:255]
  ds_read_b64_tr_b16 v[204:205], v3 offset:1024
  ds_read_b64_tr_b16 v[206:207], v3 offset:1536
  v_cvt_pk_bf16_f32 v194, v180, v181
  s_waitcnt lgkmcnt(4)
  v_mfma_f32_32x32x16_bf16 v[216:231], v[208:211], v[196:199], v[216:231]
  s_add_u32 m0, s26, 8192
  ds_read_b64_tr_b16 v[208:209], v3 offset:2048
  buffer_load_dwordx4 v5, s[8:11], s48 offen lds
  ds_read_b64_tr_b16 v[210:211], v3 offset:2560
  v_cvt_pk_bf16_f32 v195, v182, v183
  v_mfma_f32_32x32x16_bf16 v[232:247], v[212:215], v[196:199], v[232:247]
  ds_read_b64_tr_b16 v[212:213], v3 offset:3072
  ds_read_b64_tr_b16 v[214:215], v3 offset:3584
  v_add_u32 v5, 64, v5
  s_waitcnt lgkmcnt(4)
  v_mfma_f32_32x32x16_bf16 v[160:175], v[200:203], v[16:19], 0
  ds_read_b64_tr_b16 v[200:201], v3 offset:4096
  ds_read_b64_tr_b16 v[202:203], v3 offset:4608
  v_mov_b32 v10, v2
  v_mov_b32 v2, v4
  v_mfma_f32_32x32x16_bf16 v[160:175], v[204:207], v[20:23], v[160:175]
  ds_read_b64_tr_b16 v[204:205], v3 offset:5120
  ds_read_b64_tr_b16 v[206:207], v3 offset:5632
  v_mul_f32 v248, v184, v184
  v_mul_f32 v249, v185, v185
  s_waitcnt lgkmcnt(4)
  v_mfma_f32_32x32x16_bf16 v[160:175], v[208:211], v[24:27], v[160:175]
  ds_read_b64_tr_b16 v[208:209], v3 offset:6144
  ds_read_b64_tr_b16 v[210:211], v3 offset:6656
  v_mul_f32 v250, v186, v186
  v_mul_f32 v251, v187, v187
  v_mfma_f32_32x32x16_bf16 v[160:175], v[212:215], v[28:31], v[160:175]
  ds_read_b64_tr_b16 v[212:213], v3 offset:7168
  ds_read_b64_tr_b16 v[214:215], v3 offset:7680
  v_fma_f32 v248, v248, v8, v7
  v_fma_f32 v249, v249, v8, v7
  s_waitcnt lgkmcnt(4)
  v_mfma_f32_32x32x16_bf16 v[160:175], v[200:203], v[32:35], v[160:175]
  ds_read_b64_tr_b16 v[200:201], v3 offset:8192
  ds_read_b64_tr_b16 v[202:203], v3 offset:8704
  v_fma_f32 v250, v250, v8, v7
  v_fma_f32 v251, v251, v8, v7
  v_mfma_f32_32x32x16_bf16 v[160:175], v[204:207], v[36:39], v[160:175]
  ds_read_b64_tr_b16 v[204:205], v3 offset:9216
  ds_read_b64_tr_b16 v[206:207], v3 offset:9728
  v_mul_f32 v248, v184, v248
  v_mul_f32 v249, v185, v249
  s_waitcnt lgkmcnt(4)
  v_mfma_f32_32x32x16_bf16 v[160:175], v[208:211], v[40:43], v[160:175]
  ds_read_b64_tr_b16 v[208:209], v3 offset:10240
  ds_read_b64_tr_b16 v[210:211], v3 offset:10752
  v_mul_f32 v250, v186, v250
  v_mul_f32 v251, v187, v251
  v_mfma_f32_32x32x16_bf16 v[160:175], v[212:215], v[44:47], v[160:175]
  ds_read_b64_tr_b16 v[212:213], v3 offset:11264
  ds_read_b64_tr_b16 v[214:215], v3 offset:11776
  v_exp_f32 v248, v248
  v_exp_f32 v249, v249
  s_waitcnt lgkmcnt(4)
  v_mfma_f32_32x32x16_bf16 v[160:175], v[200:203], v[48:51], v[160:175]
  ds_read_b64_tr_b16 v[200:201], v3 offset:12288
  ds_read_b64_tr_b16 v[202:203], v3 offset:12800
  v_exp_f32 v250, v250
  v_mfma_f32_32x32x16_bf16 v[160:175], v[204:207], v[52:55], v[160:175]
  ds_read_b64_tr_b16 v[204:205], v3 offset:13312
  ds_read_b64_tr_b16 v[206:207], v3 offset:13824
  v_exp_f32 v251, v251
  v_add_f32 v248, 1.0, v248
  s_waitcnt lgkmcnt(4)
  v_mfma_f32_32x32x16_bf16 v[160:175], v[208:211], v[56:59], v[160:175]
  ds_read_b64_tr_b16 v[208:209], v3 offset:14336
  ds_read_b64_tr_b16 v[210:211], v3 offset:14848
  v_add_f32 v249, 1.0, v249
  v_add_f32 v250, 1.0, v250
  v_mfma_f32_32x32x16_bf16 v[160:175], v[212:215], v[60:63], v[160:175]
  ds_read_b64_tr_b16 v[212:213], v3 offset:15360
  ds_read_b64_tr_b16 v[214:215], v3 offset:15872
  v_add_f32 v251, 1.0, v251
  v_rcp_f32 v248, v248
  s_waitcnt lgkmcnt(4)
  v_mfma_f32_32x32x16_bf16 v[160:175], v[200:203], v[64:67], v[160:175]
  ds_read_b64_tr_b16 v[200:201], v3 offset:16384
  ds_read_b64_tr_b16 v[202:203], v3 offset:16896
  v_rcp_f32 v249, v249
  v_rcp_f32 v250, v250
  v_mfma_f32_32x32x16_bf16 v[160:175], v[204:207], v[68:71], v[160:175]
  ds_read_b64_tr_b16 v[204:205], v3 offset:17408
  ds_read_b64_tr_b16 v[206:207], v3 offset:17920
  v_rcp_f32 v251, v251
  v_mul_f32 v184, v184, v248
  s_waitcnt lgkmcnt(4)
  v_mfma_f32_32x32x16_bf16 v[160:175], v[208:211], v[72:75], v[160:175]
  ds_read_b64_tr_b16 v[208:209], v3 offset:18432
  ds_read_b64_tr_b16 v[210:211], v3 offset:18944
  v_mul_f32 v185, v185, v249
  v_mul_f32 v186, v186, v250
  v_mfma_f32_32x32x16_bf16 v[160:175], v[212:215], v[76:79], v[160:175]
  ds_read_b64_tr_b16 v[212:213], v3 offset:19456
  ds_read_b64_tr_b16 v[214:215], v3 offset:19968
  v_mul_f32 v187, v187, v251
  v_cvt_pk_bf16_f32 v196, v184, v185
  s_waitcnt lgkmcnt(4)
  v_mfma_f32_32x32x16_bf16 v[160:175], v[200:203], v[80:83], v[160:175]
  ds_read_b64_tr_b16 v[200:201], v3 offset:20480
  ds_read_b64_tr_b16 v[202:203], v3 offset:20992
  v_cvt_pk_bf16_f32 v197, v186, v187
  v_mfma_f32_32x32x16_bf16 v[160:175], v[204:207], v[84:87], v[160:175]
  ds_read_b64_tr_b16 v[204:205], v3 offset:21504
  ds_read_b64_tr_b16 v[206:207], v3 offset:22016
  v_mul_f32 v248, v188, v188
  v_mul_f32 v249, v189, v189
  s_waitcnt vmcnt(9)
  s_barrier
  s_waitcnt lgkmcnt(4)
  v_mfma_f32_32x32x16_bf16 v[160:175], v[208:211], v[88:91], v[160:175]
  s_add_u32 m0, s27, 0
  ds_read_b64_tr_b16 v[208:209], v3 offset:22528
  buffer_load_dwordx4 v6, s[12:15], s28 offen offset:0 lds
  ds_read_b64_tr_b16 v[210:211], v3 offset:23040
  v_mul_f32 v250, v190, v190
  v_mul_f32 v251, v191, v191
  v_mfma_f32_32x32x16_bf16 v[160:175], v[212:215], v[92:95], v[160:175]
  ds_read_b64_tr_b16 v[212:213], v3 offset:23552
  ds_read_b64_tr_b16 v[214:215], v3 offset:24064
  v_fma_f32 v248, v248, v8, v7
  v_fma_f32 v249, v249, v8, v7
  s_waitcnt lgkmcnt(4)
  v_mfma_f32_32x32x16_bf16 v[160:175], v[200:203], v[96:99], v[160:175]
  s_add_u32 m0, s27, 960
  ds_read_b64_tr_b16 v[200:201], v3 offset:24576
  buffer_load_dwordx4 v6, s[12:15], s28 offen offset:64 lds
  ds_read_b64_tr_b16 v[202:203], v3 offset:25088
  v_fma_f32 v250, v250, v8, v7
  v_fma_f32 v251, v251, v8, v7
  v_mfma_f32_32x32x16_bf16 v[160:175], v[204:207], v[100:103], v[160:175]
  ds_read_b64_tr_b16 v[204:205], v3 offset:25600
  ds_read_b64_tr_b16 v[206:207], v3 offset:26112
  v_mul_f32 v248, v188, v248
  v_mul_f32 v249, v189, v249
  s_waitcnt lgkmcnt(4)
  v_mfma_f32_32x32x16_bf16 v[160:175], v[208:211], v[104:107], v[160:175]
  s_add_u32 m0, s27, 1920
  ds_read_b64_tr_b16 v[208:209], v3 offset:26624
  buffer_load_dwordx4 v6, s[12:15], s28 offen offset:128 lds
  ds_read_b64_tr_b16 v[210:211], v3 offset:27136
  v_mul_f32 v250, v190, v250
  v_mul_f32 v251, v191, v251
  v_mfma_f32_32x32x16_bf16 v[160:175], v[212:215], v[108:111], v[160:175]
  ds_read_b64_tr_b16 v[212:213], v3 offset:27648
  ds_read_b64_tr_b16 v[214:215], v3 offset:28160
  v_exp_f32 v248, v248
  v_exp_f32 v249, v249
  s_waitcnt lgkmcnt(4)
  v_mfma_f32_32x32x16_bf16 v[160:175], v[200:203], v[112:115], v[160:175]
  s_add_u32 m0, s27, 2880
  ds_read_b64_tr_b16 v[200:201], v3 offset:28672
  buffer_load_dwordx4 v6, s[12:15], s28 offen offset:192 lds
  ds_read_b64_tr_b16 v[202:203], v3 offset:29184
  v_exp_f32 v250, v250
  v_mfma_f32_32x32x16_bf16 v[160:175], v[204:207], v[116:119], v[160:175]
  ds_read_b64_tr_b16 v[204:205], v3 offset:29696
  ds_read_b64_tr_b16 v[206:207], v3 offset:30208
  v_exp_f32 v251, v251
  v_add_f32 v248, 1.0, v248
  s_waitcnt lgkmcnt(4)
  v_mfma_f32_32x32x16_bf16 v[160:175], v[208:211], v[120:123], v[160:175]
  s_add_u32 m0, s27, 3840
  ds_read_b64_tr_b16 v[208:209], v3 offset:30720
  buffer_load_dwordx4 v6, s[12:15], s28 offen offset:256 lds
  ds_read_b64_tr_b16 v[210:211], v3 offset:31232
  v_add_f32 v249, 1.0, v249
  v_add_f32 v250, 1.0, v250
  v_mfma_f32_32x32x16_bf16 v[160:175], v[212:215], v[124:127], v[160:175]
  ds_read_b64_tr_b16 v[212:213], v3 offset:31744
  ds_read_b64_tr_b16 v[214:215], v3 offset:32256
  v_add_f32 v251, 1.0, v251
  v_rcp_f32 v248, v248
  s_waitcnt lgkmcnt(4)
  v_mfma_f32_32x32x16_bf16 v[160:175], v[200:203], v[128:131], v[160:175]
  s_add_u32 m0, s27, 4800
  ds_read_b64_tr_b16 v[200:201], v3 offset:32768
  buffer_load_dwordx4 v6, s[12:15], s28 offen offset:320 lds
  ds_read_b64_tr_b16 v[202:203], v3 offset:33280
  v_rcp_f32 v249, v249
  v_rcp_f32 v250, v250
  v_mfma_f32_32x32x16_bf16 v[160:175], v[204:207], v[132:135], v[160:175]
  ds_read_b64_tr_b16 v[204:205], v3 offset:33792
  ds_read_b64_tr_b16 v[206:207], v3 offset:34304
  v_rcp_f32 v251, v251
  v_mul_f32 v188, v188, v248
  s_waitcnt lgkmcnt(4)
  v_mfma_f32_32x32x16_bf16 v[160:175], v[208:211], v[136:139], v[160:175]
  s_add_u32 m0, s27, 5760
  ds_read_b64_tr_b16 v[208:209], v3 offset:34816
  buffer_load_dwordx4 v6, s[12:15], s28 offen offset:384 lds
  ds_read_b64_tr_b16 v[210:211], v3 offset:35328
  v_mul_f32 v189, v189, v249
  v_mul_f32 v190, v190, v250
  v_mfma_f32_32x32x16_bf16 v[160:175], v[212:215], v[140:143], v[160:175]
  ds_read_b64_tr_b16 v[212:213], v3 offset:35840
  ds_read_b64_tr_b16 v[214:215], v3 offset:36352
  v_mul_f32 v191, v191, v251
  v_cvt_pk_bf16_f32 v198, v188, v189
  s_waitcnt lgkmcnt(4)
  v_mfma_f32_32x32x16_bf16 v[160:175], v[200:203], v[144:147], v[160:175]
  s_add_u32 m0, s27, 6720
  ds_read_b64_tr_b16 v[200:201], v4 offset:0
  buffer_load_dwordx4 v6, s[12:15], s28 offen offset:448 lds
  ds_read_b64_tr_b16 v[202:203], v4 offset:512
  v_cvt_pk_bf16_f32 v199, v190, v191
  v_mfma_f32_32x32x16_bf16 v[160:175], v[204:207], v[148:151], v[160:175]
  ds_read_b64_tr_b16 v[204:205], v4 offset:1024
  ds_read_b64_tr_b16 v[206:207], v4 offset:1536
  v_add_u32 v3, 36864, v2
  s_add_u32 s24, s24, 1
  s_waitcnt lgkmcnt(4)
  v_mfma_f32_32x32x16_bf16 v[160:175], v[208:211], v[152:155], v[160:175]
  s_add_u32 m0, s27, 7680
  ds_read_b64_tr_b16 v[208:209], v4 offset:2048
  buffer_load_dwordx4 v6, s[12:15], s28 offen offset:512 lds
  ds_read_b64_tr_b16 v[210:211], v4 offset:2560
  v_mfma_f32_32x32x16_bf16 v[176:191], v[212:215], v[156:159], v[160:175]
  ds_read_b64_tr_b16 v[212:213], v4 offset:3072
  ds_read_b64_tr_b16 v[214:215], v4 offset:3584
  v_add_u32 v6, 36864, v6
  s_cmp_lt_u32 s24, 16
  s_cbranch_scc1 L_mlp_loop
  v_mov_b32 v4, v10
  s_waitcnt lgkmcnt(4)
  v_mfma_f32_32x32x16_bf16 a[0:15], v[200:203], v[192:195], a[0:15]
  ds_read_b64_tr_b16 v[200:201], v2 offset:4096
  ds_read_b64_tr_b16 v[202:203], v2 offset:4608
  v_mfma_f32_32x32x16_bf16 a[16:31], v[204:207], v[192:195], a[16:31]
  ds_read_b64_tr_b16 v[204:205], v2 offset:5120
  ds_read_b64_tr_b16 v[206:207], v2 offset:5632
  s_waitcnt lgkmcnt(4)
  v_mfma_f32_32x32x16_bf16 a[32:47], v[208:211], v[192:195], a[32:47]
  ds_read_b64_tr_b16 v[208:209], v2 offset:6144
  ds_read_b64_tr_b16 v[210:211], v2 offset:6656
  v_mul_f32 v248, v176, v176
  v_mul_f32 v249, v177, v177
  v_mul_f32 v250, v178, v178
  v_mul_f32 v251, v179, v179
  v_mfma_f32_32x32x16_bf16 a[48:63], v[212:215], v[192:195], a[48:63]
  ds_read_b64_tr_b16 v[212:213], v2 offset:7168
  ds_read_b64_tr_b16 v[214:215], v2 offset:7680
  v_fma_f32 v248, v248, v8, v7
  v_fma_f32 v249, v249, v8, v7
  v_fma_f32 v250, v250, v8, v7
  v_fma_f32 v251, v251, v8, v7
  s_waitcnt lgkmcnt(4)
  v_mfma_f32_32x32x16_bf16 a[64:79], v[200:203], v[192:195], a[64:79]
  ds_read_b64_tr_b16 v[200:201], v2 offset:8192
  ds_read_b64_tr_b16 v[202:203], v2 offset:8704
  v_mul_f32 v248, v176, v248
  v_mul_f32 v249, v177, v249
  v_mul_f32 v250, v178, v250
  v_mfma_f32_32x32x16_bf16 a[80:95], v[204:207], v[192:195], a[80:95]
  ds_read_b64_tr_b16 v[204:205], v2 offset:9216
  ds_read_b64_tr_b16 v[206:207], v2 offset:9728
  v_mul_f32 v251, v179, v251
  v_exp_f32 v248, v248
  v_exp_f32 v249, v249
  v_exp_f32 v250, v250
  s_waitcnt lgkmcnt(4)
  v_mfma_f32_32x32x16_bf16 a[96:111], v[208:211], v[192:195], a[96:111]
  ds_read_b64_tr_b16 v[208:209], v2 offset:10240
  ds_read_b64_tr_b16 v[210:211], v2 offset:10752
  v_exp_f32 v251, v251
  v_add_f32 v248, 1.0, v248
  v_add_f32 v249, 1.0, v249
  v_mfma_f32_32x32x16_bf16 a[112:127], v[212:215], v[192:195], a[112:127]
  ds_read_b64_tr_b16 v[212:213], v2 offset:11264
  ds_read_b64_tr_b16 v[214:215], v2 offset:11776
  v_add_f32 v250, 1.0, v250
  v_add_f32 v251, 1.0, v251
  v_rcp_f32 v248, v248
  v_rcp_f32 v249, v249
  s_waitcnt lgkmcnt(4)
  v_mfma_f32_32x32x16_bf16 a[128:143], v[200:203], v[192:195], a[128:143]
  ds_read_b64_tr_b16 v[200:201], v2 offset:12288
  ds_read_b64_tr_b16 v[202:203], v2 offset:12800
  v_rcp_f32 v250, v250
  v_rcp_f32 v251, v251
  v_mul_f32 v176, v176, v248
  v_mfma_f32_32x32x16_bf16 a[144:159], v[204:207], v[192:195], a[144:159]
  ds_read_b64_tr_b16 v[204:205], v2 offset:13312
  ds_read_b64_tr_b16 v[206:207], v2 offset:13824
  v_mul_f32 v177, v177, v249
  v_mul_f32 v178, v178, v250
  v_mul_f32 v179, v179, v251
  v_cvt_pk_bf16_f32 v152, v176, v177
  s_waitcnt lgkmcnt(4)
  v_mfma_f32_32x32x16_bf16 a[160:175], v[208:211], v[192:195], a[160:175]
  ds_read_b64_tr_b16 v[208:209], v2 offset:14336
  ds_read_b64_tr_b16 v[210:211], v2 offset:14848
  v_cvt_pk_bf16_f32 v153, v178, v179
  v_mul_f32 v248, v180, v180
  v_mul_f32 v249, v181, v181
  v_mfma_f32_32x32x16_bf16 a[176:191], v[212:215], v[192:195], a[176:191]
  ds_read_b64_tr_b16 v[212:213], v2 offset:15360
  ds_read_b64_tr_b16 v[214:215], v2 offset:15872
  v_mul_f32 v250, v182, v182
  v_mul_f32 v251, v183, v183
  v_fma_f32 v248, v248, v8, v7
  v_fma_f32 v249, v249, v8, v7
  s_waitcnt lgkmcnt(4)
  v_mfma_f32_32x32x16_bf16 a[192:207], v[200:203], v[192:195], a[192:207]
  ds_read_b64_tr_b16 v[200:201], v2 offset:16384
  ds_read_b64_tr_b16 v[202:203], v2 offset:16896
  v_fma_f32 v250, v250, v8, v7
  v_fma_f32 v251, v251, v8, v7
  v_mul_f32 v248, v180, v248
  v_mfma_f32_32x32x16_bf16 a[208:223], v[204:207], v[192:195], a[208:223]
  ds_read_b64_tr_b16 v[204:205], v2 offset:17408
  ds_read_b64_tr_b16 v[206:207], v2 offset:17920
  v_mul_f32 v249, v181, v249
  v_mul_f32 v250, v182, v250
  v_mul_f32 v251, v183, v251
  v_exp_f32 v248, v248
  s_waitcnt lgkmcnt(4)
  v_mfma_f32_32x32x16_bf16 a[224:239], v[208:211], v[192:195], a[224:239]
  ds_read_b64_tr_b16 v[208:209], v2 offset:18432
  ds_read_b64_tr_b16 v[210:211], v2 offset:18944
  v_exp_f32 v249, v249
  v_exp_f32 v250, v250
  v_exp_f32 v251, v251
  v_mfma_f32_32x32x16_bf16 a[240:255], v[212:215], v[192:195], a[240:255]
  ds_read_b64_tr_b16 v[212:213], v2 offset:19456
  ds_read_b64_tr_b16 v[214:215], v2 offset:19968
  v_add_f32 v248, 1.0, v248
  v_add_f32 v249, 1.0, v249
  v_add_f32 v250, 1.0, v250
  v_add_f32 v251, 1.0, v251
  s_waitcnt lgkmcnt(4)
  v_mfma_f32_32x32x16_bf16 v[216:231], v[200:203], v[192:195], v[216:231]
  ds_read_b64_tr_b16 v[200:201], v2 offset:20480
  ds_read_b64_tr_b16 v[202:203], v2 offset:20992
  v_rcp_f32 v248, v248
  v_rcp_f32 v249, v249
  v_rcp_f32 v250, v250
  v_mfma_f32_32x32x16_bf16 v[232:247], v[204:207], v[192:195], v[232:247]
  ds_read_b64_tr_b16 v[204:205], v2 offset:21504
  ds_read_b64_tr_b16 v[206:207], v2 offset:22016
  v_rcp_f32 v251, v251
  v_mul_f32 v180, v180, v248
  v_mul_f32 v181, v181, v249
  v_mul_f32 v182, v182, v250
  s_waitcnt vmcnt(0)
  s_barrier
  s_waitcnt lgkmcnt(4)
  v_mfma_f32_32x32x16_bf16 a[0:15], v[208:211], v[196:199], a[0:15]
  ds_read_b64_tr_b16 v[208:209], v2 offset:22528
  ds_read_b64_tr_b16 v[210:211], v2 offset:23040
  v_mul_f32 v183, v183, v251
  v_cvt_pk_bf16_f32 v154, v180, v181
  v_cvt_pk_bf16_f32 v155, v182, v183
  v_mfma_f32_32x32x16_bf16 a[16:31], v[212:215], v[196:199], a[16:31]
  ds_read_b64_tr_b16 v[212:213], v2 offset:23552
  ds_read_b64_tr_b16 v[214:215], v2 offset:24064
  v_mul_f32 v248, v184, v184
  v_mul_f32 v249, v185, v185
  v_mul_f32 v250, v186, v186
  v_mul_f32 v251, v187, v187
  s_waitcnt lgkmcnt(4)
  v_mfma_f32_32x32x16_bf16 a[32:47], v[200:203], v[196:199], a[32:47]
  ds_read_b64_tr_b16 v[200:201], v2 offset:24576
  ds_read_b64_tr_b16 v[202:203], v2 offset:25088
  v_fma_f32 v248, v248, v8, v7
  v_fma_f32 v249, v249, v8, v7
  v_fma_f32 v250, v250, v8, v7
  v_fma_f32 v251, v251, v8, v7
  v_mfma_f32_32x32x16_bf16 a[48:63], v[204:207], v[196:199], a[48:63]
  ds_read_b64_tr_b16 v[204:205], v2 offset:25600
  ds_read_b64_tr_b16 v[206:207], v2 offset:26112
  v_mul_f32 v248, v184, v248
  v_mul_f32 v249, v185, v249
  v_mul_f32 v250, v186, v250
  s_waitcnt lgkmcnt(4)
  v_mfma_f32_32x32x16_bf16 a[64:79], v[208:211], v[196:199], a[64:79]
  ds_read_b64_tr_b16 v[208:209], v2 offset:26624
  ds_read_b64_tr_b16 v[210:211], v2 offset:27136
  v_mul_f32 v251, v187, v251
  v_exp_f32 v248, v248
  v_exp_f32 v249, v249
  v_exp_f32 v250, v250
  v_mfma_f32_32x32x16_bf16 a[80:95], v[212:215], v[196:199], a[80:95]
  ds_read_b64_tr_b16 v[212:213], v2 offset:27648
  ds_read_b64_tr_b16 v[214:215], v2 offset:28160
  v_exp_f32 v251, v251
  v_add_f32 v248, 1.0, v248
  v_add_f32 v249, 1.0, v249
  s_waitcnt lgkmcnt(4)
  v_mfma_f32_32x32x16_bf16 a[96:111], v[200:203], v[196:199], a[96:111]
  ds_read_b64_tr_b16 v[200:201], v2 offset:28672
  ds_read_b64_tr_b16 v[202:203], v2 offset:29184
  v_add_f32 v250, 1.0, v250
  v_add_f32 v251, 1.0, v251
  v_rcp_f32 v248, v248
  v_rcp_f32 v249, v249
  v_mfma_f32_32x32x16_bf16 a[112:127], v[204:207], v[196:199], a[112:127]
  ds_read_b64_tr_b16 v[204:205], v2 offset:29696
  ds_read_b64_tr_b16 v[206:207], v2 offset:30208
  v_rcp_f32 v250, v250
  v_rcp_f32 v251, v251
  v_mul_f32 v184, v184, v248
  s_waitcnt lgkmcnt(4)
  v_mfma_f32_32x32x16_bf16 a[128:143], v[208:211], v[196:199], a[128:143]
  ds_read_b64_tr_b16 v[208:209], v2 offset:30720
  ds_read_b64_tr_b16 v[210:211], v2 offset:31232
  v_mul_f32 v185, v185, v249
  v_mul_f32 v186, v186, v250
  v_mul_f32 v187, v187, v251
  v_cvt_pk_bf16_f32 v156, v184, v185
  v_mfma_f32_32x32x16_bf16 a[144:159], v[212:215], v[196:199], a[144:159]
  ds_read_b64_tr_b16 v[212:213], v2 offset:31744
  ds_read_b64_tr_b16 v[214:215], v2 offset:32256
  v_cvt_pk_bf16_f32 v157, v186, v187
  v_mul_f32 v248, v188, v188
  v_mul_f32 v249, v189, v189
  s_waitcnt lgkmcnt(4)
  v_mfma_f32_32x32x16_bf16 a[160:175], v[200:203], v[196:199], a[160:175]
  ds_read_b64_tr_b16 v[200:201], v2 offset:32768
  ds_read_b64_tr_b16 v[202:203], v2 offset:33280
  v_mul_f32 v250, v190, v190
  v_mul_f32 v251, v191, v191
  v_fma_f32 v248, v248, v8, v7
  v_fma_f32 v249, v249, v8, v7
  v_mfma_f32_32x32x16_bf16 a[176:191], v[204:207], v[196:199], a[176:191]
  ds_read_b64_tr_b16 v[204:205], v2 offset:33792
  ds_read_b64_tr_b16 v[206:207], v2 offset:34304
  v_fma_f32 v250, v250, v8, v7
  v_fma_f32 v251, v251, v8, v7
  v_mul_f32 v248, v188, v248
  s_waitcnt lgkmcnt(4)
  v_mfma_f32_32x32x16_bf16 a[192:207], v[208:211], v[196:199], a[192:207]
  ds_read_b64_tr_b16 v[208:209], v2 offset:34816
  ds_read_b64_tr_b16 v[210:211], v2 offset:35328
  v_mul_f32 v249, v189, v249
  v_mul_f32 v250, v190, v250
  v_mul_f32 v251, v191, v251
  v_exp_f32 v248, v248
  v_mfma_f32_32x32x16_bf16 a[208:223], v[212:215], v[196:199], a[208:223]
  ds_read_b64_tr_b16 v[212:213], v2 offset:35840
  ds_read_b64_tr_b16 v[214:215], v2 offset:36352
  v_exp_f32 v249, v249
  v_exp_f32 v250, v250
  v_exp_f32 v251, v251
  s_waitcnt lgkmcnt(4)
  v_mfma_f32_32x32x16_bf16 a[224:239], v[200:203], v[196:199], a[224:239]
  ds_read_b64_tr_b16 v[200:201], v4 offset:0
  ds_read_b64_tr_b16 v[202:203], v4 offset:512
  v_add_f32 v248, 1.0, v248
  v_add_f32 v249, 1.0, v249
  v_add_f32 v250, 1.0, v250
  v_add_f32 v251, 1.0, v251
  v_mfma_f32_32x32x16_bf16 a[240:255], v[204:207], v[196:199], a[240:255]
  ds_read_b64_tr_b16 v[204:205], v4 offset:18432
  ds_read_b64_tr_b16 v[206:207], v4 offset:18944
  v_rcp_f32 v248, v248
  v_rcp_f32 v249, v249
  v_rcp_f32 v250, v250
  s_waitcnt lgkmcnt(4)
  v_mfma_f32_32x32x16_bf16 v[216:231], v[208:211], v[196:199], v[216:231]
  ds_read_b64_tr_b16 v[208:209], v4 offset:1024
  ds_read_b64_tr_b16 v[210:211], v4 offset:1536
  v_rcp_f32 v251, v251
  v_mul_f32 v188, v188, v248
  v_mul_f32 v189, v189, v249
  v_mul_f32 v190, v190, v250
  v_mfma_f32_32x32x16_bf16 v[232:247], v[212:215], v[196:199], v[232:247]
  ds_read_b64_tr_b16 v[212:213], v4 offset:19456
  ds_read_b64_tr_b16 v[214:215], v4 offset:19968
  v_mul_f32 v191, v191, v251
  v_cvt_pk_bf16_f32 v158, v188, v189
  v_cvt_pk_bf16_f32 v159, v190, v191
  s_mul_i32 s30, s22, 36864
  s_mul_i32 s23, s21, 2359296
  s_add_u32 s30, s30, s23
  s_mul_i32 s23, s22, 6
  s_add_u32 s23, s23, 128
  s_lshl_b32 s23, s23, 7
  v_mov_b32 v10, s23
  v_mov_b32 v11, 0x40000000
  v_cmp_eq_u32 vcc, 0, v1
  s_nop 1
  v_cndmask_b32 v10, v11, v10, vcc
  v_mov_b32 v11, 1
  s_waitcnt lgkmcnt(6)
  v_mfma_f32_32x32x16_bf16 a[0:15], v[200:203], v[152:155], a[0:15]
  ds_read_b64_tr_b16 v[200:201], v4 offset:2048
  ds_read_b64_tr_b16 v[202:203], v4 offset:2560
  s_waitcnt lgkmcnt(6)
  v_mfma_f32_32x32x16_bf16 a[0:15], v[204:207], v[156:159], a[0:15]
  ds_read_b64_tr_b16 v[204:205], v4 offset:20480
  ds_read_b64_tr_b16 v[206:207], v4 offset:20992
  s_waitcnt lgkmcnt(6)
  v_mfma_f32_32x32x16_bf16 a[16:31], v[208:211], v[152:155], a[16:31]
  ds_read_b64_tr_b16 v[208:209], v4 offset:3072
  ds_read_b64_tr_b16 v[210:211], v4 offset:3584
  s_waitcnt lgkmcnt(6)
  v_mfma_f32_32x32x16_bf16 a[16:31], v[212:215], v[156:159], a[16:31]
  ds_read_b64_tr_b16 v[212:213], v4 offset:21504
  ds_read_b64_tr_b16 v[214:215], v4 offset:22016
  s_waitcnt lgkmcnt(6)
  v_mfma_f32_32x32x16_bf16 a[32:47], v[200:203], v[152:155], a[32:47]
  ds_read_b64_tr_b16 v[200:201], v4 offset:4096
  ds_read_b64_tr_b16 v[202:203], v4 offset:4608
  v_accvgpr_read_b32 v16, a0
  v_accvgpr_read_b32 v17, a1
  v_accvgpr_read_b32 v18, a2
  v_accvgpr_read_b32 v19, a3
  v_accvgpr_read_b32 v20, a4
  v_accvgpr_read_b32 v21, a5
  v_accvgpr_read_b32 v22, a6
  v_accvgpr_read_b32 v23, a7
  v_accvgpr_read_b32 v24, a8
  v_accvgpr_read_b32 v25, a9
  v_accvgpr_read_b32 v26, a10
  v_accvgpr_read_b32 v27, a11
  v_accvgpr_read_b32 v28, a12
  v_accvgpr_read_b32 v29, a13
  s_waitcnt lgkmcnt(6)
  v_mfma_f32_32x32x16_bf16 a[32:47], v[204:207], v[156:159], a[32:47]
  ds_read_b64_tr_b16 v[204:205], v4 offset:22528
  ds_read_b64_tr_b16 v[206:207], v4 offset:23040
  v_accvgpr_read_b32 v30, a14
  v_accvgpr_read_b32 v31, a15
  v_cvt_pk_bf16_f32 v16, v16, v17
  v_cvt_pk_bf16_f32 v17, v18, v19
  v_cvt_pk_bf16_f32 v18, v20, v21
  v_cvt_pk_bf16_f32 v19, v22, v23
  v_cvt_pk_bf16_f32 v20, v24, v25
  v_cvt_pk_bf16_f32 v21, v26, v27
  v_cvt_pk_bf16_f32 v22, v28, v29
  v_cvt_pk_bf16_f32 v23, v30, v31
  s_add_u32 s23, s30, 0
  buffer_store_dwordx4 v[16:19], v9, s[16:19], s23 offen sc1
  buffer_store_dwordx4 v[20:23], v9, s[16:19], s23 offen offset:1024 sc1
  s_waitcnt lgkmcnt(6)
  v_mfma_f32_32x32x16_bf16 a[48:63], v[208:211], v[152:155], a[48:63]
  ds_read_b64_tr_b16 v[208:209], v4 offset:5120
  ds_read_b64_tr_b16 v[210:211], v4 offset:5632
  v_accvgpr_read_b32 v32, a16
  v_accvgpr_read_b32 v33, a17
  v_accvgpr_read_b32 v34, a18
  v_accvgpr_read_b32 v35, a19
  v_accvgpr_read_b32 v36, a20
  v_accvgpr_read_b32 v37, a21
  v_accvgpr_read_b32 v38, a22
  v_accvgpr_read_b32 v39, a23
  v_accvgpr_read_b32 v40, a24
  v_accvgpr_read_b32 v41, a25
  v_accvgpr_read_b32 v42, a26
  v_accvgpr_read_b32 v43, a27
  v_accvgpr_read_b32 v44, a28
  v_accvgpr_read_b32 v45, a29
  s_waitcnt lgkmcnt(6)
  v_mfma_f32_32x32x16_bf16 a[48:63], v[212:215], v[156:159], a[48:63]
  ds_read_b64_tr_b16 v[212:213], v4 offset:23552
  ds_read_b64_tr_b16 v[214:215], v4 offset:24064
  v_accvgpr_read_b32 v46, a30
  v_accvgpr_read_b32 v47, a31
  v_cvt_pk_bf16_f32 v32, v32, v33
  v_cvt_pk_bf16_f32 v33, v34, v35
  v_cvt_pk_bf16_f32 v34, v36, v37
  v_cvt_pk_bf16_f32 v35, v38, v39
  v_cvt_pk_bf16_f32 v36, v40, v41
  v_cvt_pk_bf16_f32 v37, v42, v43
  v_cvt_pk_bf16_f32 v38, v44, v45
  v_cvt_pk_bf16_f32 v39, v46, v47
  s_add_u32 s23, s30, 2048
  buffer_store_dwordx4 v[32:35], v9, s[16:19], s23 offen sc1
  buffer_store_dwordx4 v[36:39], v9, s[16:19], s23 offen offset:1024 sc1
  s_waitcnt lgkmcnt(6)
  v_mfma_f32_32x32x16_bf16 a[64:79], v[200:203], v[152:155], a[64:79]
  ds_read_b64_tr_b16 v[200:201], v4 offset:6144
  ds_read_b64_tr_b16 v[202:203], v4 offset:6656
  v_accvgpr_read_b32 v48, a32
  v_accvgpr_read_b32 v49, a33
  v_accvgpr_read_b32 v50, a34
  v_accvgpr_read_b32 v51, a35
  v_accvgpr_read_b32 v52, a36
  v_accvgpr_read_b32 v53, a37
  v_accvgpr_read_b32 v54, a38
  v_accvgpr_read_b32 v55, a39
  v_accvgpr_read_b32 v56, a40
  v_accvgpr_read_b32 v57, a41
  v_accvgpr_read_b32 v58, a42
  v_accvgpr_read_b32 v59, a43
  v_accvgpr_read_b32 v60, a44
  v_accvgpr_read_b32 v61, a45
  s_waitcnt lgkmcnt(6)
  v_mfma_f32_32x32x16_bf16 a[64:79], v[204:207], v[156:159], a[64:79]
  ds_read_b64_tr_b16 v[204:205], v4 offset:24576
  ds_read_b64_tr_b16 v[206:207], v4 offset:25088
  v_accvgpr_read_b32 v62, a46
  v_accvgpr_read_b32 v63, a47
  v_cvt_pk_bf16_f32 v48, v48, v49
  v_cvt_pk_bf16_f32 v49, v50, v51
  v_cvt_pk_bf16_f32 v50, v52, v53
  v_cvt_pk_bf16_f32 v51, v54, v55
  v_cvt_pk_bf16_f32 v52, v56, v57
  v_cvt_pk_bf16_f32 v53, v58, v59
  v_cvt_pk_bf16_f32 v54, v60, v61
  v_cvt_pk_bf16_f32 v55, v62, v63
  s_add_u32 s23, s30, 4096
  buffer_store_dwordx4 v[48:51], v9, s[16:19], s23 offen sc1
  buffer_store_dwordx4 v[52:55], v9, s[16:19], s23 offen offset:1024 sc1
  s_waitcnt lgkmcnt(6)
  v_mfma_f32_32x32x16_bf16 a[80:95], v[208:211], v[152:155], a[80:95]
  ds_read_b64_tr_b16 v[208:209], v4 offset:7168
  ds_read_b64_tr_b16 v[210:211], v4 offset:7680
  v_accvgpr_read_b32 v64, a48
  v_accvgpr_read_b32 v65, a49
  v_accvgpr_read_b32 v66, a50
  v_accvgpr_read_b32 v67, a51
  v_accvgpr_read_b32 v68, a52
  v_accvgpr_read_b32 v69, a53
  v_accvgpr_read_b32 v70, a54
  v_accvgpr_read_b32 v71, a55
  v_accvgpr_read_b32 v72, a56
  v_accvgpr_read_b32 v73, a57
  v_accvgpr_read_b32 v74, a58
  v_accvgpr_read_b32 v75, a59
  v_accvgpr_read_b32 v76, a60
  v_accvgpr_read_b32 v77, a61
  s_waitcnt lgkmcnt(6)
  v_mfma_f32_32x32x16_bf16 a[80:95], v[212:215], v[156:159], a[80:95]
  ds_read_b64_tr_b16 v[212:213], v4 offset:25600
  ds_read_b64_tr_b16 v[214:215], v4 offset:26112
  v_accvgpr_read_b32 v78, a62
  v_accvgpr_read_b32 v79, a63
  v_cvt_pk_bf16_f32 v64, v64, v65
  v_cvt_pk_bf16_f32 v65, v66, v67
  v_cvt_pk_bf16_f32 v66, v68, v69
  v_cvt_pk_bf16_f32 v67, v70, v71
  v_cvt_pk_bf16_f32 v68, v72, v73
  v_cvt_pk_bf16_f32 v69, v74, v75
  v_cvt_pk_bf16_f32 v70, v76, v77
  v_cvt_pk_bf16_f32 v71, v78, v79
  s_add_u32 s23, s30, 6144
  buffer_store_dwordx4 v[64:67], v9, s[16:19], s23 offen sc1
  buffer_store_dwordx4 v[68:71], v9, s[16:19], s23 offen offset:1024 sc1
  s_waitcnt lgkmcnt(6)
  v_mfma_f32_32x32x16_bf16 a[96:111], v[200:203], v[152:155], a[96:111]
  ds_read_b64_tr_b16 v[200:201], v4 offset:8192
  ds_read_b64_tr_b16 v[202:203], v4 offset:8704
  v_accvgpr_read_b32 v80, a64
  v_accvgpr_read_b32 v81, a65
  v_accvgpr_read_b32 v82, a66
  v_accvgpr_read_b32 v83, a67
  v_accvgpr_read_b32 v84, a68
  v_accvgpr_read_b32 v85, a69
  v_accvgpr_read_b32 v86, a70
  v_accvgpr_read_b32 v87, a71
  v_accvgpr_read_b32 v88, a72
  v_accvgpr_read_b32 v89, a73
  v_accvgpr_read_b32 v90, a74
  v_accvgpr_read_b32 v91, a75
  v_accvgpr_read_b32 v92, a76
  v_accvgpr_read_b32 v93, a77
  s_waitcnt lgkmcnt(6)
  v_mfma_f32_32x32x16_bf16 a[96:111], v[204:207], v[156:159], a[96:111]
  ds_read_b64_tr_b16 v[204:205], v4 offset:26624
  ds_read_b64_tr_b16 v[206:207], v4 offset:27136
  v_accvgpr_read_b32 v94, a78
  v_accvgpr_read_b32 v95, a79
  v_cvt_pk_bf16_f32 v80, v80, v81
  v_cvt_pk_bf16_f32 v81, v82, v83
  v_cvt_pk_bf16_f32 v82, v84, v85
  v_cvt_pk_bf16_f32 v83, v86, v87
  v_cvt_pk_bf16_f32 v84, v88, v89
  v_cvt_pk_bf16_f32 v85, v90, v91
  v_cvt_pk_bf16_f32 v86, v92, v93
  v_cvt_pk_bf16_f32 v87, v94, v95
  s_add_u32 s23, s30, 8192
  buffer_store_dwordx4 v[80:83], v9, s[16:19], s23 offen sc1
  buffer_store_dwordx4 v[84:87], v9, s[16:19], s23 offen offset:1024 sc1
  s_waitcnt lgkmcnt(6)
  v_mfma_f32_32x32x16_bf16 a[112:127], v[208:211], v[152:155], a[112:127]
  ds_read_b64_tr_b16 v[208:209], v4 offset:9216
  ds_read_b64_tr_b16 v[210:211], v4 offset:9728
  v_accvgpr_read_b32 v96, a80
  v_accvgpr_read_b32 v97, a81
  v_accvgpr_read_b32 v98, a82
  v_accvgpr_read_b32 v99, a83
  v_accvgpr_read_b32 v100, a84
  v_accvgpr_read_b32 v101, a85
  v_accvgpr_read_b32 v102, a86
  v_accvgpr_read_b32 v103, a87
  v_accvgpr_read_b32 v104, a88
  v_accvgpr_read_b32 v105, a89
  v_accvgpr_read_b32 v106, a90
  v_accvgpr_read_b32 v107, a91
  v_accvgpr_read_b32 v108, a92
  v_accvgpr_read_b32 v109, a93
  s_waitcnt lgkmcnt(6)
  v_mfma_f32_32x32x16_bf16 a[112:127], v[212:215], v[156:159], a[112:127]
  ds_read_b64_tr_b16 v[212:213], v4 offset:27648
  ds_read_b64_tr_b16 v[214:215], v4 offset:28160
  v_accvgpr_read_b32 v110, a94
  v_accvgpr_read_b32 v111, a95
  v_cvt_pk_bf16_f32 v96, v96, v97
  v_cvt_pk_bf16_f32 v97, v98, v99
  v_cvt_pk_bf16_f32 v98, v100, v101
  v_cvt_pk_bf16_f32 v99, v102, v103
  v_cvt_pk_bf16_f32 v100, v104, v105
  v_cvt_pk_bf16_f32 v101, v106, v107
  v_cvt_pk_bf16_f32 v102, v108, v109
  v_cvt_pk_bf16_f32 v103, v110, v111
  s_add_u32 s23, s30, 10240
  buffer_store_dwordx4 v[96:99], v9, s[16:19], s23 offen sc1
  buffer_store_dwordx4 v[100:103], v9, s[16:19], s23 offen offset:1024 sc1
  s_waitcnt lgkmcnt(6)
  v_mfma_f32_32x32x16_bf16 a[128:143], v[200:203], v[152:155], a[128:143]
  ds_read_b64_tr_b16 v[200:201], v4 offset:10240
  ds_read_b64_tr_b16 v[202:203], v4 offset:10752
  v_accvgpr_read_b32 v112, a96
  v_accvgpr_read_b32 v113, a97
  v_accvgpr_read_b32 v114, a98
  v_accvgpr_read_b32 v115, a99
  v_accvgpr_read_b32 v116, a100
  v_accvgpr_read_b32 v117, a101
  v_accvgpr_read_b32 v118, a102
  v_accvgpr_read_b32 v119, a103
  v_accvgpr_read_b32 v120, a104
  v_accvgpr_read_b32 v121, a105
  v_accvgpr_read_b32 v122, a106
  v_accvgpr_read_b32 v123, a107
  v_accvgpr_read_b32 v124, a108
  v_accvgpr_read_b32 v125, a109
  s_waitcnt lgkmcnt(6)
  v_mfma_f32_32x32x16_bf16 a[128:143], v[204:207], v[156:159], a[128:143]
  ds_read_b64_tr_b16 v[204:205], v4 offset:28672
  ds_read_b64_tr_b16 v[206:207], v4 offset:29184
  v_accvgpr_read_b32 v126, a110
  v_accvgpr_read_b32 v127, a111
  v_cvt_pk_bf16_f32 v112, v112, v113
  v_cvt_pk_bf16_f32 v113, v114, v115
  v_cvt_pk_bf16_f32 v114, v116, v117
  v_cvt_pk_bf16_f32 v115, v118, v119
  v_cvt_pk_bf16_f32 v116, v120, v121
  v_cvt_pk_bf16_f32 v117, v122, v123
  v_cvt_pk_bf16_f32 v118, v124, v125
  v_cvt_pk_bf16_f32 v119, v126, v127
  s_add_u32 s23, s30, 12288
  buffer_store_dwordx4 v[112:115], v9, s[16:19], s23 offen sc1
  buffer_store_dwordx4 v[116:119], v9, s[16:19], s23 offen offset:1024 sc1
  s_waitcnt lgkmcnt(6)
  v_mfma_f32_32x32x16_bf16 a[144:159], v[208:211], v[152:155], a[144:159]
  ds_read_b64_tr_b16 v[208:209], v4 offset:11264
  ds_read_b64_tr_b16 v[210:211], v4 offset:11776
  v_accvgpr_read_b32 v128, a112
  v_accvgpr_read_b32 v129, a113
  v_accvgpr_read_b32 v130, a114
  v_accvgpr_read_b32 v131, a115
  v_accvgpr_read_b32 v132, a116
  v_accvgpr_read_b32 v133, a117
  v_accvgpr_read_b32 v134, a118
  v_accvgpr_read_b32 v135, a119
  v_accvgpr_read_b32 v136, a120
  v_accvgpr_read_b32 v137, a121
  v_accvgpr_read_b32 v138, a122
  v_accvgpr_read_b32 v139, a123
  v_accvgpr_read_b32 v140, a124
  v_accvgpr_read_b32 v141, a125
  s_waitcnt lgkmcnt(6)
  v_mfma_f32_32x32x16_bf16 a[144:159], v[212:215], v[156:159], a[144:159]
  ds_read_b64_tr_b16 v[212:213], v4 offset:29696
  ds_read_b64_tr_b16 v[214:215], v4 offset:30208
  v_accvgpr_read_b32 v142, a126
  v_accvgpr_read_b32 v143, a127
  v_cvt_pk_bf16_f32 v128, v128, v129
  v_cvt_pk_bf16_f32 v129, v130, v131
  v_cvt_pk_bf16_f32 v130, v132, v133
  v_cvt_pk_bf16_f32 v131, v134, v135
  v_cvt_pk_bf16_f32 v132, v136, v137
  v_cvt_pk_bf16_f32 v133, v138, v139
  v_cvt_pk_bf16_f32 v134, v140, v141
  v_cvt_pk_bf16_f32 v135, v142, v143
  s_add_u32 s23, s30, 14336
  buffer_store_dwordx4 v[128:131], v9, s[16:19], s23 offen sc1
  buffer_store_dwordx4 v[132:135], v9, s[16:19], s23 offen offset:1024 sc1
  s_waitcnt lgkmcnt(6)
  v_mfma_f32_32x32x16_bf16 a[160:175], v[200:203], v[152:155], a[160:175]
  ds_read_b64_tr_b16 v[200:201], v4 offset:12288
  ds_read_b64_tr_b16 v[202:203], v4 offset:12800
  v_accvgpr_read_b32 v16, a128
  v_accvgpr_read_b32 v17, a129
  v_accvgpr_read_b32 v18, a130
  v_accvgpr_read_b32 v19, a131
  v_accvgpr_read_b32 v20, a132
  v_accvgpr_read_b32 v21, a133
  v_accvgpr_read_b32 v22, a134
  v_accvgpr_read_b32 v23, a135
  v_accvgpr_read_b32 v24, a136
  v_accvgpr_read_b32 v25, a137
  v_accvgpr_read_b32 v26, a138
  v_accvgpr_read_b32 v27, a139
  v_accvgpr_read_b32 v28, a140
  v_accvgpr_read_b32 v29, a141
  s_waitcnt lgkmcnt(6)
  v_mfma_f32_32x32x16_bf16 a[160:175], v[204:207], v[156:159], a[160:175]
  ds_read_b64_tr_b16 v[204:205], v4 offset:30720
  ds_read_b64_tr_b16 v[206:207], v4 offset:31232
  v_accvgpr_read_b32 v30, a142
  v_accvgpr_read_b32 v31, a143
  v_cvt_pk_bf16_f32 v16, v16, v17
  v_cvt_pk_bf16_f32 v17, v18, v19
  v_cvt_pk_bf16_f32 v18, v20, v21
  v_cvt_pk_bf16_f32 v19, v22, v23
  v_cvt_pk_bf16_f32 v20, v24, v25
  v_cvt_pk_bf16_f32 v21, v26, v27
  v_cvt_pk_bf16_f32 v22, v28, v29
  v_cvt_pk_bf16_f32 v23, v30, v31
  s_add_u32 s23, s30, 16384
  buffer_store_dwordx4 v[16:19], v9, s[16:19], s23 offen sc1
  buffer_store_dwordx4 v[20:23], v9, s[16:19], s23 offen offset:1024 sc1
  s_waitcnt lgkmcnt(6)
  v_mfma_f32_32x32x16_bf16 a[176:191], v[208:211], v[152:155], a[176:191]
  ds_read_b64_tr_b16 v[208:209], v4 offset:13312
  ds_read_b64_tr_b16 v[210:211], v4 offset:13824
  v_accvgpr_read_b32 v32, a144
  v_accvgpr_read_b32 v33, a145
  v_accvgpr_read_b32 v34, a146
  v_accvgpr_read_b32 v35, a147
  v_accvgpr_read_b32 v36, a148
  v_accvgpr_read_b32 v37, a149
  v_accvgpr_read_b32 v38, a150
  v_accvgpr_read_b32 v39, a151
  v_accvgpr_read_b32 v40, a152
  v_accvgpr_read_b32 v41, a153
  v_accvgpr_read_b32 v42, a154
  v_accvgpr_read_b32 v43, a155
  v_accvgpr_read_b32 v44, a156
  v_accvgpr_read_b32 v45, a157
  s_waitcnt lgkmcnt(6)
  v_mfma_f32_32x32x16_bf16 a[176:191], v[212:215], v[156:159], a[176:191]
  ds_read_b64_tr_b16 v[212:213], v4 offset:31744
  ds_read_b64_tr_b16 v[214:215], v4 offset:32256
  v_accvgpr_read_b32 v46, a158
  v_accvgpr_read_b32 v47, a159
  v_cvt_pk_bf16_f32 v32, v32, v33
  v_cvt_pk_bf16_f32 v33, v34, v35
  v_cvt_pk_bf16_f32 v34, v36, v37
  v_cvt_pk_bf16_f32 v35, v38, v39
  v_cvt_pk_bf16_f32 v36, v40, v41
  v_cvt_pk_bf16_f32 v37, v42, v43
  v_cvt_pk_bf16_f32 v38, v44, v45
  v_cvt_pk_bf16_f32 v39, v46, v47
  s_add_u32 s23, s30, 18432
  buffer_store_dwordx4 v[32:35], v9, s[16:19], s23 offen sc1
  buffer_store_dwordx4 v[36:39], v9, s[16:19], s23 offen offset:1024 sc1
  s_waitcnt vmcnt(14)
  buffer_atomic_add v11, v10, s[72:75], 0 offen offset:0 sc1
  s_waitcnt lgkmcnt(6)
  v_mfma_f32_32x32x16_bf16 a[192:207], v[200:203], v[152:155], a[192:207]
  ds_read_b64_tr_b16 v[200:201], v4 offset:14336
  ds_read_b64_tr_b16 v[202:203], v4 offset:14848
  v_accvgpr_read_b32 v48, a160
  v_accvgpr_read_b32 v49, a161
  v_accvgpr_read_b32 v50, a162
  v_accvgpr_read_b32 v51, a163
  v_accvgpr_read_b32 v52, a164
  v_accvgpr_read_b32 v53, a165
  v_accvgpr_read_b32 v54, a166
  v_accvgpr_read_b32 v55, a167
  v_accvgpr_read_b32 v56, a168
  v_accvgpr_read_b32 v57, a169
  v_accvgpr_read_b32 v58, a170
  v_accvgpr_read_b32 v59, a171
  v_accvgpr_read_b32 v60, a172
  v_accvgpr_read_b32 v61, a173
  s_waitcnt lgkmcnt(6)
  v_mfma_f32_32x32x16_bf16 a[192:207], v[204:207], v[156:159], a[192:207]
  ds_read_b64_tr_b16 v[204:205], v4 offset:32768
  ds_read_b64_tr_b16 v[206:207], v4 offset:33280
  v_accvgpr_read_b32 v62, a174
  v_accvgpr_read_b32 v63, a175
  v_cvt_pk_bf16_f32 v48, v48, v49
  v_cvt_pk_bf16_f32 v49, v50, v51
  v_cvt_pk_bf16_f32 v50, v52, v53
  v_cvt_pk_bf16_f32 v51, v54, v55
  v_cvt_pk_bf16_f32 v52, v56, v57
  v_cvt_pk_bf16_f32 v53, v58, v59
  v_cvt_pk_bf16_f32 v54, v60, v61
  v_cvt_pk_bf16_f32 v55, v62, v63
  s_add_u32 s23, s30, 20480
  buffer_store_dwordx4 v[48:51], v9, s[16:19], s23 offen sc1
  buffer_store_dwordx4 v[52:55], v9, s[16:19], s23 offen offset:1024 sc1
  s_waitcnt lgkmcnt(6)
  v_mfma_f32_32x32x16_bf16 a[208:223], v[208:211], v[152:155], a[208:223]
  ds_read_b64_tr_b16 v[208:209], v4 offset:15360
  ds_read_b64_tr_b16 v[210:211], v4 offset:15872
  v_accvgpr_read_b32 v64, a176
  v_accvgpr_read_b32 v65, a177
  v_accvgpr_read_b32 v66, a178
  v_accvgpr_read_b32 v67, a179
  v_accvgpr_read_b32 v68, a180
  v_accvgpr_read_b32 v69, a181
  v_accvgpr_read_b32 v70, a182
  v_accvgpr_read_b32 v71, a183
  v_accvgpr_read_b32 v72, a184
  v_accvgpr_read_b32 v73, a185
  v_accvgpr_read_b32 v74, a186
  v_accvgpr_read_b32 v75, a187
  v_accvgpr_read_b32 v76, a188
  v_accvgpr_read_b32 v77, a189
  s_waitcnt lgkmcnt(6)
  v_mfma_f32_32x32x16_bf16 a[208:223], v[212:215], v[156:159], a[208:223]
  ds_read_b64_tr_b16 v[212:213], v4 offset:33792
  ds_read_b64_tr_b16 v[214:215], v4 offset:34304
  v_accvgpr_read_b32 v78, a190
  v_accvgpr_read_b32 v79, a191
  v_cvt_pk_bf16_f32 v64, v64, v65
  v_cvt_pk_bf16_f32 v65, v66, v67
  v_cvt_pk_bf16_f32 v66, v68, v69
  v_cvt_pk_bf16_f32 v67, v70, v71
  v_cvt_pk_bf16_f32 v68, v72, v73
  v_cvt_pk_bf16_f32 v69, v74, v75
  v_cvt_pk_bf16_f32 v70, v76, v77
  v_cvt_pk_bf16_f32 v71, v78, v79
  s_add_u32 s23, s30, 22528
  buffer_store_dwordx4 v[64:67], v9, s[16:19], s23 offen sc1
  buffer_store_dwordx4 v[68:71], v9, s[16:19], s23 offen offset:1024 sc1
  s_waitcnt lgkmcnt(6)
  v_mfma_f32_32x32x16_bf16 a[224:239], v[200:203], v[152:155], a[224:239]
  ds_read_b64_tr_b16 v[200:201], v4 offset:16384
  ds_read_b64_tr_b16 v[202:203], v4 offset:16896
  v_accvgpr_read_b32 v80, a192
  v_accvgpr_read_b32 v81, a193
  v_accvgpr_read_b32 v82, a194
  v_accvgpr_read_b32 v83, a195
  v_accvgpr_read_b32 v84, a196
  v_accvgpr_read_b32 v85, a197
  v_accvgpr_read_b32 v86, a198
  v_accvgpr_read_b32 v87, a199
  v_accvgpr_read_b32 v88, a200
  v_accvgpr_read_b32 v89, a201
  v_accvgpr_read_b32 v90, a202
  v_accvgpr_read_b32 v91, a203
  v_accvgpr_read_b32 v92, a204
  v_accvgpr_read_b32 v93, a205
  s_waitcnt lgkmcnt(6)
  v_mfma_f32_32x32x16_bf16 a[224:239], v[204:207], v[156:159], a[224:239]
  ds_read_b64_tr_b16 v[204:205], v4 offset:34816
  ds_read_b64_tr_b16 v[206:207], v4 offset:35328
  v_accvgpr_read_b32 v94, a206
  v_accvgpr_read_b32 v95, a207
  v_cvt_pk_bf16_f32 v80, v80, v81
  v_cvt_pk_bf16_f32 v81, v82, v83
  v_cvt_pk_bf16_f32 v82, v84, v85
  v_cvt_pk_bf16_f32 v83, v86, v87
  v_cvt_pk_bf16_f32 v84, v88, v89
  v_cvt_pk_bf16_f32 v85, v90, v91
  v_cvt_pk_bf16_f32 v86, v92, v93
  v_cvt_pk_bf16_f32 v87, v94, v95
  s_add_u32 s23, s30, 24576
  buffer_store_dwordx4 v[80:83], v9, s[16:19], s23 offen sc1
  buffer_store_dwordx4 v[84:87], v9, s[16:19], s23 offen offset:1024 sc1
  s_waitcnt vmcnt(15)
  buffer_atomic_add v11, v10, s[72:75], 0 offen offset:128 sc1
  s_waitcnt lgkmcnt(6)
  v_mfma_f32_32x32x16_bf16 a[240:255], v[208:211], v[152:155], a[240:255]
  ds_read_b64_tr_b16 v[208:209], v4 offset:17408
  ds_read_b64_tr_b16 v[210:211], v4 offset:17920
  v_accvgpr_read_b32 v96, a208
  v_accvgpr_read_b32 v97, a209
  v_accvgpr_read_b32 v98, a210
  v_accvgpr_read_b32 v99, a211
  v_accvgpr_read_b32 v100, a212
  v_accvgpr_read_b32 v101, a213
  v_accvgpr_read_b32 v102, a214
  v_accvgpr_read_b32 v103, a215
  v_accvgpr_read_b32 v104, a216
  v_accvgpr_read_b32 v105, a217
  v_accvgpr_read_b32 v106, a218
  v_accvgpr_read_b32 v107, a219
  v_accvgpr_read_b32 v108, a220
  v_accvgpr_read_b32 v109, a221
  s_waitcnt lgkmcnt(6)
  v_mfma_f32_32x32x16_bf16 a[240:255], v[212:215], v[156:159], a[240:255]
  ds_read_b64_tr_b16 v[212:213], v4 offset:35840
  ds_read_b64_tr_b16 v[214:215], v4 offset:36352
  v_accvgpr_read_b32 v110, a222
  v_accvgpr_read_b32 v111, a223
  v_cvt_pk_bf16_f32 v96, v96, v97
  v_cvt_pk_bf16_f32 v97, v98, v99
  v_cvt_pk_bf16_f32 v98, v100, v101
  v_cvt_pk_bf16_f32 v99, v102, v103
  v_cvt_pk_bf16_f32 v100, v104, v105
  v_cvt_pk_bf16_f32 v101, v106, v107
  v_cvt_pk_bf16_f32 v102, v108, v109
  v_cvt_pk_bf16_f32 v103, v110, v111
  s_add_u32 s23, s30, 26624
  buffer_store_dwordx4 v[96:99], v9, s[16:19], s23 offen sc1
  buffer_store_dwordx4 v[100:103], v9, s[16:19], s23 offen offset:1024 sc1
  s_waitcnt lgkmcnt(6)
  v_mfma_f32_32x32x16_bf16 v[216:231], v[200:203], v[152:155], v[216:231]
  v_accvgpr_read_b32 v112, a224
  v_accvgpr_read_b32 v113, a225
  v_accvgpr_read_b32 v114, a226
  v_accvgpr_read_b32 v115, a227
  v_accvgpr_read_b32 v116, a228
  v_accvgpr_read_b32 v117, a229
  v_accvgpr_read_b32 v118, a230
  v_accvgpr_read_b32 v119, a231
  v_accvgpr_read_b32 v120, a232
  v_accvgpr_read_b32 v121, a233
  v_accvgpr_read_b32 v122, a234
  v_accvgpr_read_b32 v123, a235
  v_accvgpr_read_b32 v124, a236
  v_accvgpr_read_b32 v125, a237
  s_waitcnt lgkmcnt(4)
  v_mfma_f32_32x32x16_bf16 v[216:231], v[204:207], v[156:159], v[216:231]
  v_accvgpr_read_b32 v126, a238
  v_accvgpr_read_b32 v127, a239
  v_cvt_pk_bf16_f32 v112, v112, v113
  v_cvt_pk_bf16_f32 v113, v114, v115
  v_cvt_pk_bf16_f32 v114, v116, v117
  v_cvt_pk_bf16_f32 v115, v118, v119
  v_cvt_pk_bf16_f32 v116, v120, v121
  v_cvt_pk_bf16_f32 v117, v122, v123
  v_cvt_pk_bf16_f32 v118, v124, v125
  v_cvt_pk_bf16_f32 v119, v126, v127
  s_add_u32 s23, s30, 28672
  buffer_store_dwordx4 v[112:115], v9, s[16:19], s23 offen sc1
  buffer_store_dwordx4 v[116:119], v9, s[16:19], s23 offen offset:1024 sc1
  s_waitcnt lgkmcnt(2)
  v_mfma_f32_32x32x16_bf16 v[232:247], v[208:211], v[152:155], v[232:247]
  v_accvgpr_read_b32 v128, a240
  v_accvgpr_read_b32 v129, a241
  v_accvgpr_read_b32 v130, a242
  v_accvgpr_read_b32 v131, a243
  v_accvgpr_read_b32 v132, a244
  v_accvgpr_read_b32 v133, a245
  v_accvgpr_read_b32 v134, a246
  v_accvgpr_read_b32 v135, a247
  v_accvgpr_read_b32 v136, a248
  v_accvgpr_read_b32 v137, a249
  v_accvgpr_read_b32 v138, a250
  v_accvgpr_read_b32 v139, a251
  v_accvgpr_read_b32 v140, a252
  v_accvgpr_read_b32 v141, a253
  s_waitcnt lgkmcnt(0)
  v_mfma_f32_32x32x16_bf16 v[232:247], v[212:215], v[156:159], v[232:247]
  v_accvgpr_read_b32 v142, a254
  v_accvgpr_read_b32 v143, a255
  v_cvt_pk_bf16_f32 v128, v128, v129
  v_cvt_pk_bf16_f32 v129, v130, v131
  v_cvt_pk_bf16_f32 v130, v132, v133
  v_cvt_pk_bf16_f32 v131, v134, v135
  v_cvt_pk_bf16_f32 v132, v136, v137
  v_cvt_pk_bf16_f32 v133, v138, v139
  v_cvt_pk_bf16_f32 v134, v140, v141
  v_cvt_pk_bf16_f32 v135, v142, v143
  s_add_u32 s23, s30, 30720
  buffer_store_dwordx4 v[128:131], v9, s[16:19], s23 offen sc1
  buffer_store_dwordx4 v[132:135], v9, s[16:19], s23 offen offset:1024 sc1
  s_waitcnt vmcnt(16)
  buffer_atomic_add v11, v10, s[72:75], 0 offen offset:256 sc1
  v_cvt_pk_bf16_f32 v16, v216, v217
  v_cvt_pk_bf16_f32 v17, v218, v219
  v_cvt_pk_bf16_f32 v18, v220, v221
  v_cvt_pk_bf16_f32 v19, v222, v223
  v_cvt_pk_bf16_f32 v20, v224, v225
  v_cvt_pk_bf16_f32 v21, v226, v227
  v_cvt_pk_bf16_f32 v22, v228, v229
  v_cvt_pk_bf16_f32 v23, v230, v231
  s_add_u32 s23, s30, 32768
  buffer_store_dwordx4 v[16:19], v9, s[16:19], s23 offen sc1
  buffer_store_dwordx4 v[20:23], v9, s[16:19], s23 offen offset:1024 sc1
  s_waitcnt vmcnt(12)
  buffer_atomic_add v11, v10, s[72:75], 0 offen offset:384 sc1
  v_cvt_pk_bf16_f32 v32, v232, v233
  v_cvt_pk_bf16_f32 v33, v234, v235
  v_cvt_pk_bf16_f32 v34, v236, v237
  v_cvt_pk_bf16_f32 v35, v238, v239
  v_cvt_pk_bf16_f32 v36, v240, v241
  v_cvt_pk_bf16_f32 v37, v242, v243
  v_cvt_pk_bf16_f32 v38, v244, v245
  v_cvt_pk_bf16_f32 v39, v246, v247
  s_add_u32 s23, s30, 34816
  buffer_store_dwordx4 v[32:35], v9, s[16:19], s23 offen sc1
  buffer_store_dwordx4 v[36:39], v9, s[16:19], s23 offen offset:1024 sc1
  s_waitcnt vmcnt(8)
  buffer_atomic_add v11, v10, s[72:75], 0 offen offset:512 sc1
  s_waitcnt vmcnt(1)
  buffer_atomic_add v11, v10, s[72:75], 0 offen offset:640 sc1
L_k3_end:
  s_endpgm
.section .rodata,"a"
.p2align 6
.amdhsa_kernel k1_kernel
  .amdhsa_next_free_vgpr 244
  .amdhsa_next_free_sgpr 102
  .amdhsa_accum_offset 244
  .amdhsa_group_segment_fixed_size 0
  .amdhsa_kernarg_size 96
  .amdhsa_user_sgpr_count 2
  .amdhsa_user_sgpr_kernarg_segment_ptr 1
  .amdhsa_system_sgpr_workgroup_id_x 1
  .amdhsa_float_denorm_mode_32 3
.end_amdhsa_kernel
.p2align 6
.amdhsa_kernel k234_kernel
  .amdhsa_next_free_vgpr 512
  .amdhsa_next_free_sgpr 102
  .amdhsa_accum_offset 256
  .amdhsa_group_segment_fixed_size 0
  .amdhsa_kernarg_size 96
  .amdhsa_user_sgpr_count 2
  .amdhsa_user_sgpr_kernarg_segment_ptr 1
  .amdhsa_system_sgpr_workgroup_id_x 1
  .amdhsa_float_denorm_mode_32 3
.end_amdhsa_kernel
```
